```python
import torch

def _softmax(x, axis=-1):
    return torch.softmax(x, dim=axis)
def _gelu(x):
    return torch.nn.functional.gelu(x, approximate="tanh")
def _silu(x):
    return torch.nn.functional.silu(x)
def _sigmoid(x):
    return torch.sigmoid(x)
def _layernorm(x, axis=-1, eps=1e-5):
    m = x.mean(dim=axis, keepdim=True)
    v = x.var(dim=axis, keepdim=True, unbiased=False)
    return (x - m) / torch.sqrt(v + eps)
def _scatter_add(tgt, idx, src, axis=0):
    return tgt.clone().index_add_(axis, idx, src)
def _segment_sum(src, seg, n):
    out = torch.zeros((n,) + src.shape[1:], dtype=src.dtype)
    return out.index_add_(0, seg, src)
def _pad(x, pw):
    flat = tuple(v for pair in reversed(pw) for v in pair)
    return torch.nn.functional.pad(x, flat)

kernel_name = 'recurrent_scan__compressed_kv_cla__geglu_ffn__prompt'

def setup_inputs():

    _w = (lambda a: (lambda t: t.to(torch.bfloat16) if t.is_floating_point() else t)(torch.as_tensor(a)))
    def _A_setup():
        B, H, Sq, Sk, D, M = 1, 32, 2048, 2048, 128, 512
        Dc = 4 * D
        return {
            "x": _w((lambda *s: torch.randn(*s, dtype=torch.bfloat16) * 0.05)(B, Sq, M)),
            "c_kv": _w((lambda *s: torch.randn(*s, dtype=torch.bfloat16) * 0.2)(B, Sk, Dc)),
            "w_q": _w((lambda *s: torch.randn(*s, dtype=torch.bfloat16) * 3.2)(M, H, D) * (M ** -0.5)),
            "w_uk": _w((lambda *s: torch.randn(*s, dtype=torch.bfloat16) * 3.2)(Dc, H, D) * (Dc ** -0.5)),
            "w_uv": _w((lambda *s: torch.randn(*s, dtype=torch.bfloat16) * 0.2)(Dc, H, D) * (Dc ** -0.5)),
            "w_o": _w((lambda *s: torch.randn(*s, dtype=torch.bfloat16) * 0.2)(H, D, M) * ((H * D) ** -0.5)),
        }
    _A_in = _A_setup()

    def _B_setup():
        B, S, D, F = 1, 2048, 512, 1792
        return {
            "x": _w((lambda *s: torch.randn(*s, dtype=torch.bfloat16) * 0.05)(B, S, D)),
            "w_gate": _w((lambda *s: torch.randn(*s, dtype=torch.bfloat16) * 0.1)(D, F)),
            "w_up": _w((lambda *s: torch.randn(*s, dtype=torch.bfloat16) * 0.1)(D, F)),
            "w_down": _w((lambda *s: torch.randn(*s, dtype=torch.bfloat16) * 0.1)(F, D)),
        }
    _B_in = _B_setup()

    return {
        "A_x": _A_in["x"],
        "A_c_kv": _A_in["c_kv"],
        "A_w_q": _A_in["w_q"],
        "A_w_uk": _A_in["w_uk"],
        "A_w_uv": _A_in["w_uv"],
        "A_w_o": _A_in["w_o"],
        "B_x": _B_in["x"],
        "B_w_gate": _B_in["w_gate"],
        "B_w_up": _B_in["w_up"],
        "B_w_down": _B_in["w_down"],
    }

def reference(A_x, A_c_kv, A_w_q, A_w_uk, A_w_uv, A_w_o, B_x, B_w_gate, B_w_up, B_w_down):
    def _A_ref(x, c_kv, w_q, w_uk, w_uv, w_o):
        B, Sq, M = x.shape[0], x.shape[1], x.shape[2]
        Sk = c_kv.shape[1]
        H, D = w_q.shape[1], w_q.shape[2]
        q = torch.einsum("bqm,mhd->bhqd", x, w_q)
        k = torch.einsum("bkc,chd->bhkd", c_kv, w_uk)
        v = torch.einsum("bkc,chd->bhkd", c_kv, w_uv)
        scores = torch.einsum("bhqd,bhkd->bhqk", q, k) * (D ** -0.5)
        off = Sk - Sq
        qi = torch.arange(Sq)[:, None]
        kj = torch.arange(Sk)[None, :]
        cmask = kj <= (qi + off)
        scores = torch.where(cmask[None, None], scores, -1e9)
        p = _softmax(scores, axis=-1)
        ctx = torch.einsum("bhqk,bhkd->bhqd", p, v)
        return torch.einsum("bhqd,hdm->bqm", ctx, w_o)

    def _B_ref(x, w_gate, w_up, w_down):
        return (_gelu(x @ w_gate) * (x @ w_up)) @ w_down

    x = A_x
    xn = _layernorm(x, axis=-1)
    s = _A_ref(xn, A_c_kv, A_w_q, A_w_uk, A_w_uv, A_w_o)
    g = _silu(_B_ref(xn, B_w_gate, B_w_up, B_w_down))
    return x + s * g
```

```asm
; @launch grid=(256,1,1) block=(512,1,1) lds=163840
.amdgcn_target "amdgcn-amd-amdhsa--gfx950"
.text
.globl recurrent_scan__compressed_kv_cla__geglu_ffn__prompt_kernel
.p2align 8
.type recurrent_scan__compressed_kv_cla__geglu_ffn__prompt_kernel,@function
recurrent_scan__compressed_kv_cla__geglu_ffn__prompt_kernel:
    s_cmp_ge_u32 s2, 256
    s_cbranch_scc1 f_done_1
    s_load_dwordx8 s[56:63], s[0:1], 0
    s_load_dwordx4 s[64:67], s[0:1], 32
    s_load_dwordx4 s[68:71], s[0:1], 56
    s_load_dwordx2 s[100:101], s[0:1], 72
    s_load_dwordx4 s[72:75], s[0:1], 88
    s_getpc_b64 s[76:77]
    code_here:
    s_lshr_b32 s3, s2, 3
    s_lshl_b32 s3, s3, 11
    v_lshlrev_b32 v247, 7, v0
    v_add_u32 v247, s3, v247
    v_min_u32 v247, code_end - code_here - 4, v247
    v_cmp_gt_u32 vcc, 16, v0
    s_and_saveexec_b64 s[78:79], vcc
    s_cbranch_execz code_skip
    global_load_dword v247, v247, s[76:77]
    code_skip:
    s_mov_b64 exec, -1
    v_lshrrev_b32 v1, 6, v0
    v_and_b32 v0, 63, v0
    v_readfirstlane_b32 s40, v1
    s_and_b32 s41, s2, 7
    s_lshl_b32 s41, s41, 2
    s_lshr_b32 s42, s2, 3
    s_and_b32 s42, s42, 3
    s_add_u32 s41, s41, s42
    s_lshr_b32 s42, s2, 5
    s_and_b32 s43, s40, 1
    s_lshr_b32 s44, s40, 1
    s_lshr_b32 s45, s40, 2
    s_and_b32 s46, s40, 3
    v_lshlrev_b32 v1, 4, v0
    s_waitcnt lgkmcnt(0)
    s_mov_b32 s4, s74
    s_mov_b32 s5, s75
    s_mov_b32 s6, s66
    s_mov_b32 s7, s67

    s_mov_b32 s32, s56
    s_mov_b32 s33, s57
    s_mov_b32 s34, 0x200000
    s_mov_b32 s35, 0x00020000
    s_mov_b32 s24, s58
    s_mov_b32 s25, s59
    s_mov_b32 s26, 0x200000
    s_mov_b32 s27, 0x00020000
    s_mov_b32 s20, s60
    s_mov_b32 s21, s61
    s_mov_b32 s22, 0x400000
    s_mov_b32 s23, 0x00020000
    s_cmp_lt_u32 s40, 4
    s_cselect_b32 s28, s62, s64
    s_cselect_b32 s29, s63, s65
    s_mov_b32 s30, 0x400000
    s_mov_b32 s31, 0x00020000

    s_mov_b32 s36, s62
    s_mov_b32 s37, s63
    s_mov_b32 s38, 0x400000
    s_mov_b32 s39, 0x00020000
    s_mov_b32 s60, s64
    s_mov_b32 s61, s65
    s_mov_b32 s62, 0x400000
    s_mov_b32 s63, 0x00020000
    s_mov_b32 s12, s68
    s_mov_b32 s13, s69
    s_mov_b32 s14, 0x1c0000
    s_mov_b32 s15, 0x00020000
    s_mov_b32 s16, s70
    s_mov_b32 s17, s71
    s_mov_b32 s18, 0x1c0000
    s_mov_b32 s19, 0x00020000
    s_mov_b32 s76, s72
    s_mov_b32 s77, s73
    s_mov_b32 s78, 0x100
    s_mov_b32 s79, 0x00020000
    s_mov_b32 s8, s4
    s_mov_b32 s9, s5
    s_mov_b32 s10, 0x200000
    s_mov_b32 s11, 0x00020000
    s_and_b32 s3, s2, 7
    s_sub_u32 s65, 15, s42
    s_getreg_b32 s74, hwreg(HW_REG_XCC_ID)
    s_and_b32 s74, s74, 7
    s_or_b32 s74, s74, 0x10
    s_cmp_lt_u32 s41, 16
    s_cselect_b32 s58, s42, s65
    s_lshl_b32 s58, s58, 7
    s_and_b32 s66, s41, 15
    s_lshl_b32 s66, s66, 3
    s_add_u32 s58, s58, s66
    s_add_u32 s58, s58, s40
    s_lshl_b32 s67, s58, 10
    s_lshl_b32 s66, s40, 10
    s_add_u32 m0, s66, 0xc000
    v_add_u32 v204, 0xc000, v1
    v_add_u32 v204, s66, v204
    buffer_load_dwordx4 v1, s[32:35], s67 offen lds

    v_mov_b32 v14, 0
    v_mov_b32 v15, 1
    s_cmp_lt_u32 s41, 14
    s_cselect_b32 s52, s42, s65
    s_cselect_b32 s53, s65, s42
    s_sub_u32 s51, s41, 14
    s_cselect_b32 s51, s41, s51
    s_cmp_ge_u32 s51, 14
    s_cselect_b32 s51, 0, s51

    s_load_dwordx2 s[70:71], s[0:1], 80
    s_mov_b32 s32, s4
    s_mov_b32 s33, s5
    s_mov_b32 s34, 0x8000000
    s_mov_b32 s35, 0x00020000
    v_mov_b32 v246, 0
    s_lshl_b32 s66, s41, 19
    s_lshl_b32 s67, s42, 16
    s_add_u32 s66, s66, s67
    s_add_u32 s67, s66, 0x1000000
    v_mov_b32 v246, s67
    s_add_u32 s68, s66, 0x2000000
    v_writelane_b32 v246, s68, 1
    s_mul_i32 s66, s52, 458752
    s_lshl_b32 s68, s51, 13
    s_add_u32 s66, s66, s68
    s_add_u32 s66, s66, 0x3000000
    s_cmp_lt_u32 s41, 28
    s_cselect_b32 s66, s66, s67
    v_writelane_b32 v246, s66, 2
    s_lshl_b32 s68, s41, 13
    s_lshl_b32 s66, s65, 20
    s_add_u32 s66, s66, s68
    s_add_u32 s66, s66, 0x4000000
    v_writelane_b32 v246, s66, 3
    s_lshl_b32 s66, s42, 20
    s_add_u32 s66, s66, s68
    s_add_u32 s66, s66, 0x4000000
    v_writelane_b32 v246, s66, 4
    s_mul_i32 s66, s2, 23552
    s_add_u32 s66, s66, 0x7000000
    v_writelane_b32 v246, s66, 5
    s_lshl_b32 s66, s2, 7
    s_add_u32 s66, s66, 0x7800000
    v_writelane_b32 v246, s66, 6
    s_lshr_b32 s66, s58, 5
    s_lshl_b32 s66, s66, 15
    s_and_b32 s68, s58, 31
    s_lshl_b32 s68, s68, 4
    s_add_u32 s66, s66, s68
    v_writelane_b32 v246, s66, 7
    s_lshr_b32 s66, s41, 3
    s_cmp_lt_u32 s66, 2
    s_cselect_b32 s67, s42, s65
    s_lshl_b32 s67, s67, 1
    s_and_b32 s66, s66, 1
    s_add_u32 s67, s67, s66
    s_lshl_b32 s67, s67, 16
    s_and_b32 s66, s41, 7
    s_lshl_b32 s66, s66, 7
    s_add_u32 s67, s67, s66

    s_cmp_lg_u32 s40, 2
    s_cbranch_scc1 tlb_skip_2
    s_mov_b64 exec, 0xff
    buffer_load_dword v245, v246, s[32:35], 0 offen
    s_waitcnt lgkmcnt(0)

    s_mov_b32 s32, s70
    s_mov_b32 s33, s71
    s_mov_b32 s34, 0x200000
    s_mov_b32 s35, 0x00020000
    s_mov_b64 exec, 1
    buffer_load_dword v245, v14, s[32:35], s67 offen
    s_mov_b64 exec, -1

tlb_skip_2:
    s_waitcnt lgkmcnt(0)
    v_lshrrev_b32 v6, 2, v0
    v_lshlrev_b32 v6, 10, v6
    v_lshrrev_b32 v7, 4, v0
    v_and_b32 v8, 3, v0
    v_xor_b32 v8, v8, v7
    v_lshlrev_b32 v8, 4, v8
    v_add_u32 v2, v6, v8
    v_add_u32 v3, 15360, v2
    v_lshlrev_b32 v6, 13, v7
    v_and_b32 v8, 15, v0
    v_lshlrev_b32 v9, 2, v7
    v_xor_b32 v8, v8, v9
    v_lshlrev_b32 v8, 4, v8
    v_add_u32 v4, v6, v8
    v_add_u32 v5, 31744, v4
    s_lshl_b32 s66, s45, 1
    s_add_u32 s66, s66, s43
    s_lshl_b32 s54, s42, 18
    s_lshl_b32 s68, s66, 16
    s_add_u32 s54, s54, s68
    s_lshl_b32 s55, s43, 17
    s_lshl_b32 s68, s41, 8
    s_add_u32 s55, s55, s68
    s_lshl_b32 s56, s66, 12
    s_add_u32 s57, s56, 0x10000

    s_cmp_ge_u32 s46, 2
    s_cbranch_scc1 p1_prow_3
    s_add_u32 m0, s56, 0
    s_add_u32 s68, s54, 0
    buffer_load_dwordx4 v2, s[24:27], s68 offen lds
    buffer_load_dwordx4 v3, s[24:27], s68 offen offset:1024 lds
    s_add_u32 m0, s56, 2048
    s_add_u32 s68, s54, 32768
    buffer_load_dwordx4 v2, s[24:27], s68 offen lds
    buffer_load_dwordx4 v3, s[24:27], s68 offen offset:1024 lds
    s_add_u32 m0, s56, 16384
    s_add_u32 s68, s54, 64
    buffer_load_dwordx4 v2, s[24:27], s68 offen lds
    buffer_load_dwordx4 v3, s[24:27], s68 offen offset:1024 lds
    s_add_u32 m0, s56, 18432
    s_add_u32 s68, s54, 32832
    buffer_load_dwordx4 v2, s[24:27], s68 offen lds
    buffer_load_dwordx4 v3, s[24:27], s68 offen offset:1024 lds
    s_add_u32 m0, s56, 32768
    s_add_u32 s68, s54, 128
    buffer_load_dwordx4 v2, s[24:27], s68 offen lds
    buffer_load_dwordx4 v3, s[24:27], s68 offen offset:1024 lds
    s_add_u32 m0, s56, 34816
    s_add_u32 s68, s54, 32896
    buffer_load_dwordx4 v2, s[24:27], s68 offen lds
    buffer_load_dwordx4 v3, s[24:27], s68 offen offset:1024 lds
    s_branch p1_proj_4
p1_prow_3:
    s_add_u32 m0, s57, 0
    s_add_u32 s69, s55, 0
    buffer_load_dwordx4 v4, s[28:31], s69 offen lds
    buffer_load_dwordx4 v5, s[28:31], s69 offen offset:1024 lds
    s_add_u32 m0, s57, 2048
    s_add_u32 s69, s55, 65536
    buffer_load_dwordx4 v4, s[28:31], s69 offen lds
    buffer_load_dwordx4 v5, s[28:31], s69 offen offset:1024 lds
    s_add_u32 m0, s57, 16384
    s_add_u32 s69, s55, 262144
    buffer_load_dwordx4 v4, s[28:31], s69 offen lds
    buffer_load_dwordx4 v5, s[28:31], s69 offen offset:1024 lds
    s_add_u32 m0, s57, 18432
    s_add_u32 s69, s55, 327680
    buffer_load_dwordx4 v4, s[28:31], s69 offen lds
    buffer_load_dwordx4 v5, s[28:31], s69 offen offset:1024 lds
    s_add_u32 m0, s57, 32768
    s_add_u32 s69, s55, 524288
    buffer_load_dwordx4 v4, s[28:31], s69 offen lds
    buffer_load_dwordx4 v5, s[28:31], s69 offen offset:1024 lds
    s_add_u32 m0, s57, 34816
    s_add_u32 s69, s55, 589824
    buffer_load_dwordx4 v4, s[28:31], s69 offen lds
    buffer_load_dwordx4 v5, s[28:31], s69 offen offset:1024 lds
p1_proj_4:
    s_lshl_b32 s66, s2, 3
    s_add_u32 s66, s66, s40
    s_lshl_b32 s67, s66, 10
    s_lshl_b32 s66, s66, 11
    v_lshlrev_b32 v6, 7, v0
    s_mov_b64 exec, 0xff
    buffer_load_dword v9, v6, s[24:27], s67 offen
    s_mov_b64 exec, 0xffff
    buffer_load_dword v9, v6, s[36:39], s66 offen
    buffer_load_dword v9, v6, s[60:63], s66 offen
    s_mov_b64 exec, -1

    s_mov_b32 s66, 0x1000000
    s_cmp_lt_u32 s46, 2
    s_cselect_b32 s66, s66, 0x2000000
    s_add_u32 s32, s4, s66
    s_addc_u32 s33, s5, 0
    s_mov_b32 s34, 0x1000000
    s_mov_b32 s35, 0x00020000

    v_and_b32 v6, 31, v0
    v_lshrrev_b32 v7, 5, v0
    v_lshrrev_b32 v8, 2, v6
    v_and_b32 v8, 3, v8
    v_xor_b32 v8, v8, v7
    v_lshlrev_b32 v8, 4, v8
    v_lshlrev_b32 v6, 6, v6
    v_add_u32 v6, v6, v8
    s_lshl_b32 s68, s45, 13
    v_add_u32 v10, s68, v6
    v_xor_b32 v11, 32, v10
    v_lshrrev_b32 v6, 5, v0
    v_lshlrev_b32 v6, 11, v6
    v_bfe_u32 v7, v0, 2, 2
    v_lshlrev_b32 v8, 8, v7
    v_add_u32 v6, v6, v8
    v_lshlrev_b32 v8, 6, v7
    v_add_u32 v6, v6, v8
    v_bfe_u32 v8, v0, 4, 1
    v_lshlrev_b32 v8, 5, v8
    v_add_u32 v6, v6, v8
    v_and_b32 v8, 3, v0
    v_lshlrev_b32 v8, 3, v8
    v_add_u32 v198, v6, v8
    s_lshr_b32 s68, s46, 1
    s_lshl_b32 s68, s68, 13
    s_add_u32 s68, s68, 0x10000
    v_add_u32 v6, s68, v198
    s_and_b32 s68, s46, 1
    s_lshl_b32 s68, s68, 7
    v_xor_b32 v12, s68, v6
    v_xor_b32 v13, 64, v12
    v_add_u32 v192, 0x10000, v12
    v_add_u32 v193, 0x10000, v13

    s_cmp_ge_u32 s46, 2
    s_cbranch_scc1 ln_w_5
    s_waitcnt vmcnt(15)
    s_branch ln_j_6
ln_w_5:
    s_waitcnt vmcnt(15)
ln_j_6:
    ds_read_b128 v[200:203], v204
    s_waitcnt lgkmcnt(0)
    v_lshlrev_b32 v204, 16, v200
    v_and_b32 v205, 0xffff0000, v200
    v_lshlrev_b32 v206, 16, v201
    v_and_b32 v207, 0xffff0000, v201
    v_lshlrev_b32 v208, 16, v202
    v_and_b32 v209, 0xffff0000, v202
    v_lshlrev_b32 v210, 16, v203
    v_and_b32 v211, 0xffff0000, v203
    v_add_f32 v212, v204, v205
    v_add_f32 v212, v212, v206
    v_add_f32 v212, v212, v207
    v_add_f32 v212, v212, v208
    v_add_f32 v212, v212, v209
    v_add_f32 v212, v212, v210
    v_add_f32 v212, v212, v211
    s_nop 1
    v_add_f32_dpp v212, v212, v212 quad_perm:[1,0,3,2] row_mask:0xf bank_mask:0xf
    s_nop 1
    v_add_f32_dpp v212, v212, v212 quad_perm:[2,3,0,1] row_mask:0xf bank_mask:0xf
    s_nop 1
    v_add_f32_dpp v212, v212, v212 row_half_mirror row_mask:0xf bank_mask:0xf
    s_nop 1
    v_add_f32_dpp v212, v212, v212 row_mirror row_mask:0xf bank_mask:0xf
    s_nop 1
    v_readlane_b32 s70, v212, 0
    v_readlane_b32 s71, v212, 16
    v_readlane_b32 s72, v212, 32
    v_readlane_b32 s73, v212, 48
    s_nop 1
    v_mov_b32 v212, s70
    v_add_f32 v212, s71, v212
    v_add_f32 v212, s72, v212
    v_add_f32 v212, s73, v212

    v_mul_f32 v212, 0.001953125, v212
    v_sub_f32 v213, v204, v212
    v_mul_f32 v214, v213, v213
    v_sub_f32 v213, v205, v212
    v_fmac_f32 v214, v213, v213
    v_sub_f32 v213, v206, v212
    v_fmac_f32 v214, v213, v213
    v_sub_f32 v213, v207, v212
    v_fmac_f32 v214, v213, v213
    v_sub_f32 v213, v208, v212
    v_fmac_f32 v214, v213, v213
    v_sub_f32 v213, v209, v212
    v_fmac_f32 v214, v213, v213
    v_sub_f32 v213, v210, v212
    v_fmac_f32 v214, v213, v213
    v_sub_f32 v213, v211, v212
    v_fmac_f32 v214, v213, v213
    s_nop 1
    v_add_f32_dpp v214, v214, v214 quad_perm:[1,0,3,2] row_mask:0xf bank_mask:0xf
    s_nop 1
    v_add_f32_dpp v214, v214, v214 quad_perm:[2,3,0,1] row_mask:0xf bank_mask:0xf
    s_nop 1
    v_add_f32_dpp v214, v214, v214 row_half_mirror row_mask:0xf bank_mask:0xf
    s_nop 1
    v_add_f32_dpp v214, v214, v214 row_mirror row_mask:0xf bank_mask:0xf
    s_nop 1
    v_readlane_b32 s70, v214, 0
    v_readlane_b32 s71, v214, 16
    v_readlane_b32 s72, v214, 32
    v_readlane_b32 s73, v214, 48
    s_nop 1
    v_mov_b32 v214, s70
    v_add_f32 v214, s71, v214
    v_add_f32 v214, s72, v214
    v_add_f32 v214, s73, v214

    v_mul_f32 v214, 0.001953125, v214
    v_cvt_pk_bf16_f32 v212, v212, v212
    v_lshlrev_b32 v212, 16, v212
    v_cvt_pk_bf16_f32 v214, v214, v214
    v_lshlrev_b32 v214, 16, v214
    v_add_f32 v214, 0x3727c5ac, v214
    v_cvt_pk_bf16_f32 v214, v214, v214
    v_lshlrev_b32 v214, 16, v214
    v_sqrt_f32 v214, v214
    s_nop 0
    v_cvt_pk_bf16_f32 v214, v214, v214
    v_lshlrev_b32 v214, 16, v214
    v_rcp_f32 v215, v214
    s_nop 0
    v_sub_f32 v204, v204, v212
    v_cvt_pk_bf16_f32 v204, v204, v204
    v_lshlrev_b32 v204, 16, v204
    v_mul_f32 v216, v204, v215
    v_fma_f32 v217, -v216, v214, v204
    v_fma_f32 v204, v217, v215, v216
    v_sub_f32 v205, v205, v212
    v_cvt_pk_bf16_f32 v205, v205, v205
    v_lshlrev_b32 v205, 16, v205
    v_mul_f32 v216, v205, v215
    v_fma_f32 v217, -v216, v214, v205
    v_fma_f32 v205, v217, v215, v216
    v_sub_f32 v206, v206, v212
    v_cvt_pk_bf16_f32 v206, v206, v206
    v_lshlrev_b32 v206, 16, v206
    v_mul_f32 v216, v206, v215
    v_fma_f32 v217, -v216, v214, v206
    v_fma_f32 v206, v217, v215, v216
    v_sub_f32 v207, v207, v212
    v_cvt_pk_bf16_f32 v207, v207, v207
    v_lshlrev_b32 v207, 16, v207
    v_mul_f32 v216, v207, v215
    v_fma_f32 v217, -v216, v214, v207
    v_fma_f32 v207, v217, v215, v216
    v_sub_f32 v208, v208, v212
    v_cvt_pk_bf16_f32 v208, v208, v208
    v_lshlrev_b32 v208, 16, v208
    v_mul_f32 v216, v208, v215
    v_fma_f32 v217, -v216, v214, v208
    v_fma_f32 v208, v217, v215, v216
    v_sub_f32 v209, v209, v212
    v_cvt_pk_bf16_f32 v209, v209, v209
    v_lshlrev_b32 v209, 16, v209
    v_mul_f32 v216, v209, v215
    v_fma_f32 v217, -v216, v214, v209
    v_fma_f32 v209, v217, v215, v216
    v_sub_f32 v210, v210, v212
    v_cvt_pk_bf16_f32 v210, v210, v210
    v_lshlrev_b32 v210, 16, v210
    v_mul_f32 v216, v210, v215
    v_fma_f32 v217, -v216, v214, v210
    v_fma_f32 v210, v217, v215, v216
    v_sub_f32 v211, v211, v212
    v_cvt_pk_bf16_f32 v211, v211, v211
    v_lshlrev_b32 v211, 16, v211
    v_mul_f32 v216, v211, v215
    v_fma_f32 v217, -v216, v214, v211
    v_fma_f32 v211, v217, v215, v216
    v_cvt_pk_bf16_f32 v200, v204, v205
    v_cvt_pk_bf16_f32 v201, v206, v207
    v_cvt_pk_bf16_f32 v202, v208, v209
    v_cvt_pk_bf16_f32 v203, v210, v211
    v_lshrrev_b32 v6, 1, v0
    v_lshlrev_b32 v6, 10, v6
    v_and_b32 v7, 1, v0
    v_lshlrev_b32 v7, 9, v7
    v_add_u32 v6, v6, v7
    s_lshr_b32 s68, s58, 5
    s_lshl_b32 s68, s68, 15
    s_and_b32 s69, s58, 31
    s_lshl_b32 s69, s69, 4
    s_add_u32 s68, s68, s69

    v_mov_b32 v204, v6
    s_mov_b32 s58, s68
    s_add_u32 s68, s4, 0x7800000
    s_addc_u32 s69, s5, 0
    s_mov_b32 s70, 0x8000
    s_mov_b32 s71, 0x00020000
    s_lshl_b32 s72, s2, 7
    s_cmp_eq_u32 s40, 1
    s_cselect_b32 s72, s72, 0x7ff00000
    s_mov_b64 exec, 1
    buffer_store_dword v14, v14, s[68:71], s72 offen sc0 sc1
    s_mov_b64 exec, -1
    buffer_store_dwordx4 v[200:203], v204, s[8:11], s58 offen sc0 sc1

    v_lshlrev_b32 v244, 2, v0
    s_lshl_b32 s68, s2, 3
    s_add_u32 s68, s68, s40
    s_lshl_b32 s60, s68, 11
    s_mul_i32 s61, s68, 896
    v_lshlrev_b32 v8, 7, v0

    s_cmp_ge_u32 s46, 2
    s_cbranch_scc1 p1_v_7
    s_waitcnt vmcnt(9)
    s_barrier
    ds_read_b64_tr_b16 v[32:33], v12 offset:0
    ds_read_b64_tr_b16 v[34:35], v12 offset:1024
    ds_read_b64_tr_b16 v[36:37], v13 offset:0
    ds_read_b64_tr_b16 v[38:39], v13 offset:1024
    ds_read_b128 v[16:19], v10 offset:0
    ds_read_b128 v[20:23], v10 offset:2048
    ds_read_b128 v[24:27], v10 offset:4096
    ds_read_b128 v[28:31], v10 offset:6144
    s_waitcnt lgkmcnt(3)
    v_mfma_f32_32x32x16_bf16 v[64:79], v[32:35], v[16:19], 0
    ds_read_b64_tr_b16 v[56:57], v12 offset:4096
    v_mfma_f32_32x32x16_bf16 v[80:95], v[36:39], v[16:19], 0
    ds_read_b64_tr_b16 v[58:59], v12 offset:5120
    s_add_u32 m0, s56, 49152
    s_add_u32 s68, s54, 192
    buffer_load_dwordx4 v2, s[24:27], s68 offen lds
    s_waitcnt lgkmcnt(4)
    v_mfma_f32_32x32x16_bf16 v[96:111], v[32:35], v[20:23], 0
    ds_read_b64_tr_b16 v[60:61], v13 offset:4096
    v_mfma_f32_32x32x16_bf16 v[112:127], v[36:39], v[20:23], 0
    ds_read_b64_tr_b16 v[62:63], v13 offset:5120
    s_waitcnt lgkmcnt(5)
    v_mfma_f32_32x32x16_bf16 v[128:143], v[32:35], v[24:27], 0
    ds_read_b128 v[40:43], v11 offset:0
    v_mfma_f32_32x32x16_bf16 v[144:159], v[36:39], v[24:27], 0
    ds_read_b128 v[44:47], v11 offset:2048
    buffer_load_dwordx4 v3, s[24:27], s68 offen offset:1024 lds
    s_waitcnt lgkmcnt(6)
    v_mfma_f32_32x32x16_bf16 v[160:175], v[32:35], v[28:31], 0
    ds_read_b128 v[48:51], v11 offset:4096
    v_mfma_f32_32x32x16_bf16 v[176:191], v[36:39], v[28:31], 0
    ds_read_b128 v[52:55], v11 offset:6144
    s_waitcnt lgkmcnt(3)
    v_mfma_f32_32x32x16_bf16 v[64:79], v[56:59], v[40:43], v[64:79]
    ds_read_b64_tr_b16 v[32:33], v12 offset:16384
    v_mfma_f32_32x32x16_bf16 v[80:95], v[60:63], v[40:43], v[80:95]
    ds_read_b64_tr_b16 v[34:35], v12 offset:17408
    s_add_u32 m0, s56, 51200
    s_add_u32 s68, s54, 32960
    buffer_load_dwordx4 v2, s[24:27], s68 offen lds
    s_waitcnt lgkmcnt(4)
    v_mfma_f32_32x32x16_bf16 v[96:111], v[56:59], v[44:47], v[96:111]
    ds_read_b64_tr_b16 v[36:37], v13 offset:16384
    v_mfma_f32_32x32x16_bf16 v[112:127], v[60:63], v[44:47], v[112:127]
    ds_read_b64_tr_b16 v[38:39], v13 offset:17408
    s_waitcnt lgkmcnt(5)
    v_mfma_f32_32x32x16_bf16 v[128:143], v[56:59], v[48:51], v[128:143]
    ds_read_b128 v[16:19], v10 offset:16384
    v_mfma_f32_32x32x16_bf16 v[144:159], v[60:63], v[48:51], v[144:159]
    ds_read_b128 v[20:23], v10 offset:18432
    buffer_load_dwordx4 v3, s[24:27], s68 offen offset:1024 lds
    s_waitcnt lgkmcnt(6)
    v_mfma_f32_32x32x16_bf16 v[160:175], v[56:59], v[52:55], v[160:175]
    ds_read_b128 v[24:27], v10 offset:20480
    v_mfma_f32_32x32x16_bf16 v[176:191], v[60:63], v[52:55], v[176:191]
    ds_read_b128 v[28:31], v10 offset:22528
    s_waitcnt vmcnt(9)
    s_barrier
    s_waitcnt lgkmcnt(3)
    v_mfma_f32_32x32x16_bf16 v[64:79], v[32:35], v[16:19], v[64:79]
    ds_read_b64_tr_b16 v[56:57], v12 offset:20480
    v_mfma_f32_32x32x16_bf16 v[80:95], v[36:39], v[16:19], v[80:95]
    ds_read_b64_tr_b16 v[58:59], v12 offset:21504
    s_add_u32 m0, s56, 0
    s_add_u32 s68, s54, 256
    buffer_load_dwordx4 v2, s[24:27], s68 offen lds
    s_waitcnt lgkmcnt(4)
    v_mfma_f32_32x32x16_bf16 v[96:111], v[32:35], v[20:23], v[96:111]
    ds_read_b64_tr_b16 v[60:61], v13 offset:20480
    v_mfma_f32_32x32x16_bf16 v[112:127], v[36:39], v[20:23], v[112:127]
    ds_read_b64_tr_b16 v[62:63], v13 offset:21504
    s_waitcnt lgkmcnt(5)
    v_mfma_f32_32x32x16_bf16 v[128:143], v[32:35], v[24:27], v[128:143]
    ds_read_b128 v[40:43], v11 offset:16384
    v_mfma_f32_32x32x16_bf16 v[144:159], v[36:39], v[24:27], v[144:159]
    ds_read_b128 v[44:47], v11 offset:18432
    buffer_load_dwordx4 v3, s[24:27], s68 offen offset:1024 lds
    s_waitcnt lgkmcnt(6)
    v_mfma_f32_32x32x16_bf16 v[160:175], v[32:35], v[28:31], v[160:175]
    ds_read_b128 v[48:51], v11 offset:20480
    v_mfma_f32_32x32x16_bf16 v[176:191], v[36:39], v[28:31], v[176:191]
    ds_read_b128 v[52:55], v11 offset:22528
    s_waitcnt lgkmcnt(3)
    v_mfma_f32_32x32x16_bf16 v[64:79], v[56:59], v[40:43], v[64:79]
    ds_read_b64_tr_b16 v[32:33], v12 offset:32768
    v_mfma_f32_32x32x16_bf16 v[80:95], v[60:63], v[40:43], v[80:95]
    ds_read_b64_tr_b16 v[34:35], v12 offset:33792
    s_add_u32 m0, s56, 2048
    s_add_u32 s68, s54, 33024
    buffer_load_dwordx4 v2, s[24:27], s68 offen lds
    s_waitcnt lgkmcnt(4)
    v_mfma_f32_32x32x16_bf16 v[96:111], v[56:59], v[44:47], v[96:111]
    ds_read_b64_tr_b16 v[36:37], v13 offset:32768
    v_mfma_f32_32x32x16_bf16 v[112:127], v[60:63], v[44:47], v[112:127]
    ds_read_b64_tr_b16 v[38:39], v13 offset:33792
    s_waitcnt lgkmcnt(5)
    v_mfma_f32_32x32x16_bf16 v[128:143], v[56:59], v[48:51], v[128:143]
    ds_read_b128 v[16:19], v10 offset:32768
    v_mfma_f32_32x32x16_bf16 v[144:159], v[60:63], v[48:51], v[144:159]
    ds_read_b128 v[20:23], v10 offset:34816
    buffer_load_dwordx4 v3, s[24:27], s68 offen offset:1024 lds
    s_waitcnt lgkmcnt(6)
    v_mfma_f32_32x32x16_bf16 v[160:175], v[56:59], v[52:55], v[160:175]
    ds_read_b128 v[24:27], v10 offset:36864
    v_mfma_f32_32x32x16_bf16 v[176:191], v[60:63], v[52:55], v[176:191]
    ds_read_b128 v[28:31], v10 offset:38912
    s_waitcnt vmcnt(4)
    s_barrier
    s_waitcnt lgkmcnt(3)
    v_mfma_f32_32x32x16_bf16 v[64:79], v[32:35], v[16:19], v[64:79]
    ds_read_b64_tr_b16 v[56:57], v12 offset:36864
    v_mfma_f32_32x32x16_bf16 v[80:95], v[36:39], v[16:19], v[80:95]
    ds_read_b64_tr_b16 v[58:59], v12 offset:37888
    s_add_u32 m0, s56, 16384
    s_add_u32 s68, s54, 320
    buffer_load_dwordx4 v2, s[24:27], s68 offen lds
    s_waitcnt lgkmcnt(4)
    v_mfma_f32_32x32x16_bf16 v[96:111], v[32:35], v[20:23], v[96:111]
    ds_read_b64_tr_b16 v[60:61], v13 offset:36864
    v_mfma_f32_32x32x16_bf16 v[112:127], v[36:39], v[20:23], v[112:127]
    ds_read_b64_tr_b16 v[62:63], v13 offset:37888
    s_waitcnt lgkmcnt(5)
    v_mfma_f32_32x32x16_bf16 v[128:143], v[32:35], v[24:27], v[128:143]
    ds_read_b128 v[40:43], v11 offset:32768
    v_mfma_f32_32x32x16_bf16 v[144:159], v[36:39], v[24:27], v[144:159]
    ds_read_b128 v[44:47], v11 offset:34816
    buffer_load_dwordx4 v3, s[24:27], s68 offen offset:1024 lds
    s_waitcnt lgkmcnt(6)
    v_mfma_f32_32x32x16_bf16 v[160:175], v[32:35], v[28:31], v[160:175]
    ds_read_b128 v[48:51], v11 offset:36864
    v_mfma_f32_32x32x16_bf16 v[176:191], v[36:39], v[28:31], v[176:191]
    ds_read_b128 v[52:55], v11 offset:38912
    s_waitcnt lgkmcnt(3)
    v_mfma_f32_32x32x16_bf16 v[64:79], v[56:59], v[40:43], v[64:79]
    ds_read_b64_tr_b16 v[32:33], v12 offset:49152
    v_mfma_f32_32x32x16_bf16 v[80:95], v[60:63], v[40:43], v[80:95]
    ds_read_b64_tr_b16 v[34:35], v12 offset:50176
    s_add_u32 m0, s56, 18432
    s_add_u32 s68, s54, 33088
    buffer_load_dwordx4 v2, s[24:27], s68 offen lds
    s_waitcnt lgkmcnt(4)
    v_mfma_f32_32x32x16_bf16 v[96:111], v[56:59], v[44:47], v[96:111]
    ds_read_b64_tr_b16 v[36:37], v13 offset:49152
    v_mfma_f32_32x32x16_bf16 v[112:127], v[60:63], v[44:47], v[112:127]
    ds_read_b64_tr_b16 v[38:39], v13 offset:50176
    s_waitcnt lgkmcnt(5)
    v_mfma_f32_32x32x16_bf16 v[128:143], v[56:59], v[48:51], v[128:143]
    ds_read_b128 v[16:19], v10 offset:49152
    v_mfma_f32_32x32x16_bf16 v[144:159], v[60:63], v[48:51], v[144:159]
    ds_read_b128 v[20:23], v10 offset:51200
    buffer_load_dwordx4 v3, s[24:27], s68 offen offset:1024 lds
    s_waitcnt lgkmcnt(6)
    v_mfma_f32_32x32x16_bf16 v[160:175], v[56:59], v[52:55], v[160:175]
    ds_read_b128 v[24:27], v10 offset:53248
    v_mfma_f32_32x32x16_bf16 v[176:191], v[60:63], v[52:55], v[176:191]
    ds_read_b128 v[28:31], v10 offset:55296
    s_waitcnt vmcnt(4)
    s_barrier
    s_cmp_lg_u32 s40, 0
    s_cbranch_scc1 p1_nf_9
    v_mov_b32 v15, s74
    s_mov_b64 exec, 1
    buffer_store_byte v15, v14, s[76:79], s2 offen sc0 sc1
    s_mov_b64 exec, -1
p1_nf_9:
    s_waitcnt lgkmcnt(3)
    v_mfma_f32_32x32x16_bf16 v[64:79], v[32:35], v[16:19], v[64:79]
    ds_read_b64_tr_b16 v[56:57], v12 offset:53248
    v_mfma_f32_32x32x16_bf16 v[80:95], v[36:39], v[16:19], v[80:95]
    ds_read_b64_tr_b16 v[58:59], v12 offset:54272
    s_add_u32 m0, s56, 32768
    s_add_u32 s68, s54, 384
    buffer_load_dwordx4 v2, s[24:27], s68 offen lds
    s_waitcnt lgkmcnt(4)
    v_mfma_f32_32x32x16_bf16 v[96:111], v[32:35], v[20:23], v[96:111]
    ds_read_b64_tr_b16 v[60:61], v13 offset:53248
    v_mfma_f32_32x32x16_bf16 v[112:127], v[36:39], v[20:23], v[112:127]
    ds_read_b64_tr_b16 v[62:63], v13 offset:54272
    s_waitcnt lgkmcnt(5)
    v_mfma_f32_32x32x16_bf16 v[128:143], v[32:35], v[24:27], v[128:143]
    ds_read_b128 v[40:43], v11 offset:49152
    v_mfma_f32_32x32x16_bf16 v[144:159], v[36:39], v[24:27], v[144:159]
    ds_read_b128 v[44:47], v11 offset:51200
    buffer_load_dwordx4 v3, s[24:27], s68 offen offset:1024 lds
    s_waitcnt lgkmcnt(6)
    v_mfma_f32_32x32x16_bf16 v[160:175], v[32:35], v[28:31], v[160:175]
    ds_read_b128 v[48:51], v11 offset:53248
    v_mfma_f32_32x32x16_bf16 v[176:191], v[36:39], v[28:31], v[176:191]
    ds_read_b128 v[52:55], v11 offset:55296
    s_waitcnt lgkmcnt(3)
    v_mfma_f32_32x32x16_bf16 v[64:79], v[56:59], v[40:43], v[64:79]
    ds_read_b64_tr_b16 v[32:33], v12 offset:0
    v_mfma_f32_32x32x16_bf16 v[80:95], v[60:63], v[40:43], v[80:95]
    ds_read_b64_tr_b16 v[34:35], v12 offset:1024
    s_add_u32 m0, s56, 34816
    s_add_u32 s68, s54, 33152
    buffer_load_dwordx4 v2, s[24:27], s68 offen lds
    s_waitcnt lgkmcnt(4)
    v_mfma_f32_32x32x16_bf16 v[96:111], v[56:59], v[44:47], v[96:111]
    ds_read_b64_tr_b16 v[36:37], v13 offset:0
    v_mfma_f32_32x32x16_bf16 v[112:127], v[60:63], v[44:47], v[112:127]
    ds_read_b64_tr_b16 v[38:39], v13 offset:1024
    s_waitcnt lgkmcnt(5)
    v_mfma_f32_32x32x16_bf16 v[128:143], v[56:59], v[48:51], v[128:143]
    ds_read_b128 v[16:19], v10 offset:0
    v_mfma_f32_32x32x16_bf16 v[144:159], v[60:63], v[48:51], v[144:159]
    ds_read_b128 v[20:23], v10 offset:2048
    buffer_load_dwordx4 v3, s[24:27], s68 offen offset:1024 lds
    s_waitcnt lgkmcnt(6)
    v_mfma_f32_32x32x16_bf16 v[160:175], v[56:59], v[52:55], v[160:175]
    ds_read_b128 v[24:27], v10 offset:4096
    v_mfma_f32_32x32x16_bf16 v[176:191], v[60:63], v[52:55], v[176:191]
    ds_read_b128 v[28:31], v10 offset:6144
    s_waitcnt vmcnt(4)
    s_barrier
    s_waitcnt lgkmcnt(3)
    v_mfma_f32_32x32x16_bf16 v[64:79], v[32:35], v[16:19], v[64:79]
    ds_read_b64_tr_b16 v[56:57], v12 offset:4096
    v_mfma_f32_32x32x16_bf16 v[80:95], v[36:39], v[16:19], v[80:95]
    ds_read_b64_tr_b16 v[58:59], v12 offset:5120
    s_add_u32 m0, s56, 49152
    s_add_u32 s68, s54, 448
    buffer_load_dwordx4 v2, s[24:27], s68 offen lds
    s_waitcnt lgkmcnt(4)
    v_mfma_f32_32x32x16_bf16 v[96:111], v[32:35], v[20:23], v[96:111]
    ds_read_b64_tr_b16 v[60:61], v13 offset:4096
    v_mfma_f32_32x32x16_bf16 v[112:127], v[36:39], v[20:23], v[112:127]
    ds_read_b64_tr_b16 v[62:63], v13 offset:5120
    s_waitcnt lgkmcnt(5)
    v_mfma_f32_32x32x16_bf16 v[128:143], v[32:35], v[24:27], v[128:143]
    ds_read_b128 v[40:43], v11 offset:0
    v_mfma_f32_32x32x16_bf16 v[144:159], v[36:39], v[24:27], v[144:159]
    ds_read_b128 v[44:47], v11 offset:2048
    buffer_load_dwordx4 v3, s[24:27], s68 offen offset:1024 lds
    s_waitcnt lgkmcnt(6)
    v_mfma_f32_32x32x16_bf16 v[160:175], v[32:35], v[28:31], v[160:175]
    ds_read_b128 v[48:51], v11 offset:4096
    v_mfma_f32_32x32x16_bf16 v[176:191], v[36:39], v[28:31], v[176:191]
    ds_read_b128 v[52:55], v11 offset:6144
    s_waitcnt lgkmcnt(3)
    v_mfma_f32_32x32x16_bf16 v[64:79], v[56:59], v[40:43], v[64:79]
    ds_read_b64_tr_b16 v[32:33], v12 offset:16384
    v_mfma_f32_32x32x16_bf16 v[80:95], v[60:63], v[40:43], v[80:95]
    ds_read_b64_tr_b16 v[34:35], v12 offset:17408
    s_add_u32 m0, s56, 51200
    s_add_u32 s68, s54, 33216
    buffer_load_dwordx4 v2, s[24:27], s68 offen lds
    s_waitcnt lgkmcnt(4)
    v_mfma_f32_32x32x16_bf16 v[96:111], v[56:59], v[44:47], v[96:111]
    ds_read_b64_tr_b16 v[36:37], v13 offset:16384
    v_mfma_f32_32x32x16_bf16 v[112:127], v[60:63], v[44:47], v[112:127]
    ds_read_b64_tr_b16 v[38:39], v13 offset:17408
    s_waitcnt lgkmcnt(5)
    v_mfma_f32_32x32x16_bf16 v[128:143], v[56:59], v[48:51], v[128:143]
    ds_read_b128 v[16:19], v10 offset:16384
    v_mfma_f32_32x32x16_bf16 v[144:159], v[60:63], v[48:51], v[144:159]
    ds_read_b128 v[20:23], v10 offset:18432
    buffer_load_dwordx4 v3, s[24:27], s68 offen offset:1024 lds
    s_waitcnt lgkmcnt(6)
    v_mfma_f32_32x32x16_bf16 v[160:175], v[56:59], v[52:55], v[160:175]
    ds_read_b128 v[24:27], v10 offset:20480
    v_mfma_f32_32x32x16_bf16 v[176:191], v[60:63], v[52:55], v[176:191]
    ds_read_b128 v[28:31], v10 offset:22528
    s_waitcnt vmcnt(4)
    s_barrier
    s_waitcnt lgkmcnt(3)
    v_mfma_f32_32x32x16_bf16 v[64:79], v[32:35], v[16:19], v[64:79]
    ds_read_b64_tr_b16 v[56:57], v12 offset:20480
    v_mfma_f32_32x32x16_bf16 v[80:95], v[36:39], v[16:19], v[80:95]
    ds_read_b64_tr_b16 v[58:59], v12 offset:21504
    s_add_u32 m0, s56, 0
    s_add_u32 s68, s54, 512
    buffer_load_dwordx4 v2, s[24:27], s68 offen lds
    s_waitcnt lgkmcnt(4)
    v_mfma_f32_32x32x16_bf16 v[96:111], v[32:35], v[20:23], v[96:111]
    ds_read_b64_tr_b16 v[60:61], v13 offset:20480
    v_mfma_f32_32x32x16_bf16 v[112:127], v[36:39], v[20:23], v[112:127]
    ds_read_b64_tr_b16 v[62:63], v13 offset:21504
    s_waitcnt lgkmcnt(5)
    v_mfma_f32_32x32x16_bf16 v[128:143], v[32:35], v[24:27], v[128:143]
    ds_read_b128 v[40:43], v11 offset:16384
    v_mfma_f32_32x32x16_bf16 v[144:159], v[36:39], v[24:27], v[144:159]
    ds_read_b128 v[44:47], v11 offset:18432
    buffer_load_dwordx4 v3, s[24:27], s68 offen offset:1024 lds
    s_waitcnt lgkmcnt(6)
    v_mfma_f32_32x32x16_bf16 v[160:175], v[32:35], v[28:31], v[160:175]
    ds_read_b128 v[48:51], v11 offset:20480
    v_mfma_f32_32x32x16_bf16 v[176:191], v[36:39], v[28:31], v[176:191]
    ds_read_b128 v[52:55], v11 offset:22528
    s_waitcnt lgkmcnt(3)
    v_mfma_f32_32x32x16_bf16 v[64:79], v[56:59], v[40:43], v[64:79]
    ds_read_b64_tr_b16 v[32:33], v12 offset:32768
    v_mfma_f32_32x32x16_bf16 v[80:95], v[60:63], v[40:43], v[80:95]
    ds_read_b64_tr_b16 v[34:35], v12 offset:33792
    s_add_u32 m0, s56, 2048
    s_add_u32 s68, s54, 33280
    buffer_load_dwordx4 v2, s[24:27], s68 offen lds
    s_waitcnt lgkmcnt(4)
    v_mfma_f32_32x32x16_bf16 v[96:111], v[56:59], v[44:47], v[96:111]
    ds_read_b64_tr_b16 v[36:37], v13 offset:32768
    v_mfma_f32_32x32x16_bf16 v[112:127], v[60:63], v[44:47], v[112:127]
    ds_read_b64_tr_b16 v[38:39], v13 offset:33792
    s_waitcnt lgkmcnt(5)
    v_mfma_f32_32x32x16_bf16 v[128:143], v[56:59], v[48:51], v[128:143]
    ds_read_b128 v[16:19], v10 offset:32768
    v_mfma_f32_32x32x16_bf16 v[144:159], v[60:63], v[48:51], v[144:159]
    ds_read_b128 v[20:23], v10 offset:34816
    buffer_load_dwordx4 v3, s[24:27], s68 offen offset:1024 lds
    s_waitcnt lgkmcnt(6)
    v_mfma_f32_32x32x16_bf16 v[160:175], v[56:59], v[52:55], v[160:175]
    ds_read_b128 v[24:27], v10 offset:36864
    v_mfma_f32_32x32x16_bf16 v[176:191], v[60:63], v[52:55], v[176:191]
    ds_read_b128 v[28:31], v10 offset:38912
    s_waitcnt vmcnt(4)
    s_barrier
    s_mov_b64 exec, 0xffff
    buffer_load_dword v9, v8, s[20:23], s60 offen
    s_mov_b64 exec, 0x7f
    buffer_load_dword v9, v8, s[12:15], s61 offen
    buffer_load_dword v9, v8, s[16:19], s61 offen
    s_mov_b64 exec, -1
    s_waitcnt lgkmcnt(3)
    v_mfma_f32_32x32x16_bf16 v[64:79], v[32:35], v[16:19], v[64:79]
    ds_read_b64_tr_b16 v[56:57], v12 offset:36864
    v_mfma_f32_32x32x16_bf16 v[80:95], v[36:39], v[16:19], v[80:95]
    ds_read_b64_tr_b16 v[58:59], v12 offset:37888
    s_add_u32 m0, s56, 16384
    s_add_u32 s68, s54, 576
    buffer_load_dwordx4 v2, s[24:27], s68 offen lds
    s_waitcnt lgkmcnt(4)
    v_mfma_f32_32x32x16_bf16 v[96:111], v[32:35], v[20:23], v[96:111]
    ds_read_b64_tr_b16 v[60:61], v13 offset:36864
    v_mfma_f32_32x32x16_bf16 v[112:127], v[36:39], v[20:23], v[112:127]
    ds_read_b64_tr_b16 v[62:63], v13 offset:37888
    s_waitcnt lgkmcnt(5)
    v_mfma_f32_32x32x16_bf16 v[128:143], v[32:35], v[24:27], v[128:143]
    ds_read_b128 v[40:43], v11 offset:32768
    v_mfma_f32_32x32x16_bf16 v[144:159], v[36:39], v[24:27], v[144:159]
    ds_read_b128 v[44:47], v11 offset:34816
    buffer_load_dwordx4 v3, s[24:27], s68 offen offset:1024 lds
    s_waitcnt lgkmcnt(6)
    v_mfma_f32_32x32x16_bf16 v[160:175], v[32:35], v[28:31], v[160:175]
    ds_read_b128 v[48:51], v11 offset:36864
    v_mfma_f32_32x32x16_bf16 v[176:191], v[36:39], v[28:31], v[176:191]
    ds_read_b128 v[52:55], v11 offset:38912
    s_waitcnt lgkmcnt(3)
    v_mfma_f32_32x32x16_bf16 v[64:79], v[56:59], v[40:43], v[64:79]
    ds_read_b64_tr_b16 v[32:33], v12 offset:49152
    v_mfma_f32_32x32x16_bf16 v[80:95], v[60:63], v[40:43], v[80:95]
    ds_read_b64_tr_b16 v[34:35], v12 offset:50176
    s_add_u32 m0, s56, 18432
    s_add_u32 s68, s54, 33344
    buffer_load_dwordx4 v2, s[24:27], s68 offen lds
    s_waitcnt lgkmcnt(4)
    v_mfma_f32_32x32x16_bf16 v[96:111], v[56:59], v[44:47], v[96:111]
    ds_read_b64_tr_b16 v[36:37], v13 offset:49152
    v_mfma_f32_32x32x16_bf16 v[112:127], v[60:63], v[44:47], v[112:127]
    ds_read_b64_tr_b16 v[38:39], v13 offset:50176
    s_waitcnt lgkmcnt(5)
    v_mfma_f32_32x32x16_bf16 v[128:143], v[56:59], v[48:51], v[128:143]
    ds_read_b128 v[16:19], v10 offset:49152
    v_mfma_f32_32x32x16_bf16 v[144:159], v[60:63], v[48:51], v[144:159]
    ds_read_b128 v[20:23], v10 offset:51200
    buffer_load_dwordx4 v3, s[24:27], s68 offen offset:1024 lds
    s_waitcnt lgkmcnt(6)
    v_mfma_f32_32x32x16_bf16 v[160:175], v[56:59], v[52:55], v[160:175]
    ds_read_b128 v[24:27], v10 offset:53248
    v_mfma_f32_32x32x16_bf16 v[176:191], v[60:63], v[52:55], v[176:191]
    ds_read_b128 v[28:31], v10 offset:55296
    s_waitcnt vmcnt(4)
    s_barrier
    s_waitcnt lgkmcnt(3)
    v_mfma_f32_32x32x16_bf16 v[64:79], v[32:35], v[16:19], v[64:79]
    ds_read_b64_tr_b16 v[56:57], v12 offset:53248
    v_mfma_f32_32x32x16_bf16 v[80:95], v[36:39], v[16:19], v[80:95]
    ds_read_b64_tr_b16 v[58:59], v12 offset:54272
    s_add_u32 m0, s56, 32768
    s_add_u32 s68, s54, 640
    buffer_load_dwordx4 v2, s[24:27], s68 offen lds
    s_waitcnt lgkmcnt(4)
    v_mfma_f32_32x32x16_bf16 v[96:111], v[32:35], v[20:23], v[96:111]
    ds_read_b64_tr_b16 v[60:61], v13 offset:53248
    v_mfma_f32_32x32x16_bf16 v[112:127], v[36:39], v[20:23], v[112:127]
    ds_read_b64_tr_b16 v[62:63], v13 offset:54272
    s_waitcnt lgkmcnt(5)
    v_mfma_f32_32x32x16_bf16 v[128:143], v[32:35], v[24:27], v[128:143]
    ds_read_b128 v[40:43], v11 offset:49152
    v_mfma_f32_32x32x16_bf16 v[144:159], v[36:39], v[24:27], v[144:159]
    ds_read_b128 v[44:47], v11 offset:51200
    buffer_load_dwordx4 v3, s[24:27], s68 offen offset:1024 lds
    s_waitcnt lgkmcnt(6)
    v_mfma_f32_32x32x16_bf16 v[160:175], v[32:35], v[28:31], v[160:175]
    ds_read_b128 v[48:51], v11 offset:53248
    v_mfma_f32_32x32x16_bf16 v[176:191], v[36:39], v[28:31], v[176:191]
    ds_read_b128 v[52:55], v11 offset:55296
    s_waitcnt lgkmcnt(3)
    v_mfma_f32_32x32x16_bf16 v[64:79], v[56:59], v[40:43], v[64:79]
    ds_read_b64_tr_b16 v[32:33], v12 offset:0
    v_mfma_f32_32x32x16_bf16 v[80:95], v[60:63], v[40:43], v[80:95]
    ds_read_b64_tr_b16 v[34:35], v12 offset:1024
    s_add_u32 m0, s56, 34816
    s_add_u32 s68, s54, 33408
    buffer_load_dwordx4 v2, s[24:27], s68 offen lds
    s_waitcnt lgkmcnt(4)
    v_mfma_f32_32x32x16_bf16 v[96:111], v[56:59], v[44:47], v[96:111]
    ds_read_b64_tr_b16 v[36:37], v13 offset:0
    v_mfma_f32_32x32x16_bf16 v[112:127], v[60:63], v[44:47], v[112:127]
    ds_read_b64_tr_b16 v[38:39], v13 offset:1024
    s_waitcnt lgkmcnt(5)
    v_mfma_f32_32x32x16_bf16 v[128:143], v[56:59], v[48:51], v[128:143]
    ds_read_b128 v[16:19], v10 offset:0
    v_mfma_f32_32x32x16_bf16 v[144:159], v[60:63], v[48:51], v[144:159]
    ds_read_b128 v[20:23], v10 offset:2048
    buffer_load_dwordx4 v3, s[24:27], s68 offen offset:1024 lds
    s_waitcnt lgkmcnt(6)
    v_mfma_f32_32x32x16_bf16 v[160:175], v[56:59], v[52:55], v[160:175]
    ds_read_b128 v[24:27], v10 offset:4096
    v_mfma_f32_32x32x16_bf16 v[176:191], v[60:63], v[52:55], v[176:191]
    ds_read_b128 v[28:31], v10 offset:6144
    s_waitcnt vmcnt(4)
    s_barrier
    s_waitcnt lgkmcnt(3)
    v_mfma_f32_32x32x16_bf16 v[64:79], v[32:35], v[16:19], v[64:79]
    ds_read_b64_tr_b16 v[56:57], v12 offset:4096
    v_mfma_f32_32x32x16_bf16 v[80:95], v[36:39], v[16:19], v[80:95]
    ds_read_b64_tr_b16 v[58:59], v12 offset:5120
    s_add_u32 m0, s56, 49152
    s_add_u32 s68, s54, 704
    buffer_load_dwordx4 v2, s[24:27], s68 offen lds
    s_waitcnt lgkmcnt(4)
    v_mfma_f32_32x32x16_bf16 v[96:111], v[32:35], v[20:23], v[96:111]
    ds_read_b64_tr_b16 v[60:61], v13 offset:4096
    v_mfma_f32_32x32x16_bf16 v[112:127], v[36:39], v[20:23], v[112:127]
    ds_read_b64_tr_b16 v[62:63], v13 offset:5120
    s_waitcnt lgkmcnt(5)
    v_mfma_f32_32x32x16_bf16 v[128:143], v[32:35], v[24:27], v[128:143]
    ds_read_b128 v[40:43], v11 offset:0
    v_mfma_f32_32x32x16_bf16 v[144:159], v[36:39], v[24:27], v[144:159]
    ds_read_b128 v[44:47], v11 offset:2048
    buffer_load_dwordx4 v3, s[24:27], s68 offen offset:1024 lds
    s_waitcnt lgkmcnt(6)
    v_mfma_f32_32x32x16_bf16 v[160:175], v[32:35], v[28:31], v[160:175]
    ds_read_b128 v[48:51], v11 offset:4096
    v_mfma_f32_32x32x16_bf16 v[176:191], v[36:39], v[28:31], v[176:191]
    ds_read_b128 v[52:55], v11 offset:6144
    s_waitcnt lgkmcnt(3)
    v_mfma_f32_32x32x16_bf16 v[64:79], v[56:59], v[40:43], v[64:79]
    ds_read_b64_tr_b16 v[32:33], v12 offset:16384
    v_mfma_f32_32x32x16_bf16 v[80:95], v[60:63], v[40:43], v[80:95]
    ds_read_b64_tr_b16 v[34:35], v12 offset:17408
    s_add_u32 m0, s56, 51200
    s_add_u32 s68, s54, 33472
    buffer_load_dwordx4 v2, s[24:27], s68 offen lds
    s_waitcnt lgkmcnt(4)
    v_mfma_f32_32x32x16_bf16 v[96:111], v[56:59], v[44:47], v[96:111]
    ds_read_b64_tr_b16 v[36:37], v13 offset:16384
    v_mfma_f32_32x32x16_bf16 v[112:127], v[60:63], v[44:47], v[112:127]
    ds_read_b64_tr_b16 v[38:39], v13 offset:17408
    s_waitcnt lgkmcnt(5)
    v_mfma_f32_32x32x16_bf16 v[128:143], v[56:59], v[48:51], v[128:143]
    ds_read_b128 v[16:19], v10 offset:16384
    v_mfma_f32_32x32x16_bf16 v[144:159], v[60:63], v[48:51], v[144:159]
    ds_read_b128 v[20:23], v10 offset:18432
    buffer_load_dwordx4 v3, s[24:27], s68 offen offset:1024 lds
    s_waitcnt lgkmcnt(6)
    v_mfma_f32_32x32x16_bf16 v[160:175], v[56:59], v[52:55], v[160:175]
    ds_read_b128 v[24:27], v10 offset:20480
    v_mfma_f32_32x32x16_bf16 v[176:191], v[60:63], v[52:55], v[176:191]
    ds_read_b128 v[28:31], v10 offset:22528
    s_waitcnt vmcnt(4)
    s_barrier
    s_waitcnt lgkmcnt(3)
    v_mfma_f32_32x32x16_bf16 v[64:79], v[32:35], v[16:19], v[64:79]
    ds_read_b64_tr_b16 v[56:57], v12 offset:20480
    v_mfma_f32_32x32x16_bf16 v[80:95], v[36:39], v[16:19], v[80:95]
    ds_read_b64_tr_b16 v[58:59], v12 offset:21504
    s_add_u32 m0, s56, 0
    s_add_u32 s68, s54, 768
    buffer_load_dwordx4 v2, s[24:27], s68 offen lds
    s_waitcnt lgkmcnt(4)
    v_mfma_f32_32x32x16_bf16 v[96:111], v[32:35], v[20:23], v[96:111]
    ds_read_b64_tr_b16 v[60:61], v13 offset:20480
    v_mfma_f32_32x32x16_bf16 v[112:127], v[36:39], v[20:23], v[112:127]
    ds_read_b64_tr_b16 v[62:63], v13 offset:21504
    s_waitcnt lgkmcnt(5)
    v_mfma_f32_32x32x16_bf16 v[128:143], v[32:35], v[24:27], v[128:143]
    ds_read_b128 v[40:43], v11 offset:16384
    v_mfma_f32_32x32x16_bf16 v[144:159], v[36:39], v[24:27], v[144:159]
    ds_read_b128 v[44:47], v11 offset:18432
    buffer_load_dwordx4 v3, s[24:27], s68 offen offset:1024 lds
    s_waitcnt lgkmcnt(6)
    v_mfma_f32_32x32x16_bf16 v[160:175], v[32:35], v[28:31], v[160:175]
    ds_read_b128 v[48:51], v11 offset:20480
    v_mfma_f32_32x32x16_bf16 v[176:191], v[36:39], v[28:31], v[176:191]
    ds_read_b128 v[52:55], v11 offset:22528
    s_waitcnt lgkmcnt(3)
    v_mfma_f32_32x32x16_bf16 v[64:79], v[56:59], v[40:43], v[64:79]
    ds_read_b64_tr_b16 v[32:33], v12 offset:32768
    v_mfma_f32_32x32x16_bf16 v[80:95], v[60:63], v[40:43], v[80:95]
    ds_read_b64_tr_b16 v[34:35], v12 offset:33792
    s_add_u32 m0, s56, 2048
    s_add_u32 s68, s54, 33536
    buffer_load_dwordx4 v2, s[24:27], s68 offen lds
    s_waitcnt lgkmcnt(4)
    v_mfma_f32_32x32x16_bf16 v[96:111], v[56:59], v[44:47], v[96:111]
    ds_read_b64_tr_b16 v[36:37], v13 offset:32768
    v_mfma_f32_32x32x16_bf16 v[112:127], v[60:63], v[44:47], v[112:127]
    ds_read_b64_tr_b16 v[38:39], v13 offset:33792
    s_waitcnt lgkmcnt(5)
    v_mfma_f32_32x32x16_bf16 v[128:143], v[56:59], v[48:51], v[128:143]
    ds_read_b128 v[16:19], v10 offset:32768
    v_mfma_f32_32x32x16_bf16 v[144:159], v[60:63], v[48:51], v[144:159]
    ds_read_b128 v[20:23], v10 offset:34816
    buffer_load_dwordx4 v3, s[24:27], s68 offen offset:1024 lds
    s_waitcnt lgkmcnt(6)
    v_mfma_f32_32x32x16_bf16 v[160:175], v[56:59], v[52:55], v[160:175]
    ds_read_b128 v[24:27], v10 offset:36864
    v_mfma_f32_32x32x16_bf16 v[176:191], v[60:63], v[52:55], v[176:191]
    ds_read_b128 v[28:31], v10 offset:38912
    s_waitcnt vmcnt(4)
    s_barrier
    s_waitcnt lgkmcnt(3)
    v_mfma_f32_32x32x16_bf16 v[64:79], v[32:35], v[16:19], v[64:79]
    ds_read_b64_tr_b16 v[56:57], v12 offset:36864
    v_mfma_f32_32x32x16_bf16 v[80:95], v[36:39], v[16:19], v[80:95]
    ds_read_b64_tr_b16 v[58:59], v12 offset:37888
    s_add_u32 m0, s56, 16384
    s_add_u32 s68, s54, 832
    buffer_load_dwordx4 v2, s[24:27], s68 offen lds
    s_waitcnt lgkmcnt(4)
    v_mfma_f32_32x32x16_bf16 v[96:111], v[32:35], v[20:23], v[96:111]
    ds_read_b64_tr_b16 v[60:61], v13 offset:36864
    v_mfma_f32_32x32x16_bf16 v[112:127], v[36:39], v[20:23], v[112:127]
    ds_read_b64_tr_b16 v[62:63], v13 offset:37888
    s_waitcnt lgkmcnt(5)
    v_mfma_f32_32x32x16_bf16 v[128:143], v[32:35], v[24:27], v[128:143]
    ds_read_b128 v[40:43], v11 offset:32768
    v_mfma_f32_32x32x16_bf16 v[144:159], v[36:39], v[24:27], v[144:159]
    ds_read_b128 v[44:47], v11 offset:34816
    buffer_load_dwordx4 v3, s[24:27], s68 offen offset:1024 lds
    s_waitcnt lgkmcnt(6)
    v_mfma_f32_32x32x16_bf16 v[160:175], v[32:35], v[28:31], v[160:175]
    ds_read_b128 v[48:51], v11 offset:36864
    v_mfma_f32_32x32x16_bf16 v[176:191], v[36:39], v[28:31], v[176:191]
    ds_read_b128 v[52:55], v11 offset:38912
    s_waitcnt lgkmcnt(3)
    v_mfma_f32_32x32x16_bf16 v[64:79], v[56:59], v[40:43], v[64:79]
    ds_read_b64_tr_b16 v[32:33], v12 offset:49152
    v_mfma_f32_32x32x16_bf16 v[80:95], v[60:63], v[40:43], v[80:95]
    ds_read_b64_tr_b16 v[34:35], v12 offset:50176
    s_add_u32 m0, s56, 18432
    s_add_u32 s68, s54, 33600
    buffer_load_dwordx4 v2, s[24:27], s68 offen lds
    s_waitcnt lgkmcnt(4)
    v_mfma_f32_32x32x16_bf16 v[96:111], v[56:59], v[44:47], v[96:111]
    ds_read_b64_tr_b16 v[36:37], v13 offset:49152
    v_mfma_f32_32x32x16_bf16 v[112:127], v[60:63], v[44:47], v[112:127]
    ds_read_b64_tr_b16 v[38:39], v13 offset:50176
    s_waitcnt lgkmcnt(5)
    v_mfma_f32_32x32x16_bf16 v[128:143], v[56:59], v[48:51], v[128:143]
    ds_read_b128 v[16:19], v10 offset:49152
    v_mfma_f32_32x32x16_bf16 v[144:159], v[60:63], v[48:51], v[144:159]
    ds_read_b128 v[20:23], v10 offset:51200
    buffer_load_dwordx4 v3, s[24:27], s68 offen offset:1024 lds
    s_waitcnt lgkmcnt(6)
    v_mfma_f32_32x32x16_bf16 v[160:175], v[56:59], v[52:55], v[160:175]
    ds_read_b128 v[24:27], v10 offset:53248
    v_mfma_f32_32x32x16_bf16 v[176:191], v[60:63], v[52:55], v[176:191]
    ds_read_b128 v[28:31], v10 offset:55296
    s_waitcnt vmcnt(4)
    s_barrier
    s_waitcnt lgkmcnt(3)
    v_mfma_f32_32x32x16_bf16 v[64:79], v[32:35], v[16:19], v[64:79]
    ds_read_b64_tr_b16 v[56:57], v12 offset:53248
    v_mfma_f32_32x32x16_bf16 v[80:95], v[36:39], v[16:19], v[80:95]
    ds_read_b64_tr_b16 v[58:59], v12 offset:54272
    s_add_u32 m0, s56, 32768
    s_add_u32 s68, s54, 896
    buffer_load_dwordx4 v2, s[24:27], s68 offen lds
    s_waitcnt lgkmcnt(4)
    v_mfma_f32_32x32x16_bf16 v[96:111], v[32:35], v[20:23], v[96:111]
    ds_read_b64_tr_b16 v[60:61], v13 offset:53248
    v_mfma_f32_32x32x16_bf16 v[112:127], v[36:39], v[20:23], v[112:127]
    ds_read_b64_tr_b16 v[62:63], v13 offset:54272
    s_waitcnt lgkmcnt(5)
    v_mfma_f32_32x32x16_bf16 v[128:143], v[32:35], v[24:27], v[128:143]
    ds_read_b128 v[40:43], v11 offset:49152
    v_mfma_f32_32x32x16_bf16 v[144:159], v[36:39], v[24:27], v[144:159]
    ds_read_b128 v[44:47], v11 offset:51200
    buffer_load_dwordx4 v3, s[24:27], s68 offen offset:1024 lds
    s_waitcnt lgkmcnt(6)
    v_mfma_f32_32x32x16_bf16 v[160:175], v[32:35], v[28:31], v[160:175]
    ds_read_b128 v[48:51], v11 offset:53248
    v_mfma_f32_32x32x16_bf16 v[176:191], v[36:39], v[28:31], v[176:191]
    ds_read_b128 v[52:55], v11 offset:55296
    s_waitcnt lgkmcnt(3)
    v_mfma_f32_32x32x16_bf16 v[64:79], v[56:59], v[40:43], v[64:79]
    ds_read_b64_tr_b16 v[32:33], v12 offset:0
    v_mfma_f32_32x32x16_bf16 v[80:95], v[60:63], v[40:43], v[80:95]
    ds_read_b64_tr_b16 v[34:35], v12 offset:1024
    s_add_u32 m0, s56, 34816
    s_add_u32 s68, s54, 33664
    buffer_load_dwordx4 v2, s[24:27], s68 offen lds
    s_waitcnt lgkmcnt(4)
    v_mfma_f32_32x32x16_bf16 v[96:111], v[56:59], v[44:47], v[96:111]
    ds_read_b64_tr_b16 v[36:37], v13 offset:0
    v_mfma_f32_32x32x16_bf16 v[112:127], v[60:63], v[44:47], v[112:127]
    ds_read_b64_tr_b16 v[38:39], v13 offset:1024
    s_waitcnt lgkmcnt(5)
    v_mfma_f32_32x32x16_bf16 v[128:143], v[56:59], v[48:51], v[128:143]
    ds_read_b128 v[16:19], v10 offset:0
    v_mfma_f32_32x32x16_bf16 v[144:159], v[60:63], v[48:51], v[144:159]
    ds_read_b128 v[20:23], v10 offset:2048
    buffer_load_dwordx4 v3, s[24:27], s68 offen offset:1024 lds
    s_waitcnt lgkmcnt(6)
    v_mfma_f32_32x32x16_bf16 v[160:175], v[56:59], v[52:55], v[160:175]
    ds_read_b128 v[24:27], v10 offset:4096
    v_mfma_f32_32x32x16_bf16 v[176:191], v[60:63], v[52:55], v[176:191]
    ds_read_b128 v[28:31], v10 offset:6144
    s_waitcnt vmcnt(4)
    s_barrier
    s_waitcnt lgkmcnt(3)
    v_mfma_f32_32x32x16_bf16 v[64:79], v[32:35], v[16:19], v[64:79]
    ds_read_b64_tr_b16 v[56:57], v12 offset:4096
    v_mfma_f32_32x32x16_bf16 v[80:95], v[36:39], v[16:19], v[80:95]
    ds_read_b64_tr_b16 v[58:59], v12 offset:5120
    s_add_u32 m0, s56, 49152
    s_add_u32 s68, s54, 960
    buffer_load_dwordx4 v2, s[24:27], s68 offen lds
    s_waitcnt lgkmcnt(4)
    v_mfma_f32_32x32x16_bf16 v[96:111], v[32:35], v[20:23], v[96:111]
    ds_read_b64_tr_b16 v[60:61], v13 offset:4096
    v_mfma_f32_32x32x16_bf16 v[112:127], v[36:39], v[20:23], v[112:127]
    ds_read_b64_tr_b16 v[62:63], v13 offset:5120
    s_waitcnt lgkmcnt(5)
    v_mfma_f32_32x32x16_bf16 v[128:143], v[32:35], v[24:27], v[128:143]
    ds_read_b128 v[40:43], v11 offset:0
    v_mfma_f32_32x32x16_bf16 v[144:159], v[36:39], v[24:27], v[144:159]
    ds_read_b128 v[44:47], v11 offset:2048
    buffer_load_dwordx4 v3, s[24:27], s68 offen offset:1024 lds
    s_waitcnt lgkmcnt(6)
    v_mfma_f32_32x32x16_bf16 v[160:175], v[32:35], v[28:31], v[160:175]
    ds_read_b128 v[48:51], v11 offset:4096
    v_mfma_f32_32x32x16_bf16 v[176:191], v[36:39], v[28:31], v[176:191]
    ds_read_b128 v[52:55], v11 offset:6144
    s_waitcnt lgkmcnt(3)
    v_mfma_f32_32x32x16_bf16 v[64:79], v[56:59], v[40:43], v[64:79]
    ds_read_b64_tr_b16 v[32:33], v12 offset:16384
    v_mfma_f32_32x32x16_bf16 v[80:95], v[60:63], v[40:43], v[80:95]
    ds_read_b64_tr_b16 v[34:35], v12 offset:17408
    s_add_u32 m0, s56, 51200
    s_add_u32 s68, s54, 33728
    buffer_load_dwordx4 v2, s[24:27], s68 offen lds
    s_waitcnt lgkmcnt(4)
    v_mfma_f32_32x32x16_bf16 v[96:111], v[56:59], v[44:47], v[96:111]
    ds_read_b64_tr_b16 v[36:37], v13 offset:16384
    v_mfma_f32_32x32x16_bf16 v[112:127], v[60:63], v[44:47], v[112:127]
    ds_read_b64_tr_b16 v[38:39], v13 offset:17408
    s_waitcnt lgkmcnt(5)
    v_mfma_f32_32x32x16_bf16 v[128:143], v[56:59], v[48:51], v[128:143]
    ds_read_b128 v[16:19], v10 offset:16384
    v_mfma_f32_32x32x16_bf16 v[144:159], v[60:63], v[48:51], v[144:159]
    ds_read_b128 v[20:23], v10 offset:18432
    buffer_load_dwordx4 v3, s[24:27], s68 offen offset:1024 lds
    s_waitcnt lgkmcnt(6)
    v_mfma_f32_32x32x16_bf16 v[160:175], v[56:59], v[52:55], v[160:175]
    ds_read_b128 v[24:27], v10 offset:20480
    v_mfma_f32_32x32x16_bf16 v[176:191], v[60:63], v[52:55], v[176:191]
    ds_read_b128 v[28:31], v10 offset:22528
    s_waitcnt vmcnt(4)
    s_barrier
    s_lshl_b32 s70, s42, 3
    s_add_u32 s70, s70, s40
    s_lshl_b32 s71, s70, 16
    s_lshl_b32 s72, s41, 8
    s_add_u32 s71, s71, s72
    s_mul_i32 s70, s70, 28672
    s_lshl_b32 s72, s51, 8
    s_add_u32 s70, s70, s72
    v_bfe_u32 v6, v0, 1, 3
    v_and_b32 v7, 1, v0
    v_lshlrev_b32 v7, 7, v7
    v_mul_u32_u24 v8, 3584, v6
    v_add_u32 v8, v8, v7
    v_lshlrev_b32 v6, 13, v6
    v_add_u32 v6, v6, v7
    s_mov_b64 exec, 0xffff
    buffer_load_dword v9, v6, s[20:23], s71 offen
    buffer_load_dword v9, v8, s[12:15], s70 offen
    buffer_load_dword v9, v8, s[16:19], s70 offen
    s_mov_b64 exec, -1

    s_waitcnt lgkmcnt(3)
    v_mfma_f32_32x32x16_bf16 v[64:79], v[32:35], v[16:19], v[64:79]
    ds_read_b64_tr_b16 v[56:57], v12 offset:20480
    v_mfma_f32_32x32x16_bf16 v[80:95], v[36:39], v[16:19], v[80:95]
    ds_read_b64_tr_b16 v[58:59], v12 offset:21504
    s_waitcnt lgkmcnt(4)
    v_mfma_f32_32x32x16_bf16 v[96:111], v[32:35], v[20:23], v[96:111]
    ds_read_b64_tr_b16 v[60:61], v13 offset:20480
    v_mfma_f32_32x32x16_bf16 v[112:127], v[36:39], v[20:23], v[112:127]
    ds_read_b64_tr_b16 v[62:63], v13 offset:21504
    s_waitcnt lgkmcnt(5)
    v_mfma_f32_32x32x16_bf16 v[128:143], v[32:35], v[24:27], v[128:143]
    ds_read_b128 v[40:43], v11 offset:16384
    v_mfma_f32_32x32x16_bf16 v[144:159], v[36:39], v[24:27], v[144:159]
    ds_read_b128 v[44:47], v11 offset:18432
    s_waitcnt lgkmcnt(6)
    v_mfma_f32_32x32x16_bf16 v[160:175], v[32:35], v[28:31], v[160:175]
    ds_read_b128 v[48:51], v11 offset:20480
    v_mfma_f32_32x32x16_bf16 v[176:191], v[36:39], v[28:31], v[176:191]
    ds_read_b128 v[52:55], v11 offset:22528
    s_waitcnt lgkmcnt(3)
    v_mfma_f32_32x32x16_bf16 v[64:79], v[56:59], v[40:43], v[64:79]
    ds_read_b64_tr_b16 v[32:33], v12 offset:32768
    v_mfma_f32_32x32x16_bf16 v[80:95], v[60:63], v[40:43], v[80:95]
    ds_read_b64_tr_b16 v[34:35], v12 offset:33792
    s_waitcnt lgkmcnt(4)
    v_mfma_f32_32x32x16_bf16 v[96:111], v[56:59], v[44:47], v[96:111]
    ds_read_b64_tr_b16 v[36:37], v13 offset:32768
    v_mfma_f32_32x32x16_bf16 v[112:127], v[60:63], v[44:47], v[112:127]
    ds_read_b64_tr_b16 v[38:39], v13 offset:33792
    s_waitcnt lgkmcnt(5)
    v_mfma_f32_32x32x16_bf16 v[128:143], v[56:59], v[48:51], v[128:143]
    ds_read_b128 v[16:19], v10 offset:32768
    v_mfma_f32_32x32x16_bf16 v[144:159], v[60:63], v[48:51], v[144:159]
    ds_read_b128 v[20:23], v10 offset:34816
    s_waitcnt lgkmcnt(6)
    v_mfma_f32_32x32x16_bf16 v[160:175], v[56:59], v[52:55], v[160:175]
    ds_read_b128 v[24:27], v10 offset:36864
    v_mfma_f32_32x32x16_bf16 v[176:191], v[60:63], v[52:55], v[176:191]
    ds_read_b128 v[28:31], v10 offset:38912
    s_waitcnt vmcnt(0)
    s_barrier
    s_cmp_lg_u32 s40, 0
    s_cbranch_scc1 stl_10
    buffer_load_dword v199, v244, s[76:79], 0 offen sc1
stl_10:
    s_waitcnt lgkmcnt(3)
    v_mfma_f32_32x32x16_bf16 v[64:79], v[32:35], v[16:19], v[64:79]
    ds_read_b64_tr_b16 v[56:57], v12 offset:36864
    v_mfma_f32_32x32x16_bf16 v[80:95], v[36:39], v[16:19], v[80:95]
    ds_read_b64_tr_b16 v[58:59], v12 offset:37888
    s_waitcnt lgkmcnt(4)
    v_mfma_f32_32x32x16_bf16 v[96:111], v[32:35], v[20:23], v[96:111]
    ds_read_b64_tr_b16 v[60:61], v13 offset:36864
    v_mfma_f32_32x32x16_bf16 v[112:127], v[36:39], v[20:23], v[112:127]
    ds_read_b64_tr_b16 v[62:63], v13 offset:37888
    s_waitcnt lgkmcnt(5)
    v_mfma_f32_32x32x16_bf16 v[128:143], v[32:35], v[24:27], v[128:143]
    ds_read_b128 v[40:43], v11 offset:32768
    v_mfma_f32_32x32x16_bf16 v[144:159], v[36:39], v[24:27], v[144:159]
    ds_read_b128 v[44:47], v11 offset:34816
    s_waitcnt lgkmcnt(6)
    v_mfma_f32_32x32x16_bf16 v[160:175], v[32:35], v[28:31], v[160:175]
    ds_read_b128 v[48:51], v11 offset:36864
    v_mfma_f32_32x32x16_bf16 v[176:191], v[36:39], v[28:31], v[176:191]
    ds_read_b128 v[52:55], v11 offset:38912
    s_waitcnt lgkmcnt(3)
    v_mfma_f32_32x32x16_bf16 v[64:79], v[56:59], v[40:43], v[64:79]
    ds_read_b64_tr_b16 v[32:33], v12 offset:49152
    v_mfma_f32_32x32x16_bf16 v[80:95], v[60:63], v[40:43], v[80:95]
    ds_read_b64_tr_b16 v[34:35], v12 offset:50176
    s_waitcnt lgkmcnt(4)
    v_mfma_f32_32x32x16_bf16 v[96:111], v[56:59], v[44:47], v[96:111]
    ds_read_b64_tr_b16 v[36:37], v13 offset:49152
    v_mfma_f32_32x32x16_bf16 v[112:127], v[60:63], v[44:47], v[112:127]
    ds_read_b64_tr_b16 v[38:39], v13 offset:50176
    s_waitcnt lgkmcnt(5)
    v_mfma_f32_32x32x16_bf16 v[128:143], v[56:59], v[48:51], v[128:143]
    ds_read_b128 v[16:19], v10 offset:49152
    v_mfma_f32_32x32x16_bf16 v[144:159], v[60:63], v[48:51], v[144:159]
    ds_read_b128 v[20:23], v10 offset:51200
    s_waitcnt lgkmcnt(6)
    v_mfma_f32_32x32x16_bf16 v[160:175], v[56:59], v[52:55], v[160:175]
    ds_read_b128 v[24:27], v10 offset:53248
    v_mfma_f32_32x32x16_bf16 v[176:191], v[60:63], v[52:55], v[176:191]
    ds_read_b128 v[28:31], v10 offset:55296
    s_waitcnt lgkmcnt(3)
    v_mfma_f32_32x32x16_bf16 v[64:79], v[32:35], v[16:19], v[64:79]
    ds_read_b64_tr_b16 v[56:57], v12 offset:53248
    v_mfma_f32_32x32x16_bf16 v[80:95], v[36:39], v[16:19], v[80:95]
    ds_read_b64_tr_b16 v[58:59], v12 offset:54272
    s_waitcnt lgkmcnt(4)
    v_mfma_f32_32x32x16_bf16 v[96:111], v[32:35], v[20:23], v[96:111]
    ds_read_b64_tr_b16 v[60:61], v13 offset:53248
    v_mfma_f32_32x32x16_bf16 v[112:127], v[36:39], v[20:23], v[112:127]
    ds_read_b64_tr_b16 v[62:63], v13 offset:54272
    s_waitcnt lgkmcnt(5)
    v_mfma_f32_32x32x16_bf16 v[128:143], v[32:35], v[24:27], v[128:143]
    ds_read_b128 v[40:43], v11 offset:49152
    v_mfma_f32_32x32x16_bf16 v[144:159], v[36:39], v[24:27], v[144:159]
    ds_read_b128 v[44:47], v11 offset:51200
    s_waitcnt lgkmcnt(6)
    v_mfma_f32_32x32x16_bf16 v[160:175], v[32:35], v[28:31], v[160:175]
    ds_read_b128 v[48:51], v11 offset:53248
    v_mfma_f32_32x32x16_bf16 v[176:191], v[36:39], v[28:31], v[176:191]
    ds_read_b128 v[52:55], v11 offset:55296
    s_waitcnt lgkmcnt(3)
    v_mfma_f32_32x32x16_bf16 v[64:79], v[56:59], v[40:43], v[64:79]
    v_mfma_f32_32x32x16_bf16 v[80:95], v[60:63], v[40:43], v[80:95]
    s_waitcnt lgkmcnt(2)
    v_mfma_f32_32x32x16_bf16 v[96:111], v[56:59], v[44:47], v[96:111]
    v_mfma_f32_32x32x16_bf16 v[112:127], v[60:63], v[44:47], v[112:127]
    s_waitcnt lgkmcnt(1)
    v_mfma_f32_32x32x16_bf16 v[128:143], v[56:59], v[48:51], v[128:143]
    v_mfma_f32_32x32x16_bf16 v[144:159], v[60:63], v[48:51], v[144:159]
    s_waitcnt lgkmcnt(0)
    v_mfma_f32_32x32x16_bf16 v[160:175], v[56:59], v[52:55], v[160:175]
    v_mfma_f32_32x32x16_bf16 v[176:191], v[60:63], v[52:55], v[176:191]
    s_branch p1_epi_8
p1_v_7:
    s_waitcnt vmcnt(9)
    s_barrier
    ds_read_b64_tr_b16 v[32:33], v12 offset:0
    ds_read_b64_tr_b16 v[34:35], v12 offset:1024
    ds_read_b64_tr_b16 v[36:37], v13 offset:0
    ds_read_b64_tr_b16 v[38:39], v13 offset:1024
    ds_read_b128 v[16:19], v10 offset:0
    ds_read_b128 v[20:23], v10 offset:2048
    ds_read_b128 v[24:27], v10 offset:4096
    ds_read_b128 v[28:31], v10 offset:6144
    s_waitcnt lgkmcnt(3)
    v_mfma_f32_32x32x16_bf16 v[64:79], v[16:19], v[32:35], 0
    ds_read_b64_tr_b16 v[56:57], v12 offset:4096
    v_mfma_f32_32x32x16_bf16 v[80:95], v[16:19], v[36:39], 0
    ds_read_b64_tr_b16 v[58:59], v12 offset:5120
    s_add_u32 m0, s57, 49152
    s_add_u32 s69, s55, 786432
    buffer_load_dwordx4 v4, s[28:31], s69 offen lds
    s_waitcnt lgkmcnt(4)
    v_mfma_f32_32x32x16_bf16 v[96:111], v[20:23], v[32:35], 0
    ds_read_b64_tr_b16 v[60:61], v13 offset:4096
    v_mfma_f32_32x32x16_bf16 v[112:127], v[20:23], v[36:39], 0
    ds_read_b64_tr_b16 v[62:63], v13 offset:5120
    s_waitcnt lgkmcnt(5)
    v_mfma_f32_32x32x16_bf16 v[128:143], v[24:27], v[32:35], 0
    ds_read_b128 v[40:43], v11 offset:0
    v_mfma_f32_32x32x16_bf16 v[144:159], v[24:27], v[36:39], 0
    ds_read_b128 v[44:47], v11 offset:2048
    buffer_load_dwordx4 v5, s[28:31], s69 offen offset:1024 lds
    s_waitcnt lgkmcnt(6)
    v_mfma_f32_32x32x16_bf16 v[160:175], v[28:31], v[32:35], 0
    ds_read_b128 v[48:51], v11 offset:4096
    v_mfma_f32_32x32x16_bf16 v[176:191], v[28:31], v[36:39], 0
    ds_read_b128 v[52:55], v11 offset:6144
    s_waitcnt lgkmcnt(3)
    v_mfma_f32_32x32x16_bf16 v[64:79], v[40:43], v[56:59], v[64:79]
    ds_read_b64_tr_b16 v[32:33], v12 offset:16384
    v_mfma_f32_32x32x16_bf16 v[80:95], v[40:43], v[60:63], v[80:95]
    ds_read_b64_tr_b16 v[34:35], v12 offset:17408
    s_add_u32 m0, s57, 51200
    s_add_u32 s69, s55, 851968
    buffer_load_dwordx4 v4, s[28:31], s69 offen lds
    s_waitcnt lgkmcnt(4)
    v_mfma_f32_32x32x16_bf16 v[96:111], v[44:47], v[56:59], v[96:111]
    ds_read_b64_tr_b16 v[36:37], v13 offset:16384
    v_mfma_f32_32x32x16_bf16 v[112:127], v[44:47], v[60:63], v[112:127]
    ds_read_b64_tr_b16 v[38:39], v13 offset:17408
    s_waitcnt lgkmcnt(5)
    v_mfma_f32_32x32x16_bf16 v[128:143], v[48:51], v[56:59], v[128:143]
    ds_read_b128 v[16:19], v10 offset:16384
    v_mfma_f32_32x32x16_bf16 v[144:159], v[48:51], v[60:63], v[144:159]
    ds_read_b128 v[20:23], v10 offset:18432
    buffer_load_dwordx4 v5, s[28:31], s69 offen offset:1024 lds
    s_waitcnt lgkmcnt(6)
    v_mfma_f32_32x32x16_bf16 v[160:175], v[52:55], v[56:59], v[160:175]
    ds_read_b128 v[24:27], v10 offset:20480
    v_mfma_f32_32x32x16_bf16 v[176:191], v[52:55], v[60:63], v[176:191]
    ds_read_b128 v[28:31], v10 offset:22528
    s_waitcnt vmcnt(9)
    s_barrier
    s_waitcnt lgkmcnt(3)
    v_mfma_f32_32x32x16_bf16 v[64:79], v[16:19], v[32:35], v[64:79]
    ds_read_b64_tr_b16 v[56:57], v12 offset:20480
    v_mfma_f32_32x32x16_bf16 v[80:95], v[16:19], v[36:39], v[80:95]
    ds_read_b64_tr_b16 v[58:59], v12 offset:21504
    s_add_u32 m0, s57, 0
    s_add_u32 s69, s55, 1048576
    buffer_load_dwordx4 v4, s[28:31], s69 offen lds
    s_waitcnt lgkmcnt(4)
    v_mfma_f32_32x32x16_bf16 v[96:111], v[20:23], v[32:35], v[96:111]
    ds_read_b64_tr_b16 v[60:61], v13 offset:20480
    v_mfma_f32_32x32x16_bf16 v[112:127], v[20:23], v[36:39], v[112:127]
    ds_read_b64_tr_b16 v[62:63], v13 offset:21504
    s_waitcnt lgkmcnt(5)
    v_mfma_f32_32x32x16_bf16 v[128:143], v[24:27], v[32:35], v[128:143]
    ds_read_b128 v[40:43], v11 offset:16384
    v_mfma_f32_32x32x16_bf16 v[144:159], v[24:27], v[36:39], v[144:159]
    ds_read_b128 v[44:47], v11 offset:18432
    buffer_load_dwordx4 v5, s[28:31], s69 offen offset:1024 lds
    s_waitcnt lgkmcnt(6)
    v_mfma_f32_32x32x16_bf16 v[160:175], v[28:31], v[32:35], v[160:175]
    ds_read_b128 v[48:51], v11 offset:20480
    v_mfma_f32_32x32x16_bf16 v[176:191], v[28:31], v[36:39], v[176:191]
    ds_read_b128 v[52:55], v11 offset:22528
    s_waitcnt lgkmcnt(3)
    v_mfma_f32_32x32x16_bf16 v[64:79], v[40:43], v[56:59], v[64:79]
    ds_read_b64_tr_b16 v[32:33], v12 offset:32768
    v_mfma_f32_32x32x16_bf16 v[80:95], v[40:43], v[60:63], v[80:95]
    ds_read_b64_tr_b16 v[34:35], v12 offset:33792
    s_add_u32 m0, s57, 2048
    s_add_u32 s69, s55, 1114112
    buffer_load_dwordx4 v4, s[28:31], s69 offen lds
    s_waitcnt lgkmcnt(4)
    v_mfma_f32_32x32x16_bf16 v[96:111], v[44:47], v[56:59], v[96:111]
    ds_read_b64_tr_b16 v[36:37], v13 offset:32768
    v_mfma_f32_32x32x16_bf16 v[112:127], v[44:47], v[60:63], v[112:127]
    ds_read_b64_tr_b16 v[38:39], v13 offset:33792
    s_waitcnt lgkmcnt(5)
    v_mfma_f32_32x32x16_bf16 v[128:143], v[48:51], v[56:59], v[128:143]
    ds_read_b128 v[16:19], v10 offset:32768
    v_mfma_f32_32x32x16_bf16 v[144:159], v[48:51], v[60:63], v[144:159]
    ds_read_b128 v[20:23], v10 offset:34816
    buffer_load_dwordx4 v5, s[28:31], s69 offen offset:1024 lds
    s_waitcnt lgkmcnt(6)
    v_mfma_f32_32x32x16_bf16 v[160:175], v[52:55], v[56:59], v[160:175]
    ds_read_b128 v[24:27], v10 offset:36864
    v_mfma_f32_32x32x16_bf16 v[176:191], v[52:55], v[60:63], v[176:191]
    ds_read_b128 v[28:31], v10 offset:38912
    s_waitcnt vmcnt(4)
    s_barrier
    s_waitcnt lgkmcnt(3)
    v_mfma_f32_32x32x16_bf16 v[64:79], v[16:19], v[32:35], v[64:79]
    ds_read_b64_tr_b16 v[56:57], v12 offset:36864
    v_mfma_f32_32x32x16_bf16 v[80:95], v[16:19], v[36:39], v[80:95]
    ds_read_b64_tr_b16 v[58:59], v12 offset:37888
    s_add_u32 m0, s57, 16384
    s_add_u32 s69, s55, 1310720
    buffer_load_dwordx4 v4, s[28:31], s69 offen lds
    s_waitcnt lgkmcnt(4)
    v_mfma_f32_32x32x16_bf16 v[96:111], v[20:23], v[32:35], v[96:111]
    ds_read_b64_tr_b16 v[60:61], v13 offset:36864
    v_mfma_f32_32x32x16_bf16 v[112:127], v[20:23], v[36:39], v[112:127]
    ds_read_b64_tr_b16 v[62:63], v13 offset:37888
    s_waitcnt lgkmcnt(5)
    v_mfma_f32_32x32x16_bf16 v[128:143], v[24:27], v[32:35], v[128:143]
    ds_read_b128 v[40:43], v11 offset:32768
    v_mfma_f32_32x32x16_bf16 v[144:159], v[24:27], v[36:39], v[144:159]
    ds_read_b128 v[44:47], v11 offset:34816
    buffer_load_dwordx4 v5, s[28:31], s69 offen offset:1024 lds
    s_waitcnt lgkmcnt(6)
    v_mfma_f32_32x32x16_bf16 v[160:175], v[28:31], v[32:35], v[160:175]
    ds_read_b128 v[48:51], v11 offset:36864
    v_mfma_f32_32x32x16_bf16 v[176:191], v[28:31], v[36:39], v[176:191]
    ds_read_b128 v[52:55], v11 offset:38912
    s_waitcnt lgkmcnt(3)
    v_mfma_f32_32x32x16_bf16 v[64:79], v[40:43], v[56:59], v[64:79]
    ds_read_b64_tr_b16 v[32:33], v12 offset:49152
    v_mfma_f32_32x32x16_bf16 v[80:95], v[40:43], v[60:63], v[80:95]
    ds_read_b64_tr_b16 v[34:35], v12 offset:50176
    s_add_u32 m0, s57, 18432
    s_add_u32 s69, s55, 1376256
    buffer_load_dwordx4 v4, s[28:31], s69 offen lds
    s_waitcnt lgkmcnt(4)
    v_mfma_f32_32x32x16_bf16 v[96:111], v[44:47], v[56:59], v[96:111]
    ds_read_b64_tr_b16 v[36:37], v13 offset:49152
    v_mfma_f32_32x32x16_bf16 v[112:127], v[44:47], v[60:63], v[112:127]
    ds_read_b64_tr_b16 v[38:39], v13 offset:50176
    s_waitcnt lgkmcnt(5)
    v_mfma_f32_32x32x16_bf16 v[128:143], v[48:51], v[56:59], v[128:143]
    ds_read_b128 v[16:19], v10 offset:49152
    v_mfma_f32_32x32x16_bf16 v[144:159], v[48:51], v[60:63], v[144:159]
    ds_read_b128 v[20:23], v10 offset:51200
    buffer_load_dwordx4 v5, s[28:31], s69 offen offset:1024 lds
    s_waitcnt lgkmcnt(6)
    v_mfma_f32_32x32x16_bf16 v[160:175], v[52:55], v[56:59], v[160:175]
    ds_read_b128 v[24:27], v10 offset:53248
    v_mfma_f32_32x32x16_bf16 v[176:191], v[52:55], v[60:63], v[176:191]
    ds_read_b128 v[28:31], v10 offset:55296
    s_waitcnt vmcnt(4)
    s_barrier
    s_waitcnt lgkmcnt(3)
    v_mfma_f32_32x32x16_bf16 v[64:79], v[16:19], v[32:35], v[64:79]
    ds_read_b64_tr_b16 v[56:57], v12 offset:53248
    v_mfma_f32_32x32x16_bf16 v[80:95], v[16:19], v[36:39], v[80:95]
    ds_read_b64_tr_b16 v[58:59], v12 offset:54272
    s_add_u32 m0, s57, 32768
    s_add_u32 s69, s55, 1572864
    buffer_load_dwordx4 v4, s[28:31], s69 offen lds
    s_waitcnt lgkmcnt(4)
    v_mfma_f32_32x32x16_bf16 v[96:111], v[20:23], v[32:35], v[96:111]
    ds_read_b64_tr_b16 v[60:61], v13 offset:53248
    v_mfma_f32_32x32x16_bf16 v[112:127], v[20:23], v[36:39], v[112:127]
    ds_read_b64_tr_b16 v[62:63], v13 offset:54272
    s_waitcnt lgkmcnt(5)
    v_mfma_f32_32x32x16_bf16 v[128:143], v[24:27], v[32:35], v[128:143]
    ds_read_b128 v[40:43], v11 offset:49152
    v_mfma_f32_32x32x16_bf16 v[144:159], v[24:27], v[36:39], v[144:159]
    ds_read_b128 v[44:47], v11 offset:51200
    buffer_load_dwordx4 v5, s[28:31], s69 offen offset:1024 lds
    s_waitcnt lgkmcnt(6)
    v_mfma_f32_32x32x16_bf16 v[160:175], v[28:31], v[32:35], v[160:175]
    ds_read_b128 v[48:51], v11 offset:53248
    v_mfma_f32_32x32x16_bf16 v[176:191], v[28:31], v[36:39], v[176:191]
    ds_read_b128 v[52:55], v11 offset:55296
    s_waitcnt lgkmcnt(3)
    v_mfma_f32_32x32x16_bf16 v[64:79], v[40:43], v[56:59], v[64:79]
    ds_read_b64_tr_b16 v[32:33], v12 offset:0
    v_mfma_f32_32x32x16_bf16 v[80:95], v[40:43], v[60:63], v[80:95]
    ds_read_b64_tr_b16 v[34:35], v12 offset:1024
    s_add_u32 m0, s57, 34816
    s_add_u32 s69, s55, 1638400
    buffer_load_dwordx4 v4, s[28:31], s69 offen lds
    s_waitcnt lgkmcnt(4)
    v_mfma_f32_32x32x16_bf16 v[96:111], v[44:47], v[56:59], v[96:111]
    ds_read_b64_tr_b16 v[36:37], v13 offset:0
    v_mfma_f32_32x32x16_bf16 v[112:127], v[44:47], v[60:63], v[112:127]
    ds_read_b64_tr_b16 v[38:39], v13 offset:1024
    s_waitcnt lgkmcnt(5)
    v_mfma_f32_32x32x16_bf16 v[128:143], v[48:51], v[56:59], v[128:143]
    ds_read_b128 v[16:19], v10 offset:0
    v_mfma_f32_32x32x16_bf16 v[144:159], v[48:51], v[60:63], v[144:159]
    ds_read_b128 v[20:23], v10 offset:2048
    buffer_load_dwordx4 v5, s[28:31], s69 offen offset:1024 lds
    s_waitcnt lgkmcnt(6)
    v_mfma_f32_32x32x16_bf16 v[160:175], v[52:55], v[56:59], v[160:175]
    ds_read_b128 v[24:27], v10 offset:4096
    v_mfma_f32_32x32x16_bf16 v[176:191], v[52:55], v[60:63], v[176:191]
    ds_read_b128 v[28:31], v10 offset:6144
    s_waitcnt vmcnt(4)
    s_barrier
    s_waitcnt lgkmcnt(3)
    v_mfma_f32_32x32x16_bf16 v[64:79], v[16:19], v[32:35], v[64:79]
    ds_read_b64_tr_b16 v[56:57], v12 offset:4096
    v_mfma_f32_32x32x16_bf16 v[80:95], v[16:19], v[36:39], v[80:95]
    ds_read_b64_tr_b16 v[58:59], v12 offset:5120
    s_add_u32 m0, s57, 49152
    s_add_u32 s69, s55, 1835008
    buffer_load_dwordx4 v4, s[28:31], s69 offen lds
    s_waitcnt lgkmcnt(4)
    v_mfma_f32_32x32x16_bf16 v[96:111], v[20:23], v[32:35], v[96:111]
    ds_read_b64_tr_b16 v[60:61], v13 offset:4096
    v_mfma_f32_32x32x16_bf16 v[112:127], v[20:23], v[36:39], v[112:127]
    ds_read_b64_tr_b16 v[62:63], v13 offset:5120
    s_waitcnt lgkmcnt(5)
    v_mfma_f32_32x32x16_bf16 v[128:143], v[24:27], v[32:35], v[128:143]
    ds_read_b128 v[40:43], v11 offset:0
    v_mfma_f32_32x32x16_bf16 v[144:159], v[24:27], v[36:39], v[144:159]
    ds_read_b128 v[44:47], v11 offset:2048
    buffer_load_dwordx4 v5, s[28:31], s69 offen offset:1024 lds
    s_waitcnt lgkmcnt(6)
    v_mfma_f32_32x32x16_bf16 v[160:175], v[28:31], v[32:35], v[160:175]
    ds_read_b128 v[48:51], v11 offset:4096
    v_mfma_f32_32x32x16_bf16 v[176:191], v[28:31], v[36:39], v[176:191]
    ds_read_b128 v[52:55], v11 offset:6144
    s_waitcnt lgkmcnt(3)
    v_mfma_f32_32x32x16_bf16 v[64:79], v[40:43], v[56:59], v[64:79]
    ds_read_b64_tr_b16 v[32:33], v12 offset:16384
    v_mfma_f32_32x32x16_bf16 v[80:95], v[40:43], v[60:63], v[80:95]
    ds_read_b64_tr_b16 v[34:35], v12 offset:17408
    s_add_u32 m0, s57, 51200
    s_add_u32 s69, s55, 1900544
    buffer_load_dwordx4 v4, s[28:31], s69 offen lds
    s_waitcnt lgkmcnt(4)
    v_mfma_f32_32x32x16_bf16 v[96:111], v[44:47], v[56:59], v[96:111]
    ds_read_b64_tr_b16 v[36:37], v13 offset:16384
    v_mfma_f32_32x32x16_bf16 v[112:127], v[44:47], v[60:63], v[112:127]
    ds_read_b64_tr_b16 v[38:39], v13 offset:17408
    s_waitcnt lgkmcnt(5)
    v_mfma_f32_32x32x16_bf16 v[128:143], v[48:51], v[56:59], v[128:143]
    ds_read_b128 v[16:19], v10 offset:16384
    v_mfma_f32_32x32x16_bf16 v[144:159], v[48:51], v[60:63], v[144:159]
    ds_read_b128 v[20:23], v10 offset:18432
    buffer_load_dwordx4 v5, s[28:31], s69 offen offset:1024 lds
    s_waitcnt lgkmcnt(6)
    v_mfma_f32_32x32x16_bf16 v[160:175], v[52:55], v[56:59], v[160:175]
    ds_read_b128 v[24:27], v10 offset:20480
    v_mfma_f32_32x32x16_bf16 v[176:191], v[52:55], v[60:63], v[176:191]
    ds_read_b128 v[28:31], v10 offset:22528
    s_waitcnt vmcnt(4)
    s_barrier
    s_waitcnt lgkmcnt(3)
    v_mfma_f32_32x32x16_bf16 v[64:79], v[16:19], v[32:35], v[64:79]
    ds_read_b64_tr_b16 v[56:57], v12 offset:20480
    v_mfma_f32_32x32x16_bf16 v[80:95], v[16:19], v[36:39], v[80:95]
    ds_read_b64_tr_b16 v[58:59], v12 offset:21504
    s_add_u32 m0, s57, 0
    s_add_u32 s69, s55, 2097152
    buffer_load_dwordx4 v4, s[28:31], s69 offen lds
    s_waitcnt lgkmcnt(4)
    v_mfma_f32_32x32x16_bf16 v[96:111], v[20:23], v[32:35], v[96:111]
    ds_read_b64_tr_b16 v[60:61], v13 offset:20480
    v_mfma_f32_32x32x16_bf16 v[112:127], v[20:23], v[36:39], v[112:127]
    ds_read_b64_tr_b16 v[62:63], v13 offset:21504
    s_waitcnt lgkmcnt(5)
    v_mfma_f32_32x32x16_bf16 v[128:143], v[24:27], v[32:35], v[128:143]
    ds_read_b128 v[40:43], v11 offset:16384
    v_mfma_f32_32x32x16_bf16 v[144:159], v[24:27], v[36:39], v[144:159]
    ds_read_b128 v[44:47], v11 offset:18432
    buffer_load_dwordx4 v5, s[28:31], s69 offen offset:1024 lds
    s_waitcnt lgkmcnt(6)
    v_mfma_f32_32x32x16_bf16 v[160:175], v[28:31], v[32:35], v[160:175]
    ds_read_b128 v[48:51], v11 offset:20480
    v_mfma_f32_32x32x16_bf16 v[176:191], v[28:31], v[36:39], v[176:191]
    ds_read_b128 v[52:55], v11 offset:22528
    s_waitcnt lgkmcnt(3)
    v_mfma_f32_32x32x16_bf16 v[64:79], v[40:43], v[56:59], v[64:79]
    ds_read_b64_tr_b16 v[32:33], v12 offset:32768
    v_mfma_f32_32x32x16_bf16 v[80:95], v[40:43], v[60:63], v[80:95]
    ds_read_b64_tr_b16 v[34:35], v12 offset:33792
    s_add_u32 m0, s57, 2048
    s_add_u32 s69, s55, 2162688
    buffer_load_dwordx4 v4, s[28:31], s69 offen lds
    s_waitcnt lgkmcnt(4)
    v_mfma_f32_32x32x16_bf16 v[96:111], v[44:47], v[56:59], v[96:111]
    ds_read_b64_tr_b16 v[36:37], v13 offset:32768
    v_mfma_f32_32x32x16_bf16 v[112:127], v[44:47], v[60:63], v[112:127]
    ds_read_b64_tr_b16 v[38:39], v13 offset:33792
    s_waitcnt lgkmcnt(5)
    v_mfma_f32_32x32x16_bf16 v[128:143], v[48:51], v[56:59], v[128:143]
    ds_read_b128 v[16:19], v10 offset:32768
    v_mfma_f32_32x32x16_bf16 v[144:159], v[48:51], v[60:63], v[144:159]
    ds_read_b128 v[20:23], v10 offset:34816
    buffer_load_dwordx4 v5, s[28:31], s69 offen offset:1024 lds
    s_waitcnt lgkmcnt(6)
    v_mfma_f32_32x32x16_bf16 v[160:175], v[52:55], v[56:59], v[160:175]
    ds_read_b128 v[24:27], v10 offset:36864
    v_mfma_f32_32x32x16_bf16 v[176:191], v[52:55], v[60:63], v[176:191]
    ds_read_b128 v[28:31], v10 offset:38912
    s_waitcnt vmcnt(4)
    s_barrier
    s_mov_b64 exec, 0xffff
    buffer_load_dword v9, v8, s[20:23], s60 offen
    s_mov_b64 exec, 0x7f
    buffer_load_dword v9, v8, s[12:15], s61 offen
    buffer_load_dword v9, v8, s[16:19], s61 offen
    s_mov_b64 exec, -1
    s_waitcnt lgkmcnt(3)
    v_mfma_f32_32x32x16_bf16 v[64:79], v[16:19], v[32:35], v[64:79]
    ds_read_b64_tr_b16 v[56:57], v12 offset:36864
    v_mfma_f32_32x32x16_bf16 v[80:95], v[16:19], v[36:39], v[80:95]
    ds_read_b64_tr_b16 v[58:59], v12 offset:37888
    s_add_u32 m0, s57, 16384
    s_add_u32 s69, s55, 2359296
    buffer_load_dwordx4 v4, s[28:31], s69 offen lds
    s_waitcnt lgkmcnt(4)
    v_mfma_f32_32x32x16_bf16 v[96:111], v[20:23], v[32:35], v[96:111]
    ds_read_b64_tr_b16 v[60:61], v13 offset:36864
    v_mfma_f32_32x32x16_bf16 v[112:127], v[20:23], v[36:39], v[112:127]
    ds_read_b64_tr_b16 v[62:63], v13 offset:37888
    s_waitcnt lgkmcnt(5)
    v_mfma_f32_32x32x16_bf16 v[128:143], v[24:27], v[32:35], v[128:143]
    ds_read_b128 v[40:43], v11 offset:32768
    v_mfma_f32_32x32x16_bf16 v[144:159], v[24:27], v[36:39], v[144:159]
    ds_read_b128 v[44:47], v11 offset:34816
    buffer_load_dwordx4 v5, s[28:31], s69 offen offset:1024 lds
    s_waitcnt lgkmcnt(6)
    v_mfma_f32_32x32x16_bf16 v[160:175], v[28:31], v[32:35], v[160:175]
    ds_read_b128 v[48:51], v11 offset:36864
    v_mfma_f32_32x32x16_bf16 v[176:191], v[28:31], v[36:39], v[176:191]
    ds_read_b128 v[52:55], v11 offset:38912
    s_waitcnt lgkmcnt(3)
    v_mfma_f32_32x32x16_bf16 v[64:79], v[40:43], v[56:59], v[64:79]
    ds_read_b64_tr_b16 v[32:33], v12 offset:49152
    v_mfma_f32_32x32x16_bf16 v[80:95], v[40:43], v[60:63], v[80:95]
    ds_read_b64_tr_b16 v[34:35], v12 offset:50176
    s_add_u32 m0, s57, 18432
    s_add_u32 s69, s55, 2424832
    buffer_load_dwordx4 v4, s[28:31], s69 offen lds
    s_waitcnt lgkmcnt(4)
    v_mfma_f32_32x32x16_bf16 v[96:111], v[44:47], v[56:59], v[96:111]
    ds_read_b64_tr_b16 v[36:37], v13 offset:49152
    v_mfma_f32_32x32x16_bf16 v[112:127], v[44:47], v[60:63], v[112:127]
    ds_read_b64_tr_b16 v[38:39], v13 offset:50176
    s_waitcnt lgkmcnt(5)
    v_mfma_f32_32x32x16_bf16 v[128:143], v[48:51], v[56:59], v[128:143]
    ds_read_b128 v[16:19], v10 offset:49152
    v_mfma_f32_32x32x16_bf16 v[144:159], v[48:51], v[60:63], v[144:159]
    ds_read_b128 v[20:23], v10 offset:51200
    buffer_load_dwordx4 v5, s[28:31], s69 offen offset:1024 lds
    s_waitcnt lgkmcnt(6)
    v_mfma_f32_32x32x16_bf16 v[160:175], v[52:55], v[56:59], v[160:175]
    ds_read_b128 v[24:27], v10 offset:53248
    v_mfma_f32_32x32x16_bf16 v[176:191], v[52:55], v[60:63], v[176:191]
    ds_read_b128 v[28:31], v10 offset:55296
    s_waitcnt vmcnt(4)
    s_barrier
    s_waitcnt lgkmcnt(3)
    v_mfma_f32_32x32x16_bf16 v[64:79], v[16:19], v[32:35], v[64:79]
    ds_read_b64_tr_b16 v[56:57], v12 offset:53248
    v_mfma_f32_32x32x16_bf16 v[80:95], v[16:19], v[36:39], v[80:95]
    ds_read_b64_tr_b16 v[58:59], v12 offset:54272
    s_add_u32 m0, s57, 32768
    s_add_u32 s69, s55, 2621440
    buffer_load_dwordx4 v4, s[28:31], s69 offen lds
    s_waitcnt lgkmcnt(4)
    v_mfma_f32_32x32x16_bf16 v[96:111], v[20:23], v[32:35], v[96:111]
    ds_read_b64_tr_b16 v[60:61], v13 offset:53248
    v_mfma_f32_32x32x16_bf16 v[112:127], v[20:23], v[36:39], v[112:127]
    ds_read_b64_tr_b16 v[62:63], v13 offset:54272
    s_waitcnt lgkmcnt(5)
    v_mfma_f32_32x32x16_bf16 v[128:143], v[24:27], v[32:35], v[128:143]
    ds_read_b128 v[40:43], v11 offset:49152
    v_mfma_f32_32x32x16_bf16 v[144:159], v[24:27], v[36:39], v[144:159]
    ds_read_b128 v[44:47], v11 offset:51200
    buffer_load_dwordx4 v5, s[28:31], s69 offen offset:1024 lds
    s_waitcnt lgkmcnt(6)
    v_mfma_f32_32x32x16_bf16 v[160:175], v[28:31], v[32:35], v[160:175]
    ds_read_b128 v[48:51], v11 offset:53248
    v_mfma_f32_32x32x16_bf16 v[176:191], v[28:31], v[36:39], v[176:191]
    ds_read_b128 v[52:55], v11 offset:55296
    s_waitcnt lgkmcnt(3)
    v_mfma_f32_32x32x16_bf16 v[64:79], v[40:43], v[56:59], v[64:79]
    ds_read_b64_tr_b16 v[32:33], v12 offset:0
    v_mfma_f32_32x32x16_bf16 v[80:95], v[40:43], v[60:63], v[80:95]
    ds_read_b64_tr_b16 v[34:35], v12 offset:1024
    s_add_u32 m0, s57, 34816
    s_add_u32 s69, s55, 2686976
    buffer_load_dwordx4 v4, s[28:31], s69 offen lds
    s_waitcnt lgkmcnt(4)
    v_mfma_f32_32x32x16_bf16 v[96:111], v[44:47], v[56:59], v[96:111]
    ds_read_b64_tr_b16 v[36:37], v13 offset:0
    v_mfma_f32_32x32x16_bf16 v[112:127], v[44:47], v[60:63], v[112:127]
    ds_read_b64_tr_b16 v[38:39], v13 offset:1024
    s_waitcnt lgkmcnt(5)
    v_mfma_f32_32x32x16_bf16 v[128:143], v[48:51], v[56:59], v[128:143]
    ds_read_b128 v[16:19], v10 offset:0
    v_mfma_f32_32x32x16_bf16 v[144:159], v[48:51], v[60:63], v[144:159]
    ds_read_b128 v[20:23], v10 offset:2048
    buffer_load_dwordx4 v5, s[28:31], s69 offen offset:1024 lds
    s_waitcnt lgkmcnt(6)
    v_mfma_f32_32x32x16_bf16 v[160:175], v[52:55], v[56:59], v[160:175]
    ds_read_b128 v[24:27], v10 offset:4096
    v_mfma_f32_32x32x16_bf16 v[176:191], v[52:55], v[60:63], v[176:191]
    ds_read_b128 v[28:31], v10 offset:6144
    s_waitcnt vmcnt(4)
    s_barrier
    s_waitcnt lgkmcnt(3)
    v_mfma_f32_32x32x16_bf16 v[64:79], v[16:19], v[32:35], v[64:79]
    ds_read_b64_tr_b16 v[56:57], v12 offset:4096
    v_mfma_f32_32x32x16_bf16 v[80:95], v[16:19], v[36:39], v[80:95]
    ds_read_b64_tr_b16 v[58:59], v12 offset:5120
    s_add_u32 m0, s57, 49152
    s_add_u32 s69, s55, 2883584
    buffer_load_dwordx4 v4, s[28:31], s69 offen lds
    s_waitcnt lgkmcnt(4)
    v_mfma_f32_32x32x16_bf16 v[96:111], v[20:23], v[32:35], v[96:111]
    ds_read_b64_tr_b16 v[60:61], v13 offset:4096
    v_mfma_f32_32x32x16_bf16 v[112:127], v[20:23], v[36:39], v[112:127]
    ds_read_b64_tr_b16 v[62:63], v13 offset:5120
    s_waitcnt lgkmcnt(5)
    v_mfma_f32_32x32x16_bf16 v[128:143], v[24:27], v[32:35], v[128:143]
    ds_read_b128 v[40:43], v11 offset:0
    v_mfma_f32_32x32x16_bf16 v[144:159], v[24:27], v[36:39], v[144:159]
    ds_read_b128 v[44:47], v11 offset:2048
    buffer_load_dwordx4 v5, s[28:31], s69 offen offset:1024 lds
    s_waitcnt lgkmcnt(6)
    v_mfma_f32_32x32x16_bf16 v[160:175], v[28:31], v[32:35], v[160:175]
    ds_read_b128 v[48:51], v11 offset:4096
    v_mfma_f32_32x32x16_bf16 v[176:191], v[28:31], v[36:39], v[176:191]
    ds_read_b128 v[52:55], v11 offset:6144
    s_waitcnt lgkmcnt(3)
    v_mfma_f32_32x32x16_bf16 v[64:79], v[40:43], v[56:59], v[64:79]
    ds_read_b64_tr_b16 v[32:33], v12 offset:16384
    v_mfma_f32_32x32x16_bf16 v[80:95], v[40:43], v[60:63], v[80:95]
    ds_read_b64_tr_b16 v[34:35], v12 offset:17408
    s_add_u32 m0, s57, 51200
    s_add_u32 s69, s55, 2949120
    buffer_load_dwordx4 v4, s[28:31], s69 offen lds
    s_waitcnt lgkmcnt(4)
    v_mfma_f32_32x32x16_bf16 v[96:111], v[44:47], v[56:59], v[96:111]
    ds_read_b64_tr_b16 v[36:37], v13 offset:16384
    v_mfma_f32_32x32x16_bf16 v[112:127], v[44:47], v[60:63], v[112:127]
    ds_read_b64_tr_b16 v[38:39], v13 offset:17408
    s_waitcnt lgkmcnt(5)
    v_mfma_f32_32x32x16_bf16 v[128:143], v[48:51], v[56:59], v[128:143]
    ds_read_b128 v[16:19], v10 offset:16384
    v_mfma_f32_32x32x16_bf16 v[144:159], v[48:51], v[60:63], v[144:159]
    ds_read_b128 v[20:23], v10 offset:18432
    buffer_load_dwordx4 v5, s[28:31], s69 offen offset:1024 lds
    s_waitcnt lgkmcnt(6)
    v_mfma_f32_32x32x16_bf16 v[160:175], v[52:55], v[56:59], v[160:175]
    ds_read_b128 v[24:27], v10 offset:20480
    v_mfma_f32_32x32x16_bf16 v[176:191], v[52:55], v[60:63], v[176:191]
    ds_read_b128 v[28:31], v10 offset:22528
    s_waitcnt vmcnt(4)
    s_barrier
    s_waitcnt lgkmcnt(3)
    v_mfma_f32_32x32x16_bf16 v[64:79], v[16:19], v[32:35], v[64:79]
    ds_read_b64_tr_b16 v[56:57], v12 offset:20480
    v_mfma_f32_32x32x16_bf16 v[80:95], v[16:19], v[36:39], v[80:95]
    ds_read_b64_tr_b16 v[58:59], v12 offset:21504
    s_add_u32 m0, s57, 0
    s_add_u32 s69, s55, 3145728
    buffer_load_dwordx4 v4, s[28:31], s69 offen lds
    s_waitcnt lgkmcnt(4)
    v_mfma_f32_32x32x16_bf16 v[96:111], v[20:23], v[32:35], v[96:111]
    ds_read_b64_tr_b16 v[60:61], v13 offset:20480
    v_mfma_f32_32x32x16_bf16 v[112:127], v[20:23], v[36:39], v[112:127]
    ds_read_b64_tr_b16 v[62:63], v13 offset:21504
    s_waitcnt lgkmcnt(5)
    v_mfma_f32_32x32x16_bf16 v[128:143], v[24:27], v[32:35], v[128:143]
    ds_read_b128 v[40:43], v11 offset:16384
    v_mfma_f32_32x32x16_bf16 v[144:159], v[24:27], v[36:39], v[144:159]
    ds_read_b128 v[44:47], v11 offset:18432
    buffer_load_dwordx4 v5, s[28:31], s69 offen offset:1024 lds
    s_waitcnt lgkmcnt(6)
    v_mfma_f32_32x32x16_bf16 v[160:175], v[28:31], v[32:35], v[160:175]
    ds_read_b128 v[48:51], v11 offset:20480
    v_mfma_f32_32x32x16_bf16 v[176:191], v[28:31], v[36:39], v[176:191]
    ds_read_b128 v[52:55], v11 offset:22528
    s_waitcnt lgkmcnt(3)
    v_mfma_f32_32x32x16_bf16 v[64:79], v[40:43], v[56:59], v[64:79]
    ds_read_b64_tr_b16 v[32:33], v12 offset:32768
    v_mfma_f32_32x32x16_bf16 v[80:95], v[40:43], v[60:63], v[80:95]
    ds_read_b64_tr_b16 v[34:35], v12 offset:33792
    s_add_u32 m0, s57, 2048
    s_add_u32 s69, s55, 3211264
    buffer_load_dwordx4 v4, s[28:31], s69 offen lds
    s_waitcnt lgkmcnt(4)
    v_mfma_f32_32x32x16_bf16 v[96:111], v[44:47], v[56:59], v[96:111]
    ds_read_b64_tr_b16 v[36:37], v13 offset:32768
    v_mfma_f32_32x32x16_bf16 v[112:127], v[44:47], v[60:63], v[112:127]
    ds_read_b64_tr_b16 v[38:39], v13 offset:33792
    s_waitcnt lgkmcnt(5)
    v_mfma_f32_32x32x16_bf16 v[128:143], v[48:51], v[56:59], v[128:143]
    ds_read_b128 v[16:19], v10 offset:32768
    v_mfma_f32_32x32x16_bf16 v[144:159], v[48:51], v[60:63], v[144:159]
    ds_read_b128 v[20:23], v10 offset:34816
    buffer_load_dwordx4 v5, s[28:31], s69 offen offset:1024 lds
    s_waitcnt lgkmcnt(6)
    v_mfma_f32_32x32x16_bf16 v[160:175], v[52:55], v[56:59], v[160:175]
    ds_read_b128 v[24:27], v10 offset:36864
    v_mfma_f32_32x32x16_bf16 v[176:191], v[52:55], v[60:63], v[176:191]
    ds_read_b128 v[28:31], v10 offset:38912
    s_waitcnt vmcnt(4)
    s_barrier
    s_waitcnt lgkmcnt(3)
    v_mfma_f32_32x32x16_bf16 v[64:79], v[16:19], v[32:35], v[64:79]
    ds_read_b64_tr_b16 v[56:57], v12 offset:36864
    v_mfma_f32_32x32x16_bf16 v[80:95], v[16:19], v[36:39], v[80:95]
    ds_read_b64_tr_b16 v[58:59], v12 offset:37888
    s_add_u32 m0, s57, 16384
    s_add_u32 s69, s55, 3407872
    buffer_load_dwordx4 v4, s[28:31], s69 offen lds
    s_waitcnt lgkmcnt(4)
    v_mfma_f32_32x32x16_bf16 v[96:111], v[20:23], v[32:35], v[96:111]
    ds_read_b64_tr_b16 v[60:61], v13 offset:36864
    v_mfma_f32_32x32x16_bf16 v[112:127], v[20:23], v[36:39], v[112:127]
    ds_read_b64_tr_b16 v[62:63], v13 offset:37888
    s_waitcnt lgkmcnt(5)
    v_mfma_f32_32x32x16_bf16 v[128:143], v[24:27], v[32:35], v[128:143]
    ds_read_b128 v[40:43], v11 offset:32768
    v_mfma_f32_32x32x16_bf16 v[144:159], v[24:27], v[36:39], v[144:159]
    ds_read_b128 v[44:47], v11 offset:34816
    buffer_load_dwordx4 v5, s[28:31], s69 offen offset:1024 lds
    s_waitcnt lgkmcnt(6)
    v_mfma_f32_32x32x16_bf16 v[160:175], v[28:31], v[32:35], v[160:175]
    ds_read_b128 v[48:51], v11 offset:36864
    v_mfma_f32_32x32x16_bf16 v[176:191], v[28:31], v[36:39], v[176:191]
    ds_read_b128 v[52:55], v11 offset:38912
    s_waitcnt lgkmcnt(3)
    v_mfma_f32_32x32x16_bf16 v[64:79], v[40:43], v[56:59], v[64:79]
    ds_read_b64_tr_b16 v[32:33], v12 offset:49152
    v_mfma_f32_32x32x16_bf16 v[80:95], v[40:43], v[60:63], v[80:95]
    ds_read_b64_tr_b16 v[34:35], v12 offset:50176
    s_add_u32 m0, s57, 18432
    s_add_u32 s69, s55, 3473408
    buffer_load_dwordx4 v4, s[28:31], s69 offen lds
    s_waitcnt lgkmcnt(4)
    v_mfma_f32_32x32x16_bf16 v[96:111], v[44:47], v[56:59], v[96:111]
    ds_read_b64_tr_b16 v[36:37], v13 offset:49152
    v_mfma_f32_32x32x16_bf16 v[112:127], v[44:47], v[60:63], v[112:127]
    ds_read_b64_tr_b16 v[38:39], v13 offset:50176
    s_waitcnt lgkmcnt(5)
    v_mfma_f32_32x32x16_bf16 v[128:143], v[48:51], v[56:59], v[128:143]
    ds_read_b128 v[16:19], v10 offset:49152
    v_mfma_f32_32x32x16_bf16 v[144:159], v[48:51], v[60:63], v[144:159]
    ds_read_b128 v[20:23], v10 offset:51200
    buffer_load_dwordx4 v5, s[28:31], s69 offen offset:1024 lds
    s_waitcnt lgkmcnt(6)
    v_mfma_f32_32x32x16_bf16 v[160:175], v[52:55], v[56:59], v[160:175]
    ds_read_b128 v[24:27], v10 offset:53248
    v_mfma_f32_32x32x16_bf16 v[176:191], v[52:55], v[60:63], v[176:191]
    ds_read_b128 v[28:31], v10 offset:55296
    s_waitcnt vmcnt(4)
    s_barrier
    s_waitcnt lgkmcnt(3)
    v_mfma_f32_32x32x16_bf16 v[64:79], v[16:19], v[32:35], v[64:79]
    ds_read_b64_tr_b16 v[56:57], v12 offset:53248
    v_mfma_f32_32x32x16_bf16 v[80:95], v[16:19], v[36:39], v[80:95]
    ds_read_b64_tr_b16 v[58:59], v12 offset:54272
    s_add_u32 m0, s57, 32768
    s_add_u32 s69, s55, 3670016
    buffer_load_dwordx4 v4, s[28:31], s69 offen lds
    s_waitcnt lgkmcnt(4)
    v_mfma_f32_32x32x16_bf16 v[96:111], v[20:23], v[32:35], v[96:111]
    ds_read_b64_tr_b16 v[60:61], v13 offset:53248
    v_mfma_f32_32x32x16_bf16 v[112:127], v[20:23], v[36:39], v[112:127]
    ds_read_b64_tr_b16 v[62:63], v13 offset:54272
    s_waitcnt lgkmcnt(5)
    v_mfma_f32_32x32x16_bf16 v[128:143], v[24:27], v[32:35], v[128:143]
    ds_read_b128 v[40:43], v11 offset:49152
    v_mfma_f32_32x32x16_bf16 v[144:159], v[24:27], v[36:39], v[144:159]
    ds_read_b128 v[44:47], v11 offset:51200
    buffer_load_dwordx4 v5, s[28:31], s69 offen offset:1024 lds
    s_waitcnt lgkmcnt(6)
    v_mfma_f32_32x32x16_bf16 v[160:175], v[28:31], v[32:35], v[160:175]
    ds_read_b128 v[48:51], v11 offset:53248
    v_mfma_f32_32x32x16_bf16 v[176:191], v[28:31], v[36:39], v[176:191]
    ds_read_b128 v[52:55], v11 offset:55296
    s_waitcnt lgkmcnt(3)
    v_mfma_f32_32x32x16_bf16 v[64:79], v[40:43], v[56:59], v[64:79]
    ds_read_b64_tr_b16 v[32:33], v12 offset:0
    v_mfma_f32_32x32x16_bf16 v[80:95], v[40:43], v[60:63], v[80:95]
    ds_read_b64_tr_b16 v[34:35], v12 offset:1024
    s_add_u32 m0, s57, 34816
    s_add_u32 s69, s55, 3735552
    buffer_load_dwordx4 v4, s[28:31], s69 offen lds
    s_waitcnt lgkmcnt(4)
    v_mfma_f32_32x32x16_bf16 v[96:111], v[44:47], v[56:59], v[96:111]
    ds_read_b64_tr_b16 v[36:37], v13 offset:0
    v_mfma_f32_32x32x16_bf16 v[112:127], v[44:47], v[60:63], v[112:127]
    ds_read_b64_tr_b16 v[38:39], v13 offset:1024
    s_waitcnt lgkmcnt(5)
    v_mfma_f32_32x32x16_bf16 v[128:143], v[48:51], v[56:59], v[128:143]
    ds_read_b128 v[16:19], v10 offset:0
    v_mfma_f32_32x32x16_bf16 v[144:159], v[48:51], v[60:63], v[144:159]
    ds_read_b128 v[20:23], v10 offset:2048
    buffer_load_dwordx4 v5, s[28:31], s69 offen offset:1024 lds
    s_waitcnt lgkmcnt(6)
    v_mfma_f32_32x32x16_bf16 v[160:175], v[52:55], v[56:59], v[160:175]
    ds_read_b128 v[24:27], v10 offset:4096
    v_mfma_f32_32x32x16_bf16 v[176:191], v[52:55], v[60:63], v[176:191]
    ds_read_b128 v[28:31], v10 offset:6144
    s_waitcnt vmcnt(4)
    s_barrier
    s_waitcnt lgkmcnt(3)
    v_mfma_f32_32x32x16_bf16 v[64:79], v[16:19], v[32:35], v[64:79]
    ds_read_b64_tr_b16 v[56:57], v12 offset:4096
    v_mfma_f32_32x32x16_bf16 v[80:95], v[16:19], v[36:39], v[80:95]
    ds_read_b64_tr_b16 v[58:59], v12 offset:5120
    s_add_u32 m0, s57, 49152
    s_add_u32 s69, s55, 3932160
    buffer_load_dwordx4 v4, s[28:31], s69 offen lds
    s_waitcnt lgkmcnt(4)
    v_mfma_f32_32x32x16_bf16 v[96:111], v[20:23], v[32:35], v[96:111]
    ds_read_b64_tr_b16 v[60:61], v13 offset:4096
    v_mfma_f32_32x32x16_bf16 v[112:127], v[20:23], v[36:39], v[112:127]
    ds_read_b64_tr_b16 v[62:63], v13 offset:5120
    s_waitcnt lgkmcnt(5)
    v_mfma_f32_32x32x16_bf16 v[128:143], v[24:27], v[32:35], v[128:143]
    ds_read_b128 v[40:43], v11 offset:0
    v_mfma_f32_32x32x16_bf16 v[144:159], v[24:27], v[36:39], v[144:159]
    ds_read_b128 v[44:47], v11 offset:2048
    buffer_load_dwordx4 v5, s[28:31], s69 offen offset:1024 lds
    s_waitcnt lgkmcnt(6)
    v_mfma_f32_32x32x16_bf16 v[160:175], v[28:31], v[32:35], v[160:175]
    ds_read_b128 v[48:51], v11 offset:4096
    v_mfma_f32_32x32x16_bf16 v[176:191], v[28:31], v[36:39], v[176:191]
    ds_read_b128 v[52:55], v11 offset:6144
    s_waitcnt lgkmcnt(3)
    v_mfma_f32_32x32x16_bf16 v[64:79], v[40:43], v[56:59], v[64:79]
    ds_read_b64_tr_b16 v[32:33], v12 offset:16384
    v_mfma_f32_32x32x16_bf16 v[80:95], v[40:43], v[60:63], v[80:95]
    ds_read_b64_tr_b16 v[34:35], v12 offset:17408
    s_add_u32 m0, s57, 51200
    s_add_u32 s69, s55, 3997696
    buffer_load_dwordx4 v4, s[28:31], s69 offen lds
    s_waitcnt lgkmcnt(4)
    v_mfma_f32_32x32x16_bf16 v[96:111], v[44:47], v[56:59], v[96:111]
    ds_read_b64_tr_b16 v[36:37], v13 offset:16384
    v_mfma_f32_32x32x16_bf16 v[112:127], v[44:47], v[60:63], v[112:127]
    ds_read_b64_tr_b16 v[38:39], v13 offset:17408
    s_waitcnt lgkmcnt(5)
    v_mfma_f32_32x32x16_bf16 v[128:143], v[48:51], v[56:59], v[128:143]
    ds_read_b128 v[16:19], v10 offset:16384
    v_mfma_f32_32x32x16_bf16 v[144:159], v[48:51], v[60:63], v[144:159]
    ds_read_b128 v[20:23], v10 offset:18432
    buffer_load_dwordx4 v5, s[28:31], s69 offen offset:1024 lds
    s_waitcnt lgkmcnt(6)
    v_mfma_f32_32x32x16_bf16 v[160:175], v[52:55], v[56:59], v[160:175]
    ds_read_b128 v[24:27], v10 offset:20480
    v_mfma_f32_32x32x16_bf16 v[176:191], v[52:55], v[60:63], v[176:191]
    ds_read_b128 v[28:31], v10 offset:22528
    s_waitcnt vmcnt(4)
    s_barrier
    s_lshl_b32 s70, s42, 3
    s_add_u32 s70, s70, s40
    s_lshl_b32 s71, s70, 16
    s_lshl_b32 s72, s41, 8
    s_add_u32 s71, s71, s72
    s_mul_i32 s70, s70, 28672
    s_lshl_b32 s72, s51, 8
    s_add_u32 s70, s70, s72
    v_bfe_u32 v6, v0, 1, 3
    v_and_b32 v7, 1, v0
    v_lshlrev_b32 v7, 7, v7
    v_mul_u32_u24 v8, 3584, v6
    v_add_u32 v8, v8, v7
    v_lshlrev_b32 v6, 13, v6
    v_add_u32 v6, v6, v7
    s_mov_b64 exec, 0xffff
    buffer_load_dword v9, v6, s[20:23], s71 offen
    buffer_load_dword v9, v8, s[12:15], s70 offen
    buffer_load_dword v9, v8, s[16:19], s70 offen
    s_mov_b64 exec, -1

    s_waitcnt lgkmcnt(3)
    v_mfma_f32_32x32x16_bf16 v[64:79], v[16:19], v[32:35], v[64:79]
    ds_read_b64_tr_b16 v[56:57], v12 offset:20480
    v_mfma_f32_32x32x16_bf16 v[80:95], v[16:19], v[36:39], v[80:95]
    ds_read_b64_tr_b16 v[58:59], v12 offset:21504
    s_waitcnt lgkmcnt(4)
    v_mfma_f32_32x32x16_bf16 v[96:111], v[20:23], v[32:35], v[96:111]
    ds_read_b64_tr_b16 v[60:61], v13 offset:20480
    v_mfma_f32_32x32x16_bf16 v[112:127], v[20:23], v[36:39], v[112:127]
    ds_read_b64_tr_b16 v[62:63], v13 offset:21504
    s_waitcnt lgkmcnt(5)
    v_mfma_f32_32x32x16_bf16 v[128:143], v[24:27], v[32:35], v[128:143]
    ds_read_b128 v[40:43], v11 offset:16384
    v_mfma_f32_32x32x16_bf16 v[144:159], v[24:27], v[36:39], v[144:159]
    ds_read_b128 v[44:47], v11 offset:18432
    s_waitcnt lgkmcnt(6)
    v_mfma_f32_32x32x16_bf16 v[160:175], v[28:31], v[32:35], v[160:175]
    ds_read_b128 v[48:51], v11 offset:20480
    v_mfma_f32_32x32x16_bf16 v[176:191], v[28:31], v[36:39], v[176:191]
    ds_read_b128 v[52:55], v11 offset:22528
    s_waitcnt lgkmcnt(3)
    v_mfma_f32_32x32x16_bf16 v[64:79], v[40:43], v[56:59], v[64:79]
    ds_read_b64_tr_b16 v[32:33], v12 offset:32768
    v_mfma_f32_32x32x16_bf16 v[80:95], v[40:43], v[60:63], v[80:95]
    ds_read_b64_tr_b16 v[34:35], v12 offset:33792
    s_waitcnt lgkmcnt(4)
    v_mfma_f32_32x32x16_bf16 v[96:111], v[44:47], v[56:59], v[96:111]
    ds_read_b64_tr_b16 v[36:37], v13 offset:32768
    v_mfma_f32_32x32x16_bf16 v[112:127], v[44:47], v[60:63], v[112:127]
    ds_read_b64_tr_b16 v[38:39], v13 offset:33792
    s_waitcnt lgkmcnt(5)
    v_mfma_f32_32x32x16_bf16 v[128:143], v[48:51], v[56:59], v[128:143]
    ds_read_b128 v[16:19], v10 offset:32768
    v_mfma_f32_32x32x16_bf16 v[144:159], v[48:51], v[60:63], v[144:159]
    ds_read_b128 v[20:23], v10 offset:34816
    s_waitcnt lgkmcnt(6)
    v_mfma_f32_32x32x16_bf16 v[160:175], v[52:55], v[56:59], v[160:175]
    ds_read_b128 v[24:27], v10 offset:36864
    v_mfma_f32_32x32x16_bf16 v[176:191], v[52:55], v[60:63], v[176:191]
    ds_read_b128 v[28:31], v10 offset:38912
    s_waitcnt vmcnt(0)
    s_barrier
    s_cmp_lg_u32 s40, 0
    s_cbranch_scc1 stl_11
    buffer_load_dword v199, v244, s[76:79], 0 offen sc1
stl_11:
    s_waitcnt lgkmcnt(3)
    v_mfma_f32_32x32x16_bf16 v[64:79], v[16:19], v[32:35], v[64:79]
    ds_read_b64_tr_b16 v[56:57], v12 offset:36864
    v_mfma_f32_32x32x16_bf16 v[80:95], v[16:19], v[36:39], v[80:95]
    ds_read_b64_tr_b16 v[58:59], v12 offset:37888
    s_waitcnt lgkmcnt(4)
    v_mfma_f32_32x32x16_bf16 v[96:111], v[20:23], v[32:35], v[96:111]
    ds_read_b64_tr_b16 v[60:61], v13 offset:36864
    v_mfma_f32_32x32x16_bf16 v[112:127], v[20:23], v[36:39], v[112:127]
    ds_read_b64_tr_b16 v[62:63], v13 offset:37888
    s_waitcnt lgkmcnt(5)
    v_mfma_f32_32x32x16_bf16 v[128:143], v[24:27], v[32:35], v[128:143]
    ds_read_b128 v[40:43], v11 offset:32768
    v_mfma_f32_32x32x16_bf16 v[144:159], v[24:27], v[36:39], v[144:159]
    ds_read_b128 v[44:47], v11 offset:34816
    s_waitcnt lgkmcnt(6)
    v_mfma_f32_32x32x16_bf16 v[160:175], v[28:31], v[32:35], v[160:175]
    ds_read_b128 v[48:51], v11 offset:36864
    v_mfma_f32_32x32x16_bf16 v[176:191], v[28:31], v[36:39], v[176:191]
    ds_read_b128 v[52:55], v11 offset:38912
    s_waitcnt lgkmcnt(3)
    v_mfma_f32_32x32x16_bf16 v[64:79], v[40:43], v[56:59], v[64:79]
    ds_read_b64_tr_b16 v[32:33], v12 offset:49152
    v_mfma_f32_32x32x16_bf16 v[80:95], v[40:43], v[60:63], v[80:95]
    ds_read_b64_tr_b16 v[34:35], v12 offset:50176
    s_waitcnt lgkmcnt(4)
    v_mfma_f32_32x32x16_bf16 v[96:111], v[44:47], v[56:59], v[96:111]
    ds_read_b64_tr_b16 v[36:37], v13 offset:49152
    v_mfma_f32_32x32x16_bf16 v[112:127], v[44:47], v[60:63], v[112:127]
    ds_read_b64_tr_b16 v[38:39], v13 offset:50176
    s_waitcnt lgkmcnt(5)
    v_mfma_f32_32x32x16_bf16 v[128:143], v[48:51], v[56:59], v[128:143]
    ds_read_b128 v[16:19], v10 offset:49152
    v_mfma_f32_32x32x16_bf16 v[144:159], v[48:51], v[60:63], v[144:159]
    ds_read_b128 v[20:23], v10 offset:51200
    s_waitcnt lgkmcnt(6)
    v_mfma_f32_32x32x16_bf16 v[160:175], v[52:55], v[56:59], v[160:175]
    ds_read_b128 v[24:27], v10 offset:53248
    v_mfma_f32_32x32x16_bf16 v[176:191], v[52:55], v[60:63], v[176:191]
    ds_read_b128 v[28:31], v10 offset:55296
    s_waitcnt lgkmcnt(3)
    v_mfma_f32_32x32x16_bf16 v[64:79], v[16:19], v[32:35], v[64:79]
    ds_read_b64_tr_b16 v[56:57], v12 offset:53248
    v_mfma_f32_32x32x16_bf16 v[80:95], v[16:19], v[36:39], v[80:95]
    ds_read_b64_tr_b16 v[58:59], v12 offset:54272
    s_waitcnt lgkmcnt(4)
    v_mfma_f32_32x32x16_bf16 v[96:111], v[20:23], v[32:35], v[96:111]
    ds_read_b64_tr_b16 v[60:61], v13 offset:53248
    v_mfma_f32_32x32x16_bf16 v[112:127], v[20:23], v[36:39], v[112:127]
    ds_read_b64_tr_b16 v[62:63], v13 offset:54272
    s_waitcnt lgkmcnt(5)
    v_mfma_f32_32x32x16_bf16 v[128:143], v[24:27], v[32:35], v[128:143]
    ds_read_b128 v[40:43], v11 offset:49152
    v_mfma_f32_32x32x16_bf16 v[144:159], v[24:27], v[36:39], v[144:159]
    ds_read_b128 v[44:47], v11 offset:51200
    s_waitcnt lgkmcnt(6)
    v_mfma_f32_32x32x16_bf16 v[160:175], v[28:31], v[32:35], v[160:175]
    ds_read_b128 v[48:51], v11 offset:53248
    v_mfma_f32_32x32x16_bf16 v[176:191], v[28:31], v[36:39], v[176:191]
    ds_read_b128 v[52:55], v11 offset:55296
    s_waitcnt lgkmcnt(3)
    v_mfma_f32_32x32x16_bf16 v[64:79], v[40:43], v[56:59], v[64:79]
    v_mfma_f32_32x32x16_bf16 v[80:95], v[40:43], v[60:63], v[80:95]
    s_waitcnt lgkmcnt(2)
    v_mfma_f32_32x32x16_bf16 v[96:111], v[44:47], v[56:59], v[96:111]
    v_mfma_f32_32x32x16_bf16 v[112:127], v[44:47], v[60:63], v[112:127]
    s_waitcnt lgkmcnt(1)
    v_mfma_f32_32x32x16_bf16 v[128:143], v[48:51], v[56:59], v[128:143]
    v_mfma_f32_32x32x16_bf16 v[144:159], v[48:51], v[60:63], v[144:159]
    s_waitcnt lgkmcnt(0)
    v_mfma_f32_32x32x16_bf16 v[160:175], v[52:55], v[56:59], v[160:175]
    v_mfma_f32_32x32x16_bf16 v[176:191], v[52:55], v[60:63], v[176:191]
p1_epi_8:
    v_lshrrev_b32 v7, 4, v0
    v_and_b32 v8, 15, v0
    v_lshlrev_b32 v9, 2, v7
    v_xor_b32 v8, v8, v9
    v_lshlrev_b32 v8, 4, v8
    v_mul_u32_u24 v6, 3584, v7
    v_add_u32 v192, v6, v8
    v_lshlrev_b32 v6, 13, v7
    v_add_u32 v193, v6, v8
    s_cmp_lt_u32 s40, 4
    s_cselect_b32 s66, s52, s53
    s_lshl_b32 s66, s66, 2
    s_add_u32 s66, s66, s46
    s_lshl_b32 s47, s66, 15
    s_mul_i32 s48, s40, 14336
    s_lshl_b32 s66, s51, 8
    s_add_u32 s48, s48, s66
    s_lshl_b32 s49, s40, 15
    s_lshl_b32 s66, s41, 8
    s_add_u32 s49, s49, s66
    s_lshl_b32 s50, s40, 10
    s_lshl_b32 s56, s40, 11
    s_lshl_b32 s66, s43, 12
    v_add_u32 v194, s66, v1
    v_add_u32 v195, 81920, v194
    s_lshl_b32 s66, s44, 6
    v_xor_b32 v6, s66, v198
    v_add_u32 v196, 16384, v6
    v_add_u32 v197, 81920, v196
    v_mov_b32 v6, 0x27ff0
    s_waitcnt vmcnt(0)

    s_cmp_lg_u32 s40, 0
    s_cbranch_scc1 b12_nw0_12
    s_mov_b32 s73, 0
fl_spin_14:
    v_and_b32 v245, 0x10101010, v199
    v_cmp_eq_u32 vcc, 0x10101010, v245
    s_lshl_b32 s70, s42, 3
    s_lshr_b64 s[68:69], vcc, s70
    s_and_b32 s68, s68, 0xff
    s_cmp_eq_u32 s68, 0xff

    s_cbranch_scc1 fl_ok_13
    s_add_u32 s73, s73, 1
    s_cmp_ge_u32 s73, 262144
    s_cbranch_scc1 fl_ok_13
    s_sleep 16

    buffer_load_dword v199, v244, s[76:79], 0 offen sc1
    s_waitcnt vmcnt(0)
    s_branch fl_spin_14
fl_ok_13:
    s_and_b32 s70, s2, 3
    s_lshl_b32 s70, s70, 3
    v_lshrrev_b32 v245, s70, v199
    s_bfe_u32 s70, s2, 0x30002
    s_mov_b32 s68, 0x01010101
    s_mov_b32 s69, 0x01010101
    s_lshl_b64 s[68:69], s[68:69], s70
    v_and_b32 v245, 0x17, v245
    v_cmp_eq_u32 vcc, s74, v245
    s_and_b64 s[70:71], vcc, s[68:69]
    s_cmp_eq_u64 s[70:71], s[68:69]
    s_cselect_b32 s75, 0, 1

    v_mov_b32 v7, s75
    ds_write_b32 v6, v7
    s_waitcnt lgkmcnt(0)
b12_nw0_12:
    s_barrier
    ds_read_b32 v7, v6
    s_waitcnt lgkmcnt(0)
    v_readfirstlane_b32 s75, v7

    s_add_u32 m0, s56, 0
    s_add_u32 s67, s47, 0
    buffer_load_dwordx4 v1, s[8:11], s67 offen sc1 lds
    buffer_load_dwordx4 v1, s[8:11], s67 offen offset:1024 sc1 lds
    s_add_u32 m0, s50, 16384
    s_add_u32 s68, s48, 0
    buffer_load_dwordx4 v192, s[12:15], s68 offen lds
    s_add_u32 m0, s50, 24576
    s_add_u32 s69, s49, 0
    buffer_load_dwordx4 v192, s[16:19], s68 offen lds
    s_add_u32 m0, s50, 32768
    s_nop 0
    buffer_load_dwordx4 v193, s[20:23], s69 offen lds
    s_add_u32 m0, s56, 40960
    s_add_u32 s67, s47, 2048
    buffer_load_dwordx4 v1, s[8:11], s67 offen sc1 lds
    buffer_load_dwordx4 v1, s[8:11], s67 offen offset:1024 sc1 lds
    s_add_u32 m0, s50, 57344
    s_add_u32 s68, s48, 114688
    buffer_load_dwordx4 v192, s[12:15], s68 offen lds
    s_add_u32 m0, s50, 65536
    s_add_u32 s69, s49, 262144
    buffer_load_dwordx4 v192, s[16:19], s68 offen lds
    s_add_u32 m0, s50, 73728
    s_nop 0
    buffer_load_dwordx4 v193, s[20:23], s69 offen lds
    s_add_u32 m0, s56, 81920
    s_add_u32 s67, s47, 4096
    buffer_load_dwordx4 v1, s[8:11], s67 offen sc1 lds
    buffer_load_dwordx4 v1, s[8:11], s67 offen offset:1024 sc1 lds
    s_add_u32 m0, s50, 98304
    s_add_u32 s68, s48, 229376
    buffer_load_dwordx4 v192, s[12:15], s68 offen lds
    s_add_u32 m0, s50, 106496
    s_add_u32 s69, s49, 524288
    buffer_load_dwordx4 v192, s[16:19], s68 offen lds
    s_add_u32 m0, s50, 114688
    s_nop 0
    buffer_load_dwordx4 v193, s[20:23], s69 offen lds
    s_lshl_b32 s70, s41, 19
    s_lshl_b32 s71, s42, 16
    s_add_u32 s70, s70, s71
    s_lshl_b32 s71, s45, 15
    s_add_u32 s70, s70, s71
    s_and_b32 s71, s46, 1
    s_lshl_b32 s71, s71, 12
    s_add_u32 s70, s70, s71

    s_cmp_lg_u32 s75, 0
    s_cbranch_scc1 p1e_wt_15
    v_cvt_pk_bf16_f32 v200, v64, v65
    v_cvt_pk_bf16_f32 v201, v66, v67
    v_cvt_pk_bf16_f32 v202, v68, v69
    v_cvt_pk_bf16_f32 v203, v70, v71
    v_cvt_pk_bf16_f32 v204, v72, v73
    v_cvt_pk_bf16_f32 v205, v74, v75
    v_cvt_pk_bf16_f32 v206, v76, v77
    v_cvt_pk_bf16_f32 v207, v78, v79
    buffer_store_dwordx4 v[200:203], v1, s[32:35], s70 offen offset:0
    buffer_store_dwordx4 v[204:207], v1, s[32:35], s70 offen offset:1024
    v_cvt_pk_bf16_f32 v208, v80, v81
    v_cvt_pk_bf16_f32 v209, v82, v83
    v_cvt_pk_bf16_f32 v210, v84, v85
    v_cvt_pk_bf16_f32 v211, v86, v87
    v_cvt_pk_bf16_f32 v212, v88, v89
    v_cvt_pk_bf16_f32 v213, v90, v91
    v_cvt_pk_bf16_f32 v214, v92, v93
    v_cvt_pk_bf16_f32 v215, v94, v95
    buffer_store_dwordx4 v[208:211], v1, s[32:35], s70 offen offset:2048
    buffer_store_dwordx4 v[212:215], v1, s[32:35], s70 offen offset:3072
    s_add_u32 s70, s70, 8192
    v_cvt_pk_bf16_f32 v216, v96, v97
    v_cvt_pk_bf16_f32 v217, v98, v99
    v_cvt_pk_bf16_f32 v218, v100, v101
    v_cvt_pk_bf16_f32 v219, v102, v103
    v_cvt_pk_bf16_f32 v220, v104, v105
    v_cvt_pk_bf16_f32 v221, v106, v107
    v_cvt_pk_bf16_f32 v222, v108, v109
    v_cvt_pk_bf16_f32 v223, v110, v111
    buffer_store_dwordx4 v[216:219], v1, s[32:35], s70 offen offset:0
    buffer_store_dwordx4 v[220:223], v1, s[32:35], s70 offen offset:1024
    v_cvt_pk_bf16_f32 v224, v112, v113
    v_cvt_pk_bf16_f32 v225, v114, v115
    v_cvt_pk_bf16_f32 v226, v116, v117
    v_cvt_pk_bf16_f32 v227, v118, v119
    v_cvt_pk_bf16_f32 v228, v120, v121
    v_cvt_pk_bf16_f32 v229, v122, v123
    v_cvt_pk_bf16_f32 v230, v124, v125
    v_cvt_pk_bf16_f32 v231, v126, v127
    buffer_store_dwordx4 v[224:227], v1, s[32:35], s70 offen offset:2048
    buffer_store_dwordx4 v[228:231], v1, s[32:35], s70 offen offset:3072
    s_add_u32 s70, s70, 8192
    v_cvt_pk_bf16_f32 v200, v128, v129
    v_cvt_pk_bf16_f32 v201, v130, v131
    v_cvt_pk_bf16_f32 v202, v132, v133
    v_cvt_pk_bf16_f32 v203, v134, v135
    v_cvt_pk_bf16_f32 v204, v136, v137
    v_cvt_pk_bf16_f32 v205, v138, v139
    v_cvt_pk_bf16_f32 v206, v140, v141
    v_cvt_pk_bf16_f32 v207, v142, v143
    buffer_store_dwordx4 v[200:203], v1, s[32:35], s70 offen offset:0
    buffer_store_dwordx4 v[204:207], v1, s[32:35], s70 offen offset:1024
    v_cvt_pk_bf16_f32 v208, v144, v145
    v_cvt_pk_bf16_f32 v209, v146, v147
    v_cvt_pk_bf16_f32 v210, v148, v149
    v_cvt_pk_bf16_f32 v211, v150, v151
    v_cvt_pk_bf16_f32 v212, v152, v153
    v_cvt_pk_bf16_f32 v213, v154, v155
    v_cvt_pk_bf16_f32 v214, v156, v157
    v_cvt_pk_bf16_f32 v215, v158, v159
    buffer_store_dwordx4 v[208:211], v1, s[32:35], s70 offen offset:2048
    buffer_store_dwordx4 v[212:215], v1, s[32:35], s70 offen offset:3072
    s_add_u32 s70, s70, 8192
    v_cvt_pk_bf16_f32 v216, v160, v161
    v_cvt_pk_bf16_f32 v217, v162, v163
    v_cvt_pk_bf16_f32 v218, v164, v165
    v_cvt_pk_bf16_f32 v219, v166, v167
    v_cvt_pk_bf16_f32 v220, v168, v169
    v_cvt_pk_bf16_f32 v221, v170, v171
    v_cvt_pk_bf16_f32 v222, v172, v173
    v_cvt_pk_bf16_f32 v223, v174, v175
    buffer_store_dwordx4 v[216:219], v1, s[32:35], s70 offen offset:0
    buffer_store_dwordx4 v[220:223], v1, s[32:35], s70 offen offset:1024
    v_cvt_pk_bf16_f32 v224, v176, v177
    v_cvt_pk_bf16_f32 v225, v178, v179
    v_cvt_pk_bf16_f32 v226, v180, v181
    v_cvt_pk_bf16_f32 v227, v182, v183
    v_cvt_pk_bf16_f32 v228, v184, v185
    v_cvt_pk_bf16_f32 v229, v186, v187
    v_cvt_pk_bf16_f32 v230, v188, v189
    v_cvt_pk_bf16_f32 v231, v190, v191
    buffer_store_dwordx4 v[224:227], v1, s[32:35], s70 offen offset:2048
    buffer_store_dwordx4 v[228:231], v1, s[32:35], s70 offen offset:3072
    s_branch p1e_join_16
p1e_wt_15:
    v_cvt_pk_bf16_f32 v200, v64, v65
    v_cvt_pk_bf16_f32 v201, v66, v67
    v_cvt_pk_bf16_f32 v202, v68, v69
    v_cvt_pk_bf16_f32 v203, v70, v71
    v_cvt_pk_bf16_f32 v204, v72, v73
    v_cvt_pk_bf16_f32 v205, v74, v75
    v_cvt_pk_bf16_f32 v206, v76, v77
    v_cvt_pk_bf16_f32 v207, v78, v79
    buffer_store_dwordx4 v[200:203], v1, s[32:35], s70 offen offset:0 sc0 sc1
    buffer_store_dwordx4 v[204:207], v1, s[32:35], s70 offen offset:1024 sc0 sc1
    v_cvt_pk_bf16_f32 v208, v80, v81
    v_cvt_pk_bf16_f32 v209, v82, v83
    v_cvt_pk_bf16_f32 v210, v84, v85
    v_cvt_pk_bf16_f32 v211, v86, v87
    v_cvt_pk_bf16_f32 v212, v88, v89
    v_cvt_pk_bf16_f32 v213, v90, v91
    v_cvt_pk_bf16_f32 v214, v92, v93
    v_cvt_pk_bf16_f32 v215, v94, v95
    buffer_store_dwordx4 v[208:211], v1, s[32:35], s70 offen offset:2048 sc0 sc1
    buffer_store_dwordx4 v[212:215], v1, s[32:35], s70 offen offset:3072 sc0 sc1
    s_add_u32 s70, s70, 8192
    v_cvt_pk_bf16_f32 v216, v96, v97
    v_cvt_pk_bf16_f32 v217, v98, v99
    v_cvt_pk_bf16_f32 v218, v100, v101
    v_cvt_pk_bf16_f32 v219, v102, v103
    v_cvt_pk_bf16_f32 v220, v104, v105
    v_cvt_pk_bf16_f32 v221, v106, v107
    v_cvt_pk_bf16_f32 v222, v108, v109
    v_cvt_pk_bf16_f32 v223, v110, v111
    buffer_store_dwordx4 v[216:219], v1, s[32:35], s70 offen offset:0 sc0 sc1
    buffer_store_dwordx4 v[220:223], v1, s[32:35], s70 offen offset:1024 sc0 sc1
    v_cvt_pk_bf16_f32 v224, v112, v113
    v_cvt_pk_bf16_f32 v225, v114, v115
    v_cvt_pk_bf16_f32 v226, v116, v117
    v_cvt_pk_bf16_f32 v227, v118, v119
    v_cvt_pk_bf16_f32 v228, v120, v121
    v_cvt_pk_bf16_f32 v229, v122, v123
    v_cvt_pk_bf16_f32 v230, v124, v125
    v_cvt_pk_bf16_f32 v231, v126, v127
    buffer_store_dwordx4 v[224:227], v1, s[32:35], s70 offen offset:2048 sc0 sc1
    buffer_store_dwordx4 v[228:231], v1, s[32:35], s70 offen offset:3072 sc0 sc1
    s_add_u32 s70, s70, 8192
    v_cvt_pk_bf16_f32 v200, v128, v129
    v_cvt_pk_bf16_f32 v201, v130, v131
    v_cvt_pk_bf16_f32 v202, v132, v133
    v_cvt_pk_bf16_f32 v203, v134, v135
    v_cvt_pk_bf16_f32 v204, v136, v137
    v_cvt_pk_bf16_f32 v205, v138, v139
    v_cvt_pk_bf16_f32 v206, v140, v141
    v_cvt_pk_bf16_f32 v207, v142, v143
    buffer_store_dwordx4 v[200:203], v1, s[32:35], s70 offen offset:0 sc0 sc1
    buffer_store_dwordx4 v[204:207], v1, s[32:35], s70 offen offset:1024 sc0 sc1
    v_cvt_pk_bf16_f32 v208, v144, v145
    v_cvt_pk_bf16_f32 v209, v146, v147
    v_cvt_pk_bf16_f32 v210, v148, v149
    v_cvt_pk_bf16_f32 v211, v150, v151
    v_cvt_pk_bf16_f32 v212, v152, v153
    v_cvt_pk_bf16_f32 v213, v154, v155
    v_cvt_pk_bf16_f32 v214, v156, v157
    v_cvt_pk_bf16_f32 v215, v158, v159
    buffer_store_dwordx4 v[208:211], v1, s[32:35], s70 offen offset:2048 sc0 sc1
    buffer_store_dwordx4 v[212:215], v1, s[32:35], s70 offen offset:3072 sc0 sc1
    s_add_u32 s70, s70, 8192
    v_cvt_pk_bf16_f32 v216, v160, v161
    v_cvt_pk_bf16_f32 v217, v162, v163
    v_cvt_pk_bf16_f32 v218, v164, v165
    v_cvt_pk_bf16_f32 v219, v166, v167
    v_cvt_pk_bf16_f32 v220, v168, v169
    v_cvt_pk_bf16_f32 v221, v170, v171
    v_cvt_pk_bf16_f32 v222, v172, v173
    v_cvt_pk_bf16_f32 v223, v174, v175
    buffer_store_dwordx4 v[216:219], v1, s[32:35], s70 offen offset:0 sc0 sc1
    buffer_store_dwordx4 v[220:223], v1, s[32:35], s70 offen offset:1024 sc0 sc1
    v_cvt_pk_bf16_f32 v224, v176, v177
    v_cvt_pk_bf16_f32 v225, v178, v179
    v_cvt_pk_bf16_f32 v226, v180, v181
    v_cvt_pk_bf16_f32 v227, v182, v183
    v_cvt_pk_bf16_f32 v228, v184, v185
    v_cvt_pk_bf16_f32 v229, v186, v187
    v_cvt_pk_bf16_f32 v230, v188, v189
    v_cvt_pk_bf16_f32 v231, v190, v191
    buffer_store_dwordx4 v[224:227], v1, s[32:35], s70 offen offset:2048 sc0 sc1
    buffer_store_dwordx4 v[228:231], v1, s[32:35], s70 offen offset:3072 sc0 sc1
p1e_join_16:
    s_add_u32 s24, s4, 0x1000000
    s_addc_u32 s25, s5, 0
    s_mov_b32 s26, 0x1000000
    s_mov_b32 s27, 0x00020000
    s_add_u32 s28, s4, 0x2000000
    s_addc_u32 s29, s5, 0
    s_mov_b32 s30, 0x1000000
    s_mov_b32 s31, 0x00020000
    s_add_u32 s32, s4, 0x3000000
    s_addc_u32 s33, s5, 0
    s_mov_b32 s34, 0x700000
    s_mov_b32 s35, 0x00020000
    s_add_u32 s36, s4, 0x4000000
    s_addc_u32 s37, s5, 0
    s_mov_b32 s38, 0x1000000
    s_mov_b32 s39, 0x00020000
    v_mov_b32 v4, 0
    v_mov_b32 v5, 1
    s_waitcnt vmcnt(21)
    s_barrier
    ds_read_b64_tr_b16 v[8:9], v196 offset:0
    ds_read_b64_tr_b16 v[10:11], v196 offset:1024
    ds_read_b128 v[20:23], v194 offset:0
    ds_read_b128 v[24:27], v194 offset:2048
    ds_read_b64_tr_b16 v[12:13], v196 offset:8192
    ds_read_b64_tr_b16 v[14:15], v196 offset:9216
    ds_read_b64_tr_b16 v[16:17], v196 offset:16384
    ds_read_b64_tr_b16 v[18:19], v196 offset:17408
    ds_read_b128 v[28:31], v194 offset:8192
    ds_read_b128 v[32:35], v194 offset:10240
    s_waitcnt lgkmcnt(7)
    v_mfma_f32_32x32x16_bf16 v[64:79], v[8:11], v[20:23], 0
    ds_read_b64_tr_b16 v[36:37], v196 offset:4096
    ds_read_b64_tr_b16 v[38:39], v196 offset:5120
    s_waitcnt lgkmcnt(8)
    v_mfma_f32_32x32x16_bf16 v[80:95], v[8:11], v[24:27], 0
    ds_read_b128 v[48:51], v194 offset:1024
    ds_read_b128 v[52:55], v194 offset:3072
    s_add_u32 m0, s56, 122880
    s_add_u32 s67, s47, 6144
    buffer_load_dwordx4 v1, s[8:11], s67 offen sc1 lds
    s_waitcnt lgkmcnt(8)
    v_mfma_f32_32x32x16_bf16 v[96:111], v[12:15], v[20:23], 0
    ds_read_b64_tr_b16 v[40:41], v196 offset:12288
    v_mfma_f32_32x32x16_bf16 v[112:127], v[12:15], v[24:27], 0
    ds_read_b64_tr_b16 v[42:43], v196 offset:13312
    s_waitcnt lgkmcnt(8)
    v_mfma_f32_32x32x16_bf16 v[128:143], v[16:19], v[20:23], 0
    ds_read_b64_tr_b16 v[44:45], v196 offset:20480
    buffer_load_dwordx4 v1, s[8:11], s67 offen offset:1024 sc1 lds
    v_mfma_f32_32x32x16_bf16 v[144:159], v[16:19], v[24:27], 0
    ds_read_b64_tr_b16 v[46:47], v196 offset:21504
    s_waitcnt lgkmcnt(9)
    v_mfma_f32_32x32x16_bf16 v[160:175], v[16:19], v[28:31], 0
    ds_read_b128 v[56:59], v194 offset:9216
    s_waitcnt lgkmcnt(9)
    v_mfma_f32_32x32x16_bf16 v[176:191], v[16:19], v[32:35], 0
    ds_read_b128 v[60:63], v194 offset:11264
    s_add_u32 m0, s50, 139264
    s_add_u32 s68, s48, 344064
    buffer_load_dwordx4 v192, s[12:15], s68 offen lds
    s_waitcnt lgkmcnt(7)
    v_mfma_f32_32x32x16_bf16 v[64:79], v[36:39], v[48:51], v[64:79]
    ds_read_b64_tr_b16 v[8:9], v196 offset:40960
    ds_read_b64_tr_b16 v[10:11], v196 offset:41984
    s_waitcnt lgkmcnt(8)
    v_mfma_f32_32x32x16_bf16 v[80:95], v[36:39], v[52:55], v[80:95]
    ds_read_b128 v[20:23], v194 offset:40960
    ds_read_b128 v[24:27], v194 offset:43008
    s_waitcnt lgkmcnt(8)
    v_mfma_f32_32x32x16_bf16 v[96:111], v[40:43], v[48:51], v[96:111]
    ds_read_b64_tr_b16 v[12:13], v196 offset:49152
    s_add_u32 m0, s50, 147456
    s_add_u32 s69, s49, 786432
    buffer_load_dwordx4 v192, s[16:19], s68 offen lds
    v_mfma_f32_32x32x16_bf16 v[112:127], v[40:43], v[52:55], v[112:127]
    ds_read_b64_tr_b16 v[14:15], v196 offset:50176
    s_waitcnt lgkmcnt(8)
    v_mfma_f32_32x32x16_bf16 v[128:143], v[44:47], v[48:51], v[128:143]
    ds_read_b64_tr_b16 v[16:17], v196 offset:57344
    v_mfma_f32_32x32x16_bf16 v[144:159], v[44:47], v[52:55], v[144:159]
    ds_read_b64_tr_b16 v[18:19], v196 offset:58368
    s_add_u32 m0, s50, 155648
    s_nop 0
    buffer_load_dwordx4 v193, s[20:23], s69 offen lds
    s_waitcnt lgkmcnt(9)
    v_mfma_f32_32x32x16_bf16 v[160:175], v[44:47], v[56:59], v[160:175]
    ds_read_b128 v[28:31], v194 offset:49152
    s_waitcnt lgkmcnt(9)
    v_mfma_f32_32x32x16_bf16 v[176:191], v[44:47], v[60:63], v[176:191]
    ds_read_b128 v[32:35], v194 offset:51200
    s_waitcnt vmcnt(21)
    s_barrier
    s_waitcnt lgkmcnt(7)
    v_mfma_f32_32x32x16_bf16 v[64:79], v[8:11], v[20:23], v[64:79]
    ds_read_b64_tr_b16 v[36:37], v196 offset:45056
    ds_read_b64_tr_b16 v[38:39], v196 offset:46080
    s_waitcnt lgkmcnt(8)
    v_mfma_f32_32x32x16_bf16 v[80:95], v[8:11], v[24:27], v[80:95]
    ds_read_b128 v[48:51], v194 offset:41984
    ds_read_b128 v[52:55], v194 offset:44032
    s_add_u32 m0, s56, 0
    s_add_u32 s67, s47, 8192
    buffer_load_dwordx4 v1, s[8:11], s67 offen sc1 lds
    s_waitcnt lgkmcnt(8)
    v_mfma_f32_32x32x16_bf16 v[96:111], v[12:15], v[20:23], v[96:111]
    ds_read_b64_tr_b16 v[40:41], v196 offset:53248
    v_mfma_f32_32x32x16_bf16 v[112:127], v[12:15], v[24:27], v[112:127]
    ds_read_b64_tr_b16 v[42:43], v196 offset:54272
    s_waitcnt lgkmcnt(8)
    v_mfma_f32_32x32x16_bf16 v[128:143], v[16:19], v[20:23], v[128:143]
    ds_read_b64_tr_b16 v[44:45], v196 offset:61440
    buffer_load_dwordx4 v1, s[8:11], s67 offen offset:1024 sc1 lds
    v_mfma_f32_32x32x16_bf16 v[144:159], v[16:19], v[24:27], v[144:159]
    ds_read_b64_tr_b16 v[46:47], v196 offset:62464
    s_waitcnt lgkmcnt(9)
    v_mfma_f32_32x32x16_bf16 v[160:175], v[16:19], v[28:31], v[160:175]
    ds_read_b128 v[56:59], v194 offset:50176
    s_waitcnt lgkmcnt(9)
    v_mfma_f32_32x32x16_bf16 v[176:191], v[16:19], v[32:35], v[176:191]
    ds_read_b128 v[60:63], v194 offset:52224
    s_add_u32 m0, s50, 16384
    s_add_u32 s68, s48, 458752
    buffer_load_dwordx4 v192, s[12:15], s68 offen lds
    s_waitcnt lgkmcnt(7)
    v_mfma_f32_32x32x16_bf16 v[64:79], v[36:39], v[48:51], v[64:79]
    ds_read_b64_tr_b16 v[8:9], v197 offset:0
    ds_read_b64_tr_b16 v[10:11], v197 offset:1024
    s_waitcnt lgkmcnt(8)
    v_mfma_f32_32x32x16_bf16 v[80:95], v[36:39], v[52:55], v[80:95]
    ds_read_b128 v[20:23], v195 offset:0
    ds_read_b128 v[24:27], v195 offset:2048
    s_waitcnt lgkmcnt(8)
    v_mfma_f32_32x32x16_bf16 v[96:111], v[40:43], v[48:51], v[96:111]
    ds_read_b64_tr_b16 v[12:13], v197 offset:8192
    s_add_u32 m0, s50, 24576
    s_add_u32 s69, s49, 1048576
    buffer_load_dwordx4 v192, s[16:19], s68 offen lds
    v_mfma_f32_32x32x16_bf16 v[112:127], v[40:43], v[52:55], v[112:127]
    ds_read_b64_tr_b16 v[14:15], v197 offset:9216
    s_waitcnt lgkmcnt(8)
    v_mfma_f32_32x32x16_bf16 v[128:143], v[44:47], v[48:51], v[128:143]
    ds_read_b64_tr_b16 v[16:17], v197 offset:16384
    v_mfma_f32_32x32x16_bf16 v[144:159], v[44:47], v[52:55], v[144:159]
    ds_read_b64_tr_b16 v[18:19], v197 offset:17408
    s_add_u32 m0, s50, 32768
    s_nop 0
    buffer_load_dwordx4 v193, s[20:23], s69 offen lds
    s_waitcnt lgkmcnt(9)
    v_mfma_f32_32x32x16_bf16 v[160:175], v[44:47], v[56:59], v[160:175]
    ds_read_b128 v[28:31], v195 offset:8192
    s_waitcnt lgkmcnt(9)
    v_mfma_f32_32x32x16_bf16 v[176:191], v[44:47], v[60:63], v[176:191]
    ds_read_b128 v[32:35], v195 offset:10240
    s_waitcnt vmcnt(5)
    s_barrier
    s_cmp_lg_u32 s40, 7
    s_cbranch_scc1 p2_ns_17
    s_or_b32 s70, s74, 0x20
    v_mov_b32 v5, s70
    s_mov_b64 exec, 1
    buffer_store_byte v5, v4, s[76:79], s2 offen sc0 sc1
    s_mov_b64 exec, -1
p2_ns_17:
    s_waitcnt lgkmcnt(7)
    v_mfma_f32_32x32x16_bf16 v[64:79], v[8:11], v[20:23], v[64:79]
    ds_read_b64_tr_b16 v[36:37], v197 offset:4096
    ds_read_b64_tr_b16 v[38:39], v197 offset:5120
    s_waitcnt lgkmcnt(8)
    v_mfma_f32_32x32x16_bf16 v[80:95], v[8:11], v[24:27], v[80:95]
    ds_read_b128 v[48:51], v195 offset:1024
    ds_read_b128 v[52:55], v195 offset:3072
    s_add_u32 m0, s56, 40960
    s_add_u32 s67, s47, 10240
    buffer_load_dwordx4 v1, s[8:11], s67 offen sc1 lds
    s_waitcnt lgkmcnt(8)
    v_mfma_f32_32x32x16_bf16 v[96:111], v[12:15], v[20:23], v[96:111]
    ds_read_b64_tr_b16 v[40:41], v197 offset:12288
    v_mfma_f32_32x32x16_bf16 v[112:127], v[12:15], v[24:27], v[112:127]
    ds_read_b64_tr_b16 v[42:43], v197 offset:13312
    s_waitcnt lgkmcnt(8)
    v_mfma_f32_32x32x16_bf16 v[128:143], v[16:19], v[20:23], v[128:143]
    ds_read_b64_tr_b16 v[44:45], v197 offset:20480
    buffer_load_dwordx4 v1, s[8:11], s67 offen offset:1024 sc1 lds
    v_mfma_f32_32x32x16_bf16 v[144:159], v[16:19], v[24:27], v[144:159]
    ds_read_b64_tr_b16 v[46:47], v197 offset:21504
    s_waitcnt lgkmcnt(9)
    v_mfma_f32_32x32x16_bf16 v[160:175], v[16:19], v[28:31], v[160:175]
    ds_read_b128 v[56:59], v195 offset:9216
    s_waitcnt lgkmcnt(9)
    v_mfma_f32_32x32x16_bf16 v[176:191], v[16:19], v[32:35], v[176:191]
    ds_read_b128 v[60:63], v195 offset:11264
    s_add_u32 m0, s50, 57344
    s_add_u32 s68, s48, 573440
    buffer_load_dwordx4 v192, s[12:15], s68 offen lds
    s_waitcnt lgkmcnt(7)
    v_mfma_f32_32x32x16_bf16 v[64:79], v[36:39], v[48:51], v[64:79]
    ds_read_b64_tr_b16 v[8:9], v197 offset:40960
    ds_read_b64_tr_b16 v[10:11], v197 offset:41984
    s_waitcnt lgkmcnt(8)
    v_mfma_f32_32x32x16_bf16 v[80:95], v[36:39], v[52:55], v[80:95]
    ds_read_b128 v[20:23], v195 offset:40960
    ds_read_b128 v[24:27], v195 offset:43008
    s_waitcnt lgkmcnt(8)
    v_mfma_f32_32x32x16_bf16 v[96:111], v[40:43], v[48:51], v[96:111]
    ds_read_b64_tr_b16 v[12:13], v197 offset:49152
    s_add_u32 m0, s50, 65536
    s_add_u32 s69, s49, 1310720
    buffer_load_dwordx4 v192, s[16:19], s68 offen lds
    v_mfma_f32_32x32x16_bf16 v[112:127], v[40:43], v[52:55], v[112:127]
    ds_read_b64_tr_b16 v[14:15], v197 offset:50176
    s_waitcnt lgkmcnt(8)
    v_mfma_f32_32x32x16_bf16 v[128:143], v[44:47], v[48:51], v[128:143]
    ds_read_b64_tr_b16 v[16:17], v197 offset:57344
    v_mfma_f32_32x32x16_bf16 v[144:159], v[44:47], v[52:55], v[144:159]
    ds_read_b64_tr_b16 v[18:19], v197 offset:58368
    s_add_u32 m0, s50, 73728
    s_nop 0
    buffer_load_dwordx4 v193, s[20:23], s69 offen lds
    s_waitcnt lgkmcnt(9)
    v_mfma_f32_32x32x16_bf16 v[160:175], v[44:47], v[56:59], v[160:175]
    ds_read_b128 v[28:31], v195 offset:49152
    s_waitcnt lgkmcnt(9)
    v_mfma_f32_32x32x16_bf16 v[176:191], v[44:47], v[60:63], v[176:191]
    ds_read_b128 v[32:35], v195 offset:51200
    s_waitcnt vmcnt(5)
    s_barrier
    s_waitcnt lgkmcnt(7)
    v_mfma_f32_32x32x16_bf16 v[64:79], v[8:11], v[20:23], v[64:79]
    ds_read_b64_tr_b16 v[36:37], v197 offset:45056
    ds_read_b64_tr_b16 v[38:39], v197 offset:46080
    s_waitcnt lgkmcnt(8)
    v_mfma_f32_32x32x16_bf16 v[80:95], v[8:11], v[24:27], v[80:95]
    ds_read_b128 v[48:51], v195 offset:41984
    ds_read_b128 v[52:55], v195 offset:44032
    s_add_u32 m0, s56, 81920
    s_add_u32 s67, s47, 12288
    buffer_load_dwordx4 v1, s[8:11], s67 offen sc1 lds
    s_waitcnt lgkmcnt(8)
    v_mfma_f32_32x32x16_bf16 v[96:111], v[12:15], v[20:23], v[96:111]
    ds_read_b64_tr_b16 v[40:41], v197 offset:53248
    v_mfma_f32_32x32x16_bf16 v[112:127], v[12:15], v[24:27], v[112:127]
    ds_read_b64_tr_b16 v[42:43], v197 offset:54272
    s_waitcnt lgkmcnt(8)
    v_mfma_f32_32x32x16_bf16 v[128:143], v[16:19], v[20:23], v[128:143]
    ds_read_b64_tr_b16 v[44:45], v197 offset:61440
    buffer_load_dwordx4 v1, s[8:11], s67 offen offset:1024 sc1 lds
    v_mfma_f32_32x32x16_bf16 v[144:159], v[16:19], v[24:27], v[144:159]
    ds_read_b64_tr_b16 v[46:47], v197 offset:62464
    s_waitcnt lgkmcnt(9)
    v_mfma_f32_32x32x16_bf16 v[160:175], v[16:19], v[28:31], v[160:175]
    ds_read_b128 v[56:59], v195 offset:50176
    s_waitcnt lgkmcnt(9)
    v_mfma_f32_32x32x16_bf16 v[176:191], v[16:19], v[32:35], v[176:191]
    ds_read_b128 v[60:63], v195 offset:52224
    s_add_u32 m0, s50, 98304
    s_add_u32 s68, s48, 688128
    buffer_load_dwordx4 v192, s[12:15], s68 offen lds
    s_waitcnt lgkmcnt(7)
    v_mfma_f32_32x32x16_bf16 v[64:79], v[36:39], v[48:51], v[64:79]
    ds_read_b64_tr_b16 v[8:9], v196 offset:0
    ds_read_b64_tr_b16 v[10:11], v196 offset:1024
    s_waitcnt lgkmcnt(8)
    v_mfma_f32_32x32x16_bf16 v[80:95], v[36:39], v[52:55], v[80:95]
    ds_read_b128 v[20:23], v194 offset:0
    ds_read_b128 v[24:27], v194 offset:2048
    s_waitcnt lgkmcnt(8)
    v_mfma_f32_32x32x16_bf16 v[96:111], v[40:43], v[48:51], v[96:111]
    ds_read_b64_tr_b16 v[12:13], v196 offset:8192
    s_add_u32 m0, s50, 106496
    s_add_u32 s69, s49, 1572864
    buffer_load_dwordx4 v192, s[16:19], s68 offen lds
    v_mfma_f32_32x32x16_bf16 v[112:127], v[40:43], v[52:55], v[112:127]
    ds_read_b64_tr_b16 v[14:15], v196 offset:9216
    s_waitcnt lgkmcnt(8)
    v_mfma_f32_32x32x16_bf16 v[128:143], v[44:47], v[48:51], v[128:143]
    ds_read_b64_tr_b16 v[16:17], v196 offset:16384
    v_mfma_f32_32x32x16_bf16 v[144:159], v[44:47], v[52:55], v[144:159]
    ds_read_b64_tr_b16 v[18:19], v196 offset:17408
    s_add_u32 m0, s50, 114688
    s_nop 0
    buffer_load_dwordx4 v193, s[20:23], s69 offen lds
    s_waitcnt lgkmcnt(9)
    v_mfma_f32_32x32x16_bf16 v[160:175], v[44:47], v[56:59], v[160:175]
    ds_read_b128 v[28:31], v194 offset:8192
    s_waitcnt lgkmcnt(9)
    v_mfma_f32_32x32x16_bf16 v[176:191], v[44:47], v[60:63], v[176:191]
    ds_read_b128 v[32:35], v194 offset:10240
    s_waitcnt vmcnt(5)
    s_barrier
    s_waitcnt lgkmcnt(7)
    v_mfma_f32_32x32x16_bf16 v[64:79], v[8:11], v[20:23], v[64:79]
    ds_read_b64_tr_b16 v[36:37], v196 offset:4096
    ds_read_b64_tr_b16 v[38:39], v196 offset:5120
    s_waitcnt lgkmcnt(8)
    v_mfma_f32_32x32x16_bf16 v[80:95], v[8:11], v[24:27], v[80:95]
    ds_read_b128 v[48:51], v194 offset:1024
    ds_read_b128 v[52:55], v194 offset:3072
    s_add_u32 m0, s56, 122880
    s_add_u32 s67, s47, 14336
    buffer_load_dwordx4 v1, s[8:11], s67 offen sc1 lds
    s_waitcnt lgkmcnt(8)
    v_mfma_f32_32x32x16_bf16 v[96:111], v[12:15], v[20:23], v[96:111]
    ds_read_b64_tr_b16 v[40:41], v196 offset:12288
    v_mfma_f32_32x32x16_bf16 v[112:127], v[12:15], v[24:27], v[112:127]
    ds_read_b64_tr_b16 v[42:43], v196 offset:13312
    s_waitcnt lgkmcnt(8)
    v_mfma_f32_32x32x16_bf16 v[128:143], v[16:19], v[20:23], v[128:143]
    ds_read_b64_tr_b16 v[44:45], v196 offset:20480
    buffer_load_dwordx4 v1, s[8:11], s67 offen offset:1024 sc1 lds
    v_mfma_f32_32x32x16_bf16 v[144:159], v[16:19], v[24:27], v[144:159]
    ds_read_b64_tr_b16 v[46:47], v196 offset:21504
    s_waitcnt lgkmcnt(9)
    v_mfma_f32_32x32x16_bf16 v[160:175], v[16:19], v[28:31], v[160:175]
    ds_read_b128 v[56:59], v194 offset:9216
    s_waitcnt lgkmcnt(9)
    v_mfma_f32_32x32x16_bf16 v[176:191], v[16:19], v[32:35], v[176:191]
    ds_read_b128 v[60:63], v194 offset:11264
    s_add_u32 m0, s50, 139264
    s_add_u32 s68, s48, 802816
    buffer_load_dwordx4 v192, s[12:15], s68 offen lds
    s_waitcnt lgkmcnt(7)
    v_mfma_f32_32x32x16_bf16 v[64:79], v[36:39], v[48:51], v[64:79]
    ds_read_b64_tr_b16 v[8:9], v196 offset:40960
    ds_read_b64_tr_b16 v[10:11], v196 offset:41984
    s_waitcnt lgkmcnt(8)
    v_mfma_f32_32x32x16_bf16 v[80:95], v[36:39], v[52:55], v[80:95]
    ds_read_b128 v[20:23], v194 offset:40960
    ds_read_b128 v[24:27], v194 offset:43008
    s_waitcnt lgkmcnt(8)
    v_mfma_f32_32x32x16_bf16 v[96:111], v[40:43], v[48:51], v[96:111]
    ds_read_b64_tr_b16 v[12:13], v196 offset:49152
    s_add_u32 m0, s50, 147456
    s_add_u32 s69, s49, 1835008
    buffer_load_dwordx4 v192, s[16:19], s68 offen lds
    v_mfma_f32_32x32x16_bf16 v[112:127], v[40:43], v[52:55], v[112:127]
    ds_read_b64_tr_b16 v[14:15], v196 offset:50176
    s_waitcnt lgkmcnt(8)
    v_mfma_f32_32x32x16_bf16 v[128:143], v[44:47], v[48:51], v[128:143]
    ds_read_b64_tr_b16 v[16:17], v196 offset:57344
    v_mfma_f32_32x32x16_bf16 v[144:159], v[44:47], v[52:55], v[144:159]
    ds_read_b64_tr_b16 v[18:19], v196 offset:58368
    s_add_u32 m0, s50, 155648
    s_nop 0
    buffer_load_dwordx4 v193, s[20:23], s69 offen lds
    s_waitcnt lgkmcnt(9)
    v_mfma_f32_32x32x16_bf16 v[160:175], v[44:47], v[56:59], v[160:175]
    ds_read_b128 v[28:31], v194 offset:49152
    s_waitcnt lgkmcnt(9)
    v_mfma_f32_32x32x16_bf16 v[176:191], v[44:47], v[60:63], v[176:191]
    ds_read_b128 v[32:35], v194 offset:51200
    s_waitcnt vmcnt(5)
    s_barrier
    s_waitcnt lgkmcnt(7)
    v_mfma_f32_32x32x16_bf16 v[64:79], v[8:11], v[20:23], v[64:79]
    ds_read_b64_tr_b16 v[36:37], v196 offset:45056
    ds_read_b64_tr_b16 v[38:39], v196 offset:46080
    s_waitcnt lgkmcnt(8)
    v_mfma_f32_32x32x16_bf16 v[80:95], v[8:11], v[24:27], v[80:95]
    ds_read_b128 v[48:51], v194 offset:41984
    ds_read_b128 v[52:55], v194 offset:44032
    s_add_u32 m0, s56, 0
    s_add_u32 s67, s47, 16384
    buffer_load_dwordx4 v1, s[8:11], s67 offen sc1 lds
    s_waitcnt lgkmcnt(8)
    v_mfma_f32_32x32x16_bf16 v[96:111], v[12:15], v[20:23], v[96:111]
    ds_read_b64_tr_b16 v[40:41], v196 offset:53248
    v_mfma_f32_32x32x16_bf16 v[112:127], v[12:15], v[24:27], v[112:127]
    ds_read_b64_tr_b16 v[42:43], v196 offset:54272
    s_waitcnt lgkmcnt(8)
    v_mfma_f32_32x32x16_bf16 v[128:143], v[16:19], v[20:23], v[128:143]
    ds_read_b64_tr_b16 v[44:45], v196 offset:61440
    buffer_load_dwordx4 v1, s[8:11], s67 offen offset:1024 sc1 lds
    v_mfma_f32_32x32x16_bf16 v[144:159], v[16:19], v[24:27], v[144:159]
    ds_read_b64_tr_b16 v[46:47], v196 offset:62464
    s_waitcnt lgkmcnt(9)
    v_mfma_f32_32x32x16_bf16 v[160:175], v[16:19], v[28:31], v[160:175]
    ds_read_b128 v[56:59], v194 offset:50176
    s_waitcnt lgkmcnt(9)
    v_mfma_f32_32x32x16_bf16 v[176:191], v[16:19], v[32:35], v[176:191]
    ds_read_b128 v[60:63], v194 offset:52224
    s_add_u32 m0, s50, 16384
    s_add_u32 s68, s48, 917504
    buffer_load_dwordx4 v192, s[12:15], s68 offen lds
    s_waitcnt lgkmcnt(7)
    v_mfma_f32_32x32x16_bf16 v[64:79], v[36:39], v[48:51], v[64:79]
    ds_read_b64_tr_b16 v[8:9], v197 offset:0
    ds_read_b64_tr_b16 v[10:11], v197 offset:1024
    s_waitcnt lgkmcnt(8)
    v_mfma_f32_32x32x16_bf16 v[80:95], v[36:39], v[52:55], v[80:95]
    ds_read_b128 v[20:23], v195 offset:0
    ds_read_b128 v[24:27], v195 offset:2048
    s_waitcnt lgkmcnt(8)
    v_mfma_f32_32x32x16_bf16 v[96:111], v[40:43], v[48:51], v[96:111]
    ds_read_b64_tr_b16 v[12:13], v197 offset:8192
    s_add_u32 m0, s50, 24576
    s_add_u32 s69, s49, 2097152
    buffer_load_dwordx4 v192, s[16:19], s68 offen lds
    v_mfma_f32_32x32x16_bf16 v[112:127], v[40:43], v[52:55], v[112:127]
    ds_read_b64_tr_b16 v[14:15], v197 offset:9216
    s_waitcnt lgkmcnt(8)
    v_mfma_f32_32x32x16_bf16 v[128:143], v[44:47], v[48:51], v[128:143]
    ds_read_b64_tr_b16 v[16:17], v197 offset:16384
    v_mfma_f32_32x32x16_bf16 v[144:159], v[44:47], v[52:55], v[144:159]
    ds_read_b64_tr_b16 v[18:19], v197 offset:17408
    s_add_u32 m0, s50, 32768
    s_nop 0
    buffer_load_dwordx4 v193, s[20:23], s69 offen lds
    s_waitcnt lgkmcnt(9)
    v_mfma_f32_32x32x16_bf16 v[160:175], v[44:47], v[56:59], v[160:175]
    ds_read_b128 v[28:31], v195 offset:8192
    s_waitcnt lgkmcnt(9)
    v_mfma_f32_32x32x16_bf16 v[176:191], v[44:47], v[60:63], v[176:191]
    ds_read_b128 v[32:35], v195 offset:10240
    s_waitcnt vmcnt(5)
    s_barrier
    s_waitcnt lgkmcnt(7)
    v_mfma_f32_32x32x16_bf16 v[64:79], v[8:11], v[20:23], v[64:79]
    ds_read_b64_tr_b16 v[36:37], v197 offset:4096
    ds_read_b64_tr_b16 v[38:39], v197 offset:5120
    s_waitcnt lgkmcnt(8)
    v_mfma_f32_32x32x16_bf16 v[80:95], v[8:11], v[24:27], v[80:95]
    ds_read_b128 v[48:51], v195 offset:1024
    ds_read_b128 v[52:55], v195 offset:3072
    s_add_u32 m0, s56, 40960
    s_add_u32 s67, s47, 18432
    buffer_load_dwordx4 v1, s[8:11], s67 offen sc1 lds
    s_waitcnt lgkmcnt(8)
    v_mfma_f32_32x32x16_bf16 v[96:111], v[12:15], v[20:23], v[96:111]
    ds_read_b64_tr_b16 v[40:41], v197 offset:12288
    v_mfma_f32_32x32x16_bf16 v[112:127], v[12:15], v[24:27], v[112:127]
    ds_read_b64_tr_b16 v[42:43], v197 offset:13312
    s_waitcnt lgkmcnt(8)
    v_mfma_f32_32x32x16_bf16 v[128:143], v[16:19], v[20:23], v[128:143]
    ds_read_b64_tr_b16 v[44:45], v197 offset:20480
    buffer_load_dwordx4 v1, s[8:11], s67 offen offset:1024 sc1 lds
    v_mfma_f32_32x32x16_bf16 v[144:159], v[16:19], v[24:27], v[144:159]
    ds_read_b64_tr_b16 v[46:47], v197 offset:21504
    s_waitcnt lgkmcnt(9)
    v_mfma_f32_32x32x16_bf16 v[160:175], v[16:19], v[28:31], v[160:175]
    ds_read_b128 v[56:59], v195 offset:9216
    s_waitcnt lgkmcnt(9)
    v_mfma_f32_32x32x16_bf16 v[176:191], v[16:19], v[32:35], v[176:191]
    ds_read_b128 v[60:63], v195 offset:11264
    s_add_u32 m0, s50, 57344
    s_add_u32 s68, s48, 1032192
    buffer_load_dwordx4 v192, s[12:15], s68 offen lds
    s_waitcnt lgkmcnt(7)
    v_mfma_f32_32x32x16_bf16 v[64:79], v[36:39], v[48:51], v[64:79]
    ds_read_b64_tr_b16 v[8:9], v197 offset:40960
    ds_read_b64_tr_b16 v[10:11], v197 offset:41984
    s_waitcnt lgkmcnt(8)
    v_mfma_f32_32x32x16_bf16 v[80:95], v[36:39], v[52:55], v[80:95]
    ds_read_b128 v[20:23], v195 offset:40960
    ds_read_b128 v[24:27], v195 offset:43008
    s_waitcnt lgkmcnt(8)
    v_mfma_f32_32x32x16_bf16 v[96:111], v[40:43], v[48:51], v[96:111]
    ds_read_b64_tr_b16 v[12:13], v197 offset:49152
    s_add_u32 m0, s50, 65536
    s_add_u32 s69, s49, 2359296
    buffer_load_dwordx4 v192, s[16:19], s68 offen lds
    v_mfma_f32_32x32x16_bf16 v[112:127], v[40:43], v[52:55], v[112:127]
    ds_read_b64_tr_b16 v[14:15], v197 offset:50176
    s_waitcnt lgkmcnt(8)
    v_mfma_f32_32x32x16_bf16 v[128:143], v[44:47], v[48:51], v[128:143]
    ds_read_b64_tr_b16 v[16:17], v197 offset:57344
    v_mfma_f32_32x32x16_bf16 v[144:159], v[44:47], v[52:55], v[144:159]
    ds_read_b64_tr_b16 v[18:19], v197 offset:58368
    s_add_u32 m0, s50, 73728
    s_nop 0
    buffer_load_dwordx4 v193, s[20:23], s69 offen lds
    s_waitcnt lgkmcnt(9)
    v_mfma_f32_32x32x16_bf16 v[160:175], v[44:47], v[56:59], v[160:175]
    ds_read_b128 v[28:31], v195 offset:49152
    s_waitcnt lgkmcnt(9)
    v_mfma_f32_32x32x16_bf16 v[176:191], v[44:47], v[60:63], v[176:191]
    ds_read_b128 v[32:35], v195 offset:51200
    s_waitcnt vmcnt(5)
    s_barrier
    s_waitcnt lgkmcnt(7)
    v_mfma_f32_32x32x16_bf16 v[64:79], v[8:11], v[20:23], v[64:79]
    ds_read_b64_tr_b16 v[36:37], v197 offset:45056
    ds_read_b64_tr_b16 v[38:39], v197 offset:46080
    s_waitcnt lgkmcnt(8)
    v_mfma_f32_32x32x16_bf16 v[80:95], v[8:11], v[24:27], v[80:95]
    ds_read_b128 v[48:51], v195 offset:41984
    ds_read_b128 v[52:55], v195 offset:44032
    s_add_u32 m0, s56, 81920
    s_add_u32 s67, s47, 20480
    buffer_load_dwordx4 v1, s[8:11], s67 offen sc1 lds
    s_waitcnt lgkmcnt(8)
    v_mfma_f32_32x32x16_bf16 v[96:111], v[12:15], v[20:23], v[96:111]
    ds_read_b64_tr_b16 v[40:41], v197 offset:53248
    v_mfma_f32_32x32x16_bf16 v[112:127], v[12:15], v[24:27], v[112:127]
    ds_read_b64_tr_b16 v[42:43], v197 offset:54272
    s_waitcnt lgkmcnt(8)
    v_mfma_f32_32x32x16_bf16 v[128:143], v[16:19], v[20:23], v[128:143]
    ds_read_b64_tr_b16 v[44:45], v197 offset:61440
    buffer_load_dwordx4 v1, s[8:11], s67 offen offset:1024 sc1 lds
    v_mfma_f32_32x32x16_bf16 v[144:159], v[16:19], v[24:27], v[144:159]
    ds_read_b64_tr_b16 v[46:47], v197 offset:62464
    s_waitcnt lgkmcnt(9)
    v_mfma_f32_32x32x16_bf16 v[160:175], v[16:19], v[28:31], v[160:175]
    ds_read_b128 v[56:59], v195 offset:50176
    s_waitcnt lgkmcnt(9)
    v_mfma_f32_32x32x16_bf16 v[176:191], v[16:19], v[32:35], v[176:191]
    ds_read_b128 v[60:63], v195 offset:52224
    s_add_u32 m0, s50, 98304
    s_add_u32 s68, s48, 1146880
    buffer_load_dwordx4 v192, s[12:15], s68 offen lds
    s_waitcnt lgkmcnt(7)
    v_mfma_f32_32x32x16_bf16 v[64:79], v[36:39], v[48:51], v[64:79]
    ds_read_b64_tr_b16 v[8:9], v196 offset:0
    ds_read_b64_tr_b16 v[10:11], v196 offset:1024
    s_waitcnt lgkmcnt(8)
    v_mfma_f32_32x32x16_bf16 v[80:95], v[36:39], v[52:55], v[80:95]
    ds_read_b128 v[20:23], v194 offset:0
    ds_read_b128 v[24:27], v194 offset:2048
    s_waitcnt lgkmcnt(8)
    v_mfma_f32_32x32x16_bf16 v[96:111], v[40:43], v[48:51], v[96:111]
    ds_read_b64_tr_b16 v[12:13], v196 offset:8192
    s_add_u32 m0, s50, 106496
    s_add_u32 s69, s49, 2621440
    buffer_load_dwordx4 v192, s[16:19], s68 offen lds
    v_mfma_f32_32x32x16_bf16 v[112:127], v[40:43], v[52:55], v[112:127]
    ds_read_b64_tr_b16 v[14:15], v196 offset:9216
    s_waitcnt lgkmcnt(8)
    v_mfma_f32_32x32x16_bf16 v[128:143], v[44:47], v[48:51], v[128:143]
    ds_read_b64_tr_b16 v[16:17], v196 offset:16384
    v_mfma_f32_32x32x16_bf16 v[144:159], v[44:47], v[52:55], v[144:159]
    ds_read_b64_tr_b16 v[18:19], v196 offset:17408
    s_add_u32 m0, s50, 114688
    s_nop 0
    buffer_load_dwordx4 v193, s[20:23], s69 offen lds
    s_waitcnt lgkmcnt(9)
    v_mfma_f32_32x32x16_bf16 v[160:175], v[44:47], v[56:59], v[160:175]
    ds_read_b128 v[28:31], v194 offset:8192
    s_waitcnt lgkmcnt(9)
    v_mfma_f32_32x32x16_bf16 v[176:191], v[44:47], v[60:63], v[176:191]
    ds_read_b128 v[32:35], v194 offset:10240
    s_waitcnt vmcnt(5)
    s_barrier
    s_waitcnt lgkmcnt(7)
    v_mfma_f32_32x32x16_bf16 v[64:79], v[8:11], v[20:23], v[64:79]
    ds_read_b64_tr_b16 v[36:37], v196 offset:4096
    ds_read_b64_tr_b16 v[38:39], v196 offset:5120
    s_waitcnt lgkmcnt(8)
    v_mfma_f32_32x32x16_bf16 v[80:95], v[8:11], v[24:27], v[80:95]
    ds_read_b128 v[48:51], v194 offset:1024
    ds_read_b128 v[52:55], v194 offset:3072
    s_add_u32 m0, s56, 122880
    s_add_u32 s67, s47, 22528
    buffer_load_dwordx4 v1, s[8:11], s67 offen sc1 lds
    s_waitcnt lgkmcnt(8)
    v_mfma_f32_32x32x16_bf16 v[96:111], v[12:15], v[20:23], v[96:111]
    ds_read_b64_tr_b16 v[40:41], v196 offset:12288
    v_mfma_f32_32x32x16_bf16 v[112:127], v[12:15], v[24:27], v[112:127]
    ds_read_b64_tr_b16 v[42:43], v196 offset:13312
    s_waitcnt lgkmcnt(8)
    v_mfma_f32_32x32x16_bf16 v[128:143], v[16:19], v[20:23], v[128:143]
    ds_read_b64_tr_b16 v[44:45], v196 offset:20480
    buffer_load_dwordx4 v1, s[8:11], s67 offen offset:1024 sc1 lds
    v_mfma_f32_32x32x16_bf16 v[144:159], v[16:19], v[24:27], v[144:159]
    ds_read_b64_tr_b16 v[46:47], v196 offset:21504
    s_waitcnt lgkmcnt(9)
    v_mfma_f32_32x32x16_bf16 v[160:175], v[16:19], v[28:31], v[160:175]
    ds_read_b128 v[56:59], v194 offset:9216
    s_waitcnt lgkmcnt(9)
    v_mfma_f32_32x32x16_bf16 v[176:191], v[16:19], v[32:35], v[176:191]
    ds_read_b128 v[60:63], v194 offset:11264
    s_add_u32 m0, s50, 139264
    s_add_u32 s68, s48, 1261568
    buffer_load_dwordx4 v192, s[12:15], s68 offen lds
    s_waitcnt lgkmcnt(7)
    v_mfma_f32_32x32x16_bf16 v[64:79], v[36:39], v[48:51], v[64:79]
    ds_read_b64_tr_b16 v[8:9], v196 offset:40960
    ds_read_b64_tr_b16 v[10:11], v196 offset:41984
    s_waitcnt lgkmcnt(8)
    v_mfma_f32_32x32x16_bf16 v[80:95], v[36:39], v[52:55], v[80:95]
    ds_read_b128 v[20:23], v194 offset:40960
    ds_read_b128 v[24:27], v194 offset:43008
    s_waitcnt lgkmcnt(8)
    v_mfma_f32_32x32x16_bf16 v[96:111], v[40:43], v[48:51], v[96:111]
    ds_read_b64_tr_b16 v[12:13], v196 offset:49152
    s_add_u32 m0, s50, 147456
    s_add_u32 s69, s49, 2883584
    buffer_load_dwordx4 v192, s[16:19], s68 offen lds
    v_mfma_f32_32x32x16_bf16 v[112:127], v[40:43], v[52:55], v[112:127]
    ds_read_b64_tr_b16 v[14:15], v196 offset:50176
    s_waitcnt lgkmcnt(8)
    v_mfma_f32_32x32x16_bf16 v[128:143], v[44:47], v[48:51], v[128:143]
    ds_read_b64_tr_b16 v[16:17], v196 offset:57344
    v_mfma_f32_32x32x16_bf16 v[144:159], v[44:47], v[52:55], v[144:159]
    ds_read_b64_tr_b16 v[18:19], v196 offset:58368
    s_add_u32 m0, s50, 155648
    s_nop 0
    buffer_load_dwordx4 v193, s[20:23], s69 offen lds
    s_waitcnt lgkmcnt(9)
    v_mfma_f32_32x32x16_bf16 v[160:175], v[44:47], v[56:59], v[160:175]
    ds_read_b128 v[28:31], v194 offset:49152
    s_waitcnt lgkmcnt(9)
    v_mfma_f32_32x32x16_bf16 v[176:191], v[44:47], v[60:63], v[176:191]
    ds_read_b128 v[32:35], v194 offset:51200
    s_waitcnt vmcnt(5)
    s_barrier
    s_waitcnt lgkmcnt(7)
    v_mfma_f32_32x32x16_bf16 v[64:79], v[8:11], v[20:23], v[64:79]
    ds_read_b64_tr_b16 v[36:37], v196 offset:45056
    ds_read_b64_tr_b16 v[38:39], v196 offset:46080
    s_waitcnt lgkmcnt(8)
    v_mfma_f32_32x32x16_bf16 v[80:95], v[8:11], v[24:27], v[80:95]
    ds_read_b128 v[48:51], v194 offset:41984
    ds_read_b128 v[52:55], v194 offset:44032
    s_add_u32 m0, s56, 0
    s_add_u32 s67, s47, 24576
    buffer_load_dwordx4 v1, s[8:11], s67 offen sc1 lds
    s_waitcnt lgkmcnt(8)
    v_mfma_f32_32x32x16_bf16 v[96:111], v[12:15], v[20:23], v[96:111]
    ds_read_b64_tr_b16 v[40:41], v196 offset:53248
    v_mfma_f32_32x32x16_bf16 v[112:127], v[12:15], v[24:27], v[112:127]
    ds_read_b64_tr_b16 v[42:43], v196 offset:54272
    s_waitcnt lgkmcnt(8)
    v_mfma_f32_32x32x16_bf16 v[128:143], v[16:19], v[20:23], v[128:143]
    ds_read_b64_tr_b16 v[44:45], v196 offset:61440
    buffer_load_dwordx4 v1, s[8:11], s67 offen offset:1024 sc1 lds
    v_mfma_f32_32x32x16_bf16 v[144:159], v[16:19], v[24:27], v[144:159]
    ds_read_b64_tr_b16 v[46:47], v196 offset:62464
    s_waitcnt lgkmcnt(9)
    v_mfma_f32_32x32x16_bf16 v[160:175], v[16:19], v[28:31], v[160:175]
    ds_read_b128 v[56:59], v194 offset:50176
    s_waitcnt lgkmcnt(9)
    v_mfma_f32_32x32x16_bf16 v[176:191], v[16:19], v[32:35], v[176:191]
    ds_read_b128 v[60:63], v194 offset:52224
    s_add_u32 m0, s50, 16384
    s_add_u32 s68, s48, 1376256
    buffer_load_dwordx4 v192, s[12:15], s68 offen lds
    s_waitcnt lgkmcnt(7)
    v_mfma_f32_32x32x16_bf16 v[64:79], v[36:39], v[48:51], v[64:79]
    ds_read_b64_tr_b16 v[8:9], v197 offset:0
    ds_read_b64_tr_b16 v[10:11], v197 offset:1024
    s_waitcnt lgkmcnt(8)
    v_mfma_f32_32x32x16_bf16 v[80:95], v[36:39], v[52:55], v[80:95]
    ds_read_b128 v[20:23], v195 offset:0
    ds_read_b128 v[24:27], v195 offset:2048
    s_waitcnt lgkmcnt(8)
    v_mfma_f32_32x32x16_bf16 v[96:111], v[40:43], v[48:51], v[96:111]
    ds_read_b64_tr_b16 v[12:13], v197 offset:8192
    s_add_u32 m0, s50, 24576
    s_add_u32 s69, s49, 3145728
    buffer_load_dwordx4 v192, s[16:19], s68 offen lds
    v_mfma_f32_32x32x16_bf16 v[112:127], v[40:43], v[52:55], v[112:127]
    ds_read_b64_tr_b16 v[14:15], v197 offset:9216
    s_waitcnt lgkmcnt(8)
    v_mfma_f32_32x32x16_bf16 v[128:143], v[44:47], v[48:51], v[128:143]
    ds_read_b64_tr_b16 v[16:17], v197 offset:16384
    v_mfma_f32_32x32x16_bf16 v[144:159], v[44:47], v[52:55], v[144:159]
    ds_read_b64_tr_b16 v[18:19], v197 offset:17408
    s_add_u32 m0, s50, 32768
    s_nop 0
    buffer_load_dwordx4 v193, s[20:23], s69 offen lds
    s_waitcnt lgkmcnt(9)
    v_mfma_f32_32x32x16_bf16 v[160:175], v[44:47], v[56:59], v[160:175]
    ds_read_b128 v[28:31], v195 offset:8192
    s_waitcnt lgkmcnt(9)
    v_mfma_f32_32x32x16_bf16 v[176:191], v[44:47], v[60:63], v[176:191]
    ds_read_b128 v[32:35], v195 offset:10240
    s_waitcnt vmcnt(5)
    s_barrier
    s_waitcnt lgkmcnt(7)
    v_mfma_f32_32x32x16_bf16 v[64:79], v[8:11], v[20:23], v[64:79]
    ds_read_b64_tr_b16 v[36:37], v197 offset:4096
    ds_read_b64_tr_b16 v[38:39], v197 offset:5120
    s_waitcnt lgkmcnt(8)
    v_mfma_f32_32x32x16_bf16 v[80:95], v[8:11], v[24:27], v[80:95]
    ds_read_b128 v[48:51], v195 offset:1024
    ds_read_b128 v[52:55], v195 offset:3072
    s_add_u32 m0, s56, 40960
    s_add_u32 s67, s47, 26624
    buffer_load_dwordx4 v1, s[8:11], s67 offen sc1 lds
    s_waitcnt lgkmcnt(8)
    v_mfma_f32_32x32x16_bf16 v[96:111], v[12:15], v[20:23], v[96:111]
    ds_read_b64_tr_b16 v[40:41], v197 offset:12288
    v_mfma_f32_32x32x16_bf16 v[112:127], v[12:15], v[24:27], v[112:127]
    ds_read_b64_tr_b16 v[42:43], v197 offset:13312
    s_waitcnt lgkmcnt(8)
    v_mfma_f32_32x32x16_bf16 v[128:143], v[16:19], v[20:23], v[128:143]
    ds_read_b64_tr_b16 v[44:45], v197 offset:20480
    buffer_load_dwordx4 v1, s[8:11], s67 offen offset:1024 sc1 lds
    v_mfma_f32_32x32x16_bf16 v[144:159], v[16:19], v[24:27], v[144:159]
    ds_read_b64_tr_b16 v[46:47], v197 offset:21504
    s_waitcnt lgkmcnt(9)
    v_mfma_f32_32x32x16_bf16 v[160:175], v[16:19], v[28:31], v[160:175]
    ds_read_b128 v[56:59], v195 offset:9216
    s_waitcnt lgkmcnt(9)
    v_mfma_f32_32x32x16_bf16 v[176:191], v[16:19], v[32:35], v[176:191]
    ds_read_b128 v[60:63], v195 offset:11264
    s_add_u32 m0, s50, 57344
    s_add_u32 s68, s48, 1490944
    buffer_load_dwordx4 v192, s[12:15], s68 offen lds
    s_waitcnt lgkmcnt(7)
    v_mfma_f32_32x32x16_bf16 v[64:79], v[36:39], v[48:51], v[64:79]
    ds_read_b64_tr_b16 v[8:9], v197 offset:40960
    ds_read_b64_tr_b16 v[10:11], v197 offset:41984
    s_waitcnt lgkmcnt(8)
    v_mfma_f32_32x32x16_bf16 v[80:95], v[36:39], v[52:55], v[80:95]
    ds_read_b128 v[20:23], v195 offset:40960
    ds_read_b128 v[24:27], v195 offset:43008
    s_waitcnt lgkmcnt(8)
    v_mfma_f32_32x32x16_bf16 v[96:111], v[40:43], v[48:51], v[96:111]
    ds_read_b64_tr_b16 v[12:13], v197 offset:49152
    s_add_u32 m0, s50, 65536
    s_add_u32 s69, s49, 3407872
    buffer_load_dwordx4 v192, s[16:19], s68 offen lds
    v_mfma_f32_32x32x16_bf16 v[112:127], v[40:43], v[52:55], v[112:127]
    ds_read_b64_tr_b16 v[14:15], v197 offset:50176
    s_waitcnt lgkmcnt(8)
    v_mfma_f32_32x32x16_bf16 v[128:143], v[44:47], v[48:51], v[128:143]
    ds_read_b64_tr_b16 v[16:17], v197 offset:57344
    v_mfma_f32_32x32x16_bf16 v[144:159], v[44:47], v[52:55], v[144:159]
    ds_read_b64_tr_b16 v[18:19], v197 offset:58368
    s_add_u32 m0, s50, 73728
    s_nop 0
    buffer_load_dwordx4 v193, s[20:23], s69 offen lds
    s_waitcnt lgkmcnt(9)
    v_mfma_f32_32x32x16_bf16 v[160:175], v[44:47], v[56:59], v[160:175]
    ds_read_b128 v[28:31], v195 offset:49152
    s_waitcnt lgkmcnt(9)
    v_mfma_f32_32x32x16_bf16 v[176:191], v[44:47], v[60:63], v[176:191]
    ds_read_b128 v[32:35], v195 offset:51200
    s_waitcnt vmcnt(5)
    s_barrier
    s_waitcnt lgkmcnt(7)
    v_mfma_f32_32x32x16_bf16 v[64:79], v[8:11], v[20:23], v[64:79]
    ds_read_b64_tr_b16 v[36:37], v197 offset:45056
    ds_read_b64_tr_b16 v[38:39], v197 offset:46080
    s_waitcnt lgkmcnt(8)
    v_mfma_f32_32x32x16_bf16 v[80:95], v[8:11], v[24:27], v[80:95]
    ds_read_b128 v[48:51], v195 offset:41984
    ds_read_b128 v[52:55], v195 offset:44032
    s_add_u32 m0, s56, 81920
    s_add_u32 s67, s47, 28672
    buffer_load_dwordx4 v1, s[8:11], s67 offen sc1 lds
    s_waitcnt lgkmcnt(8)
    v_mfma_f32_32x32x16_bf16 v[96:111], v[12:15], v[20:23], v[96:111]
    ds_read_b64_tr_b16 v[40:41], v197 offset:53248
    v_mfma_f32_32x32x16_bf16 v[112:127], v[12:15], v[24:27], v[112:127]
    ds_read_b64_tr_b16 v[42:43], v197 offset:54272
    s_waitcnt lgkmcnt(8)
    v_mfma_f32_32x32x16_bf16 v[128:143], v[16:19], v[20:23], v[128:143]
    ds_read_b64_tr_b16 v[44:45], v197 offset:61440
    buffer_load_dwordx4 v1, s[8:11], s67 offen offset:1024 sc1 lds
    v_mfma_f32_32x32x16_bf16 v[144:159], v[16:19], v[24:27], v[144:159]
    ds_read_b64_tr_b16 v[46:47], v197 offset:62464
    s_waitcnt lgkmcnt(9)
    v_mfma_f32_32x32x16_bf16 v[160:175], v[16:19], v[28:31], v[160:175]
    ds_read_b128 v[56:59], v195 offset:50176
    s_waitcnt lgkmcnt(9)
    v_mfma_f32_32x32x16_bf16 v[176:191], v[16:19], v[32:35], v[176:191]
    ds_read_b128 v[60:63], v195 offset:52224
    s_add_u32 m0, s50, 98304
    s_add_u32 s68, s48, 1605632
    buffer_load_dwordx4 v192, s[12:15], s68 offen lds
    s_waitcnt lgkmcnt(7)
    v_mfma_f32_32x32x16_bf16 v[64:79], v[36:39], v[48:51], v[64:79]
    ds_read_b64_tr_b16 v[8:9], v196 offset:0
    ds_read_b64_tr_b16 v[10:11], v196 offset:1024
    s_waitcnt lgkmcnt(8)
    v_mfma_f32_32x32x16_bf16 v[80:95], v[36:39], v[52:55], v[80:95]
    ds_read_b128 v[20:23], v194 offset:0
    ds_read_b128 v[24:27], v194 offset:2048
    s_waitcnt lgkmcnt(8)
    v_mfma_f32_32x32x16_bf16 v[96:111], v[40:43], v[48:51], v[96:111]
    ds_read_b64_tr_b16 v[12:13], v196 offset:8192
    s_add_u32 m0, s50, 106496
    s_add_u32 s69, s49, 3670016
    buffer_load_dwordx4 v192, s[16:19], s68 offen lds
    v_mfma_f32_32x32x16_bf16 v[112:127], v[40:43], v[52:55], v[112:127]
    ds_read_b64_tr_b16 v[14:15], v196 offset:9216
    s_waitcnt lgkmcnt(8)
    v_mfma_f32_32x32x16_bf16 v[128:143], v[44:47], v[48:51], v[128:143]
    ds_read_b64_tr_b16 v[16:17], v196 offset:16384
    v_mfma_f32_32x32x16_bf16 v[144:159], v[44:47], v[52:55], v[144:159]
    ds_read_b64_tr_b16 v[18:19], v196 offset:17408
    s_add_u32 m0, s50, 114688
    s_nop 0
    buffer_load_dwordx4 v193, s[20:23], s69 offen lds
    s_waitcnt lgkmcnt(9)
    v_mfma_f32_32x32x16_bf16 v[160:175], v[44:47], v[56:59], v[160:175]
    ds_read_b128 v[28:31], v194 offset:8192
    s_waitcnt lgkmcnt(9)
    v_mfma_f32_32x32x16_bf16 v[176:191], v[44:47], v[60:63], v[176:191]
    ds_read_b128 v[32:35], v194 offset:10240
    s_waitcnt vmcnt(5)
    s_barrier
    s_waitcnt lgkmcnt(7)
    v_mfma_f32_32x32x16_bf16 v[64:79], v[8:11], v[20:23], v[64:79]
    ds_read_b64_tr_b16 v[36:37], v196 offset:4096
    ds_read_b64_tr_b16 v[38:39], v196 offset:5120
    s_waitcnt lgkmcnt(8)
    v_mfma_f32_32x32x16_bf16 v[80:95], v[8:11], v[24:27], v[80:95]
    ds_read_b128 v[48:51], v194 offset:1024
    ds_read_b128 v[52:55], v194 offset:3072
    s_add_u32 m0, s56, 122880
    s_add_u32 s67, s47, 30720
    buffer_load_dwordx4 v1, s[8:11], s67 offen sc1 lds
    s_waitcnt lgkmcnt(8)
    v_mfma_f32_32x32x16_bf16 v[96:111], v[12:15], v[20:23], v[96:111]
    ds_read_b64_tr_b16 v[40:41], v196 offset:12288
    v_mfma_f32_32x32x16_bf16 v[112:127], v[12:15], v[24:27], v[112:127]
    ds_read_b64_tr_b16 v[42:43], v196 offset:13312
    s_waitcnt lgkmcnt(8)
    v_mfma_f32_32x32x16_bf16 v[128:143], v[16:19], v[20:23], v[128:143]
    ds_read_b64_tr_b16 v[44:45], v196 offset:20480
    buffer_load_dwordx4 v1, s[8:11], s67 offen offset:1024 sc1 lds
    v_mfma_f32_32x32x16_bf16 v[144:159], v[16:19], v[24:27], v[144:159]
    ds_read_b64_tr_b16 v[46:47], v196 offset:21504
    s_waitcnt lgkmcnt(9)
    v_mfma_f32_32x32x16_bf16 v[160:175], v[16:19], v[28:31], v[160:175]
    ds_read_b128 v[56:59], v194 offset:9216
    s_waitcnt lgkmcnt(9)
    v_mfma_f32_32x32x16_bf16 v[176:191], v[16:19], v[32:35], v[176:191]
    ds_read_b128 v[60:63], v194 offset:11264
    s_add_u32 m0, s50, 139264
    s_add_u32 s68, s48, 1720320
    buffer_load_dwordx4 v192, s[12:15], s68 offen lds
    s_waitcnt lgkmcnt(7)
    v_mfma_f32_32x32x16_bf16 v[64:79], v[36:39], v[48:51], v[64:79]
    ds_read_b64_tr_b16 v[8:9], v196 offset:40960
    ds_read_b64_tr_b16 v[10:11], v196 offset:41984
    s_waitcnt lgkmcnt(8)
    v_mfma_f32_32x32x16_bf16 v[80:95], v[36:39], v[52:55], v[80:95]
    ds_read_b128 v[20:23], v194 offset:40960
    ds_read_b128 v[24:27], v194 offset:43008
    s_waitcnt lgkmcnt(8)
    v_mfma_f32_32x32x16_bf16 v[96:111], v[40:43], v[48:51], v[96:111]
    ds_read_b64_tr_b16 v[12:13], v196 offset:49152
    s_add_u32 m0, s50, 147456
    s_add_u32 s69, s49, 3932160
    buffer_load_dwordx4 v192, s[16:19], s68 offen lds
    v_mfma_f32_32x32x16_bf16 v[112:127], v[40:43], v[52:55], v[112:127]
    ds_read_b64_tr_b16 v[14:15], v196 offset:50176
    s_waitcnt lgkmcnt(8)
    v_mfma_f32_32x32x16_bf16 v[128:143], v[44:47], v[48:51], v[128:143]
    ds_read_b64_tr_b16 v[16:17], v196 offset:57344
    v_mfma_f32_32x32x16_bf16 v[144:159], v[44:47], v[52:55], v[144:159]
    ds_read_b64_tr_b16 v[18:19], v196 offset:58368
    s_add_u32 m0, s50, 155648
    s_nop 0
    buffer_load_dwordx4 v193, s[20:23], s69 offen lds
    s_waitcnt lgkmcnt(9)
    v_mfma_f32_32x32x16_bf16 v[160:175], v[44:47], v[56:59], v[160:175]
    ds_read_b128 v[28:31], v194 offset:49152
    s_waitcnt lgkmcnt(9)
    v_mfma_f32_32x32x16_bf16 v[176:191], v[44:47], v[60:63], v[176:191]
    ds_read_b128 v[32:35], v194 offset:51200
    s_waitcnt vmcnt(5)
    s_barrier
    s_waitcnt lgkmcnt(7)
    v_mfma_f32_32x32x16_bf16 v[64:79], v[8:11], v[20:23], v[64:79]
    ds_read_b64_tr_b16 v[36:37], v196 offset:45056
    ds_read_b64_tr_b16 v[38:39], v196 offset:46080
    s_waitcnt lgkmcnt(8)
    v_mfma_f32_32x32x16_bf16 v[80:95], v[8:11], v[24:27], v[80:95]
    ds_read_b128 v[48:51], v194 offset:41984
    ds_read_b128 v[52:55], v194 offset:44032
    s_waitcnt lgkmcnt(8)
    v_mfma_f32_32x32x16_bf16 v[96:111], v[12:15], v[20:23], v[96:111]
    ds_read_b64_tr_b16 v[40:41], v196 offset:53248
    v_mfma_f32_32x32x16_bf16 v[112:127], v[12:15], v[24:27], v[112:127]
    ds_read_b64_tr_b16 v[42:43], v196 offset:54272
    s_waitcnt lgkmcnt(8)
    v_mfma_f32_32x32x16_bf16 v[128:143], v[16:19], v[20:23], v[128:143]
    ds_read_b64_tr_b16 v[44:45], v196 offset:61440
    v_mfma_f32_32x32x16_bf16 v[144:159], v[16:19], v[24:27], v[144:159]
    ds_read_b64_tr_b16 v[46:47], v196 offset:62464
    s_waitcnt lgkmcnt(9)
    v_mfma_f32_32x32x16_bf16 v[160:175], v[16:19], v[28:31], v[160:175]
    ds_read_b128 v[56:59], v194 offset:50176
    s_waitcnt lgkmcnt(9)
    v_mfma_f32_32x32x16_bf16 v[176:191], v[16:19], v[32:35], v[176:191]
    ds_read_b128 v[60:63], v194 offset:52224
    s_waitcnt lgkmcnt(7)
    v_mfma_f32_32x32x16_bf16 v[64:79], v[36:39], v[48:51], v[64:79]
    ds_read_b64_tr_b16 v[8:9], v197 offset:0
    ds_read_b64_tr_b16 v[10:11], v197 offset:1024
    s_waitcnt lgkmcnt(8)
    v_mfma_f32_32x32x16_bf16 v[80:95], v[36:39], v[52:55], v[80:95]
    ds_read_b128 v[20:23], v195 offset:0
    ds_read_b128 v[24:27], v195 offset:2048
    s_waitcnt lgkmcnt(8)
    v_mfma_f32_32x32x16_bf16 v[96:111], v[40:43], v[48:51], v[96:111]
    ds_read_b64_tr_b16 v[12:13], v197 offset:8192
    v_mfma_f32_32x32x16_bf16 v[112:127], v[40:43], v[52:55], v[112:127]
    ds_read_b64_tr_b16 v[14:15], v197 offset:9216
    s_waitcnt lgkmcnt(8)
    v_mfma_f32_32x32x16_bf16 v[128:143], v[44:47], v[48:51], v[128:143]
    ds_read_b64_tr_b16 v[16:17], v197 offset:16384
    v_mfma_f32_32x32x16_bf16 v[144:159], v[44:47], v[52:55], v[144:159]
    ds_read_b64_tr_b16 v[18:19], v197 offset:17408
    s_waitcnt lgkmcnt(9)
    v_mfma_f32_32x32x16_bf16 v[160:175], v[44:47], v[56:59], v[160:175]
    ds_read_b128 v[28:31], v195 offset:8192
    s_waitcnt lgkmcnt(9)
    v_mfma_f32_32x32x16_bf16 v[176:191], v[44:47], v[60:63], v[176:191]
    ds_read_b128 v[32:35], v195 offset:10240
    s_waitcnt vmcnt(0)
    s_barrier
    s_cmp_lg_u32 s40, 0
    s_cbranch_scc1 stl_18
    buffer_load_dword v199, v244, s[76:79], 0 offen sc1
stl_18:
    s_mov_b32 s24, s6
    s_mov_b32 s25, s7
    s_mov_b32 s26, 0x400000
    s_mov_b32 s27, 0x00020000
    s_mov_b32 s28, s100
    s_mov_b32 s29, s101
    s_mov_b32 s30, 0x1c0000
    s_mov_b32 s31, 0x00020000
    v_and_b32 v2, 31, v0
    v_lshlrev_b32 v2, 1, v2
    v_lshrrev_b32 v3, 5, v0
    v_lshlrev_b32 v3, 12, v3
    v_add_u32 v2, v2, v3
    v_add_u32 v3, 8192, v2
    s_mul_i32 s66, s2, 23
    s_mul_i32 s67, s40, 3
    s_add_u32 s54, s66, s67

    s_add_u32 s66, s54, 0
    s_lshr_b32 s67, s66, 4
    s_and_b32 s66, s66, 15
    s_lshl_b32 s66, s66, 6
    s_cmp_ge_u32 s67, 256
    s_cbranch_scc1 rl_wd_19
    s_lshl_b32 s67, s67, 14
    s_add_u32 s66, s66, s67

    buffer_load_ushort v220, v2, s[24:27], s66 offen offset:0
    buffer_load_ushort v221, v2, s[24:27], s66 offen offset:1024
    buffer_load_ushort v222, v2, s[24:27], s66 offen offset:2048
    buffer_load_ushort v223, v2, s[24:27], s66 offen offset:3072
    buffer_load_ushort v224, v3, s[24:27], s66 offen offset:0
    buffer_load_ushort v225, v3, s[24:27], s66 offen offset:1024
    buffer_load_ushort v226, v3, s[24:27], s66 offen offset:2048
    buffer_load_ushort v227, v3, s[24:27], s66 offen offset:3072
    s_branch rl_j_20
rl_wd_19:
    s_sub_u32 s67, s67, 256
    s_lshl_b32 s67, s67, 14
    s_add_u32 s66, s66, s67
    buffer_load_ushort v220, v2, s[28:31], s66 offen offset:0
    buffer_load_ushort v221, v2, s[28:31], s66 offen offset:1024
    buffer_load_ushort v222, v2, s[28:31], s66 offen offset:2048
    buffer_load_ushort v223, v2, s[28:31], s66 offen offset:3072
    buffer_load_ushort v224, v3, s[28:31], s66 offen offset:0
    buffer_load_ushort v225, v3, s[28:31], s66 offen offset:1024
    buffer_load_ushort v226, v3, s[28:31], s66 offen offset:2048
    buffer_load_ushort v227, v3, s[28:31], s66 offen offset:3072
rl_j_20:
    s_add_u32 s66, s54, 1
    s_lshr_b32 s67, s66, 4
    s_and_b32 s66, s66, 15
    s_lshl_b32 s66, s66, 6
    s_cmp_ge_u32 s67, 256
    s_cbranch_scc1 rl_wd_21
    s_lshl_b32 s67, s67, 14
    s_add_u32 s66, s66, s67

    buffer_load_ushort v228, v2, s[24:27], s66 offen offset:0
    buffer_load_ushort v229, v2, s[24:27], s66 offen offset:1024
    buffer_load_ushort v230, v2, s[24:27], s66 offen offset:2048
    buffer_load_ushort v231, v2, s[24:27], s66 offen offset:3072
    buffer_load_ushort v232, v3, s[24:27], s66 offen offset:0
    buffer_load_ushort v233, v3, s[24:27], s66 offen offset:1024
    buffer_load_ushort v234, v3, s[24:27], s66 offen offset:2048
    buffer_load_ushort v235, v3, s[24:27], s66 offen offset:3072
    s_branch rl_j_22
rl_wd_21:
    s_sub_u32 s67, s67, 256
    s_lshl_b32 s67, s67, 14
    s_add_u32 s66, s66, s67
    buffer_load_ushort v228, v2, s[28:31], s66 offen offset:0
    buffer_load_ushort v229, v2, s[28:31], s66 offen offset:1024
    buffer_load_ushort v230, v2, s[28:31], s66 offen offset:2048
    buffer_load_ushort v231, v2, s[28:31], s66 offen offset:3072
    buffer_load_ushort v232, v3, s[28:31], s66 offen offset:0
    buffer_load_ushort v233, v3, s[28:31], s66 offen offset:1024
    buffer_load_ushort v234, v3, s[28:31], s66 offen offset:2048
    buffer_load_ushort v235, v3, s[28:31], s66 offen offset:3072
rl_j_22:
    s_add_u32 s66, s54, 2
    s_lshr_b32 s67, s66, 4
    s_and_b32 s66, s66, 15
    s_lshl_b32 s66, s66, 6
    s_cmp_ge_u32 s67, 256
    s_cbranch_scc1 rl_wd_23
    s_lshl_b32 s67, s67, 14
    s_add_u32 s66, s66, s67

    buffer_load_ushort v236, v2, s[24:27], s66 offen offset:0
    buffer_load_ushort v237, v2, s[24:27], s66 offen offset:1024
    buffer_load_ushort v238, v2, s[24:27], s66 offen offset:2048
    buffer_load_ushort v239, v2, s[24:27], s66 offen offset:3072
    buffer_load_ushort v240, v3, s[24:27], s66 offen offset:0
    buffer_load_ushort v241, v3, s[24:27], s66 offen offset:1024
    buffer_load_ushort v242, v3, s[24:27], s66 offen offset:2048
    buffer_load_ushort v243, v3, s[24:27], s66 offen offset:3072
    s_branch rl_j_24
rl_wd_23:
    s_sub_u32 s67, s67, 256
    s_lshl_b32 s67, s67, 14
    s_add_u32 s66, s66, s67
    buffer_load_ushort v236, v2, s[28:31], s66 offen offset:0
    buffer_load_ushort v237, v2, s[28:31], s66 offen offset:1024
    buffer_load_ushort v238, v2, s[28:31], s66 offen offset:2048
    buffer_load_ushort v239, v2, s[28:31], s66 offen offset:3072
    buffer_load_ushort v240, v3, s[28:31], s66 offen offset:0
    buffer_load_ushort v241, v3, s[28:31], s66 offen offset:1024
    buffer_load_ushort v242, v3, s[28:31], s66 offen offset:2048
    buffer_load_ushort v243, v3, s[28:31], s66 offen offset:3072
rl_j_24:
    s_add_u32 s24, s4, 0x1000000
    s_addc_u32 s25, s5, 0
    s_mov_b32 s26, 0x1000000
    s_mov_b32 s27, 0x00020000
    s_add_u32 s28, s4, 0x2000000
    s_addc_u32 s29, s5, 0
    s_mov_b32 s30, 0x1000000
    s_mov_b32 s31, 0x00020000
    s_waitcnt lgkmcnt(7)
    v_mfma_f32_32x32x16_bf16 v[64:79], v[8:11], v[20:23], v[64:79]
    ds_read_b64_tr_b16 v[36:37], v197 offset:4096
    ds_read_b64_tr_b16 v[38:39], v197 offset:5120
    s_waitcnt lgkmcnt(8)
    v_mfma_f32_32x32x16_bf16 v[80:95], v[8:11], v[24:27], v[80:95]
    ds_read_b128 v[48:51], v195 offset:1024
    ds_read_b128 v[52:55], v195 offset:3072
    s_waitcnt lgkmcnt(8)
    v_mfma_f32_32x32x16_bf16 v[96:111], v[12:15], v[20:23], v[96:111]
    ds_read_b64_tr_b16 v[40:41], v197 offset:12288
    v_mfma_f32_32x32x16_bf16 v[112:127], v[12:15], v[24:27], v[112:127]
    ds_read_b64_tr_b16 v[42:43], v197 offset:13312
    s_waitcnt lgkmcnt(8)
    v_mfma_f32_32x32x16_bf16 v[128:143], v[16:19], v[20:23], v[128:143]
    ds_read_b64_tr_b16 v[44:45], v197 offset:20480
    v_mfma_f32_32x32x16_bf16 v[144:159], v[16:19], v[24:27], v[144:159]
    ds_read_b64_tr_b16 v[46:47], v197 offset:21504
    s_waitcnt lgkmcnt(9)
    v_mfma_f32_32x32x16_bf16 v[160:175], v[16:19], v[28:31], v[160:175]
    ds_read_b128 v[56:59], v195 offset:9216
    s_waitcnt lgkmcnt(9)
    v_mfma_f32_32x32x16_bf16 v[176:191], v[16:19], v[32:35], v[176:191]
    ds_read_b128 v[60:63], v195 offset:11264
    s_waitcnt lgkmcnt(7)
    v_mfma_f32_32x32x16_bf16 v[64:79], v[36:39], v[48:51], v[64:79]
    ds_read_b64_tr_b16 v[8:9], v197 offset:40960
    ds_read_b64_tr_b16 v[10:11], v197 offset:41984
    s_waitcnt lgkmcnt(8)
    v_mfma_f32_32x32x16_bf16 v[80:95], v[36:39], v[52:55], v[80:95]
    ds_read_b128 v[20:23], v195 offset:40960
    ds_read_b128 v[24:27], v195 offset:43008
    s_waitcnt lgkmcnt(8)
    v_mfma_f32_32x32x16_bf16 v[96:111], v[40:43], v[48:51], v[96:111]
    ds_read_b64_tr_b16 v[12:13], v197 offset:49152
    v_mfma_f32_32x32x16_bf16 v[112:127], v[40:43], v[52:55], v[112:127]
    ds_read_b64_tr_b16 v[14:15], v197 offset:50176
    s_waitcnt lgkmcnt(8)
    v_mfma_f32_32x32x16_bf16 v[128:143], v[44:47], v[48:51], v[128:143]
    ds_read_b64_tr_b16 v[16:17], v197 offset:57344
    v_mfma_f32_32x32x16_bf16 v[144:159], v[44:47], v[52:55], v[144:159]
    ds_read_b64_tr_b16 v[18:19], v197 offset:58368
    s_waitcnt lgkmcnt(9)
    v_mfma_f32_32x32x16_bf16 v[160:175], v[44:47], v[56:59], v[160:175]
    ds_read_b128 v[28:31], v195 offset:49152
    s_waitcnt lgkmcnt(9)
    v_mfma_f32_32x32x16_bf16 v[176:191], v[44:47], v[60:63], v[176:191]
    ds_read_b128 v[32:35], v195 offset:51200
    s_waitcnt lgkmcnt(7)
    v_mfma_f32_32x32x16_bf16 v[64:79], v[8:11], v[20:23], v[64:79]
    ds_read_b64_tr_b16 v[36:37], v197 offset:45056
    ds_read_b64_tr_b16 v[38:39], v197 offset:46080
    s_waitcnt lgkmcnt(8)
    v_mfma_f32_32x32x16_bf16 v[80:95], v[8:11], v[24:27], v[80:95]
    ds_read_b128 v[48:51], v195 offset:41984
    ds_read_b128 v[52:55], v195 offset:44032
    s_waitcnt lgkmcnt(8)
    v_mfma_f32_32x32x16_bf16 v[96:111], v[12:15], v[20:23], v[96:111]
    ds_read_b64_tr_b16 v[40:41], v197 offset:53248
    v_mfma_f32_32x32x16_bf16 v[112:127], v[12:15], v[24:27], v[112:127]
    ds_read_b64_tr_b16 v[42:43], v197 offset:54272
    s_waitcnt lgkmcnt(8)
    v_mfma_f32_32x32x16_bf16 v[128:143], v[16:19], v[20:23], v[128:143]
    ds_read_b64_tr_b16 v[44:45], v197 offset:61440
    v_mfma_f32_32x32x16_bf16 v[144:159], v[16:19], v[24:27], v[144:159]
    ds_read_b64_tr_b16 v[46:47], v197 offset:62464
    s_waitcnt lgkmcnt(9)
    v_mfma_f32_32x32x16_bf16 v[160:175], v[16:19], v[28:31], v[160:175]
    ds_read_b128 v[56:59], v195 offset:50176
    s_waitcnt lgkmcnt(9)
    v_mfma_f32_32x32x16_bf16 v[176:191], v[16:19], v[32:35], v[176:191]
    ds_read_b128 v[60:63], v195 offset:52224
    s_waitcnt lgkmcnt(7)
    v_mfma_f32_32x32x16_bf16 v[64:79], v[36:39], v[48:51], v[64:79]
    s_waitcnt lgkmcnt(6)
    v_mfma_f32_32x32x16_bf16 v[80:95], v[36:39], v[52:55], v[80:95]
    s_waitcnt lgkmcnt(4)
    v_mfma_f32_32x32x16_bf16 v[96:111], v[40:43], v[48:51], v[96:111]
    v_mfma_f32_32x32x16_bf16 v[112:127], v[40:43], v[52:55], v[112:127]
    s_waitcnt lgkmcnt(2)
    v_mfma_f32_32x32x16_bf16 v[128:143], v[44:47], v[48:51], v[128:143]
    v_mfma_f32_32x32x16_bf16 v[144:159], v[44:47], v[52:55], v[144:159]
    s_waitcnt lgkmcnt(1)
    v_mfma_f32_32x32x16_bf16 v[160:175], v[44:47], v[56:59], v[160:175]
    s_waitcnt lgkmcnt(0)
    v_mfma_f32_32x32x16_bf16 v[176:191], v[44:47], v[60:63], v[176:191]
    s_cmp_lg_u32 s40, 0
    s_cbranch_scc1 b23_nw0_25
    s_waitcnt vmcnt(24)
    s_mov_b32 s73, 0
fl_spin_27:
    s_and_b32 s70, s2, 3
    s_lshl_b32 s70, s70, 3
    v_lshrrev_b32 v245, s70, v199
    s_bfe_u32 s70, s2, 0x30002
    s_mov_b32 s68, 0x01010101
    s_mov_b32 s69, 0x01010101
    s_lshl_b64 s[68:69], s[68:69], s70
    v_and_b32 v245, 0x20, v245
    v_cmp_ne_u32 vcc, 0, v245
    s_and_b64 s[70:71], vcc, s[68:69]
    s_cmp_eq_u64 s[70:71], s[68:69]

    s_cbranch_scc1 fl_ok_26
    s_add_u32 s73, s73, 1
    s_cmp_ge_u32 s73, 262144
    s_cbranch_scc1 fl_ok_26
    s_sleep 16

    buffer_load_dword v199, v244, s[76:79], 0 offen sc1
    s_waitcnt vmcnt(0)
    s_branch fl_spin_27
fl_ok_26:
b23_nw0_25:
    s_barrier
    v_mov_b32 v14, 0

    s_mul_i32 s66, s45, 3
    s_xor_b32 s46, s46, s66
    s_lshl_b32 s66, s45, 1
    s_sub_u32 s56, s46, s66
    s_add_u32 s56, s56, 1
    s_lshl_b32 s61, s41, 19
    s_lshl_b32 s66, s40, 12
    s_add_u32 s61, s61, s66
    s_lshl_b32 s50, s40, 12
    s_mov_b32 s63, 0
    s_mov_b32 s64, 0
    s_mov_b32 s57, s61
    s_mov_b32 s58, s61
    s_mov_b32 s59, s50
    s_add_u32 s60, s50, 65536

    s_mov_b32 m0, s59
    s_mov_b32 s72, s57
    s_xor_b32 s59, s59, 32768
    s_add_u32 s57, s57, 32768
    s_cmp_eq_u32 s63, s65
    s_cselect_b32 s57, s61, s57
    s_add_u32 s63, s63, 1
    buffer_load_dwordx4 v1, s[24:27], s72 offen offset:0 lds
    buffer_load_dwordx4 v1, s[24:27], s72 offen offset:1024 lds
    buffer_load_dwordx4 v1, s[24:27], s72 offen offset:2048 lds
    buffer_load_dwordx4 v1, s[24:27], s72 offen offset:3072 lds
    s_mov_b32 m0, s60
    s_mov_b32 s73, s58
    s_xor_b32 s60, s60, 32768
    s_add_u32 s58, s58, 32768
    s_cmp_eq_u32 s64, s65
    s_cselect_b32 s58, s61, s58
    s_add_u32 s64, s64, 1
    buffer_load_dwordx4 v1, s[28:31], s73 offen offset:0 lds
    buffer_load_dwordx4 v1, s[28:31], s73 offen offset:1024 lds
    buffer_load_dwordx4 v1, s[28:31], s73 offen offset:2048 lds
    buffer_load_dwordx4 v1, s[28:31], s73 offen offset:3072 lds
    s_mov_b32 m0, s59
    s_mov_b32 s72, s57
    s_xor_b32 s59, s59, 32768
    s_add_u32 s57, s57, 32768
    s_cmp_eq_u32 s63, s65
    s_cselect_b32 s57, s61, s57
    s_add_u32 s63, s63, 1
    buffer_load_dwordx4 v1, s[24:27], s72 offen offset:0 lds
    buffer_load_dwordx4 v1, s[24:27], s72 offen offset:1024 lds
    buffer_load_dwordx4 v1, s[24:27], s72 offen offset:2048 lds
    buffer_load_dwordx4 v1, s[24:27], s72 offen offset:3072 lds
    v_mov_b32 v216, 0x3e0293ee
    s_lshl_b32 s66, s43, 14
    s_lshl_b32 s67, s44, 11
    s_add_u32 s66, s66, s67
    s_add_u32 s66, s66, 98304
    v_add_u32 v6, s66, v1

    v_pk_mul_f32 v[128:129], v[128:129], v[216:217] op_sel_hi:[1,0]
    v_pk_mul_f32 v[130:131], v[130:131], v[216:217] op_sel_hi:[1,0]
    v_pk_mul_f32 v[132:133], v[132:133], v[216:217] op_sel_hi:[1,0]
    v_pk_mul_f32 v[134:135], v[134:135], v[216:217] op_sel_hi:[1,0]
    v_pk_mul_f32 v[136:137], v[136:137], v[216:217] op_sel_hi:[1,0]
    v_pk_mul_f32 v[138:139], v[138:139], v[216:217] op_sel_hi:[1,0]
    v_pk_mul_f32 v[140:141], v[140:141], v[216:217] op_sel_hi:[1,0]
    v_pk_mul_f32 v[142:143], v[142:143], v[216:217] op_sel_hi:[1,0]
    v_cvt_pk_bf16_f32 v200, v128, v129
    v_cvt_pk_bf16_f32 v201, v130, v131
    v_cvt_pk_bf16_f32 v202, v132, v133
    v_cvt_pk_bf16_f32 v203, v134, v135
    v_cvt_pk_bf16_f32 v204, v136, v137
    v_cvt_pk_bf16_f32 v205, v138, v139
    v_cvt_pk_bf16_f32 v206, v140, v141
    v_cvt_pk_bf16_f32 v207, v142, v143
    ds_write_b128 v6, v[200:203] offset:0
    ds_write_b128 v6, v[204:207] offset:1024
    v_pk_mul_f32 v[144:145], v[144:145], v[216:217] op_sel_hi:[1,0]
    v_pk_mul_f32 v[146:147], v[146:147], v[216:217] op_sel_hi:[1,0]
    v_pk_mul_f32 v[148:149], v[148:149], v[216:217] op_sel_hi:[1,0]
    v_pk_mul_f32 v[150:151], v[150:151], v[216:217] op_sel_hi:[1,0]
    v_pk_mul_f32 v[152:153], v[152:153], v[216:217] op_sel_hi:[1,0]
    v_pk_mul_f32 v[154:155], v[154:155], v[216:217] op_sel_hi:[1,0]
    v_pk_mul_f32 v[156:157], v[156:157], v[216:217] op_sel_hi:[1,0]
    v_pk_mul_f32 v[158:159], v[158:159], v[216:217] op_sel_hi:[1,0]
    v_cvt_pk_bf16_f32 v208, v144, v145
    v_cvt_pk_bf16_f32 v209, v146, v147
    v_cvt_pk_bf16_f32 v210, v148, v149
    v_cvt_pk_bf16_f32 v211, v150, v151
    v_cvt_pk_bf16_f32 v212, v152, v153
    v_cvt_pk_bf16_f32 v213, v154, v155
    v_cvt_pk_bf16_f32 v214, v156, v157
    v_cvt_pk_bf16_f32 v215, v158, v159
    ds_write_b128 v6, v[208:211] offset:8192
    ds_write_b128 v6, v[212:215] offset:9216
    v_pk_mul_f32 v[160:161], v[160:161], v[216:217] op_sel_hi:[1,0]
    v_pk_mul_f32 v[162:163], v[162:163], v[216:217] op_sel_hi:[1,0]
    v_pk_mul_f32 v[164:165], v[164:165], v[216:217] op_sel_hi:[1,0]
    v_pk_mul_f32 v[166:167], v[166:167], v[216:217] op_sel_hi:[1,0]
    v_pk_mul_f32 v[168:169], v[168:169], v[216:217] op_sel_hi:[1,0]
    v_pk_mul_f32 v[170:171], v[170:171], v[216:217] op_sel_hi:[1,0]
    v_pk_mul_f32 v[172:173], v[172:173], v[216:217] op_sel_hi:[1,0]
    v_pk_mul_f32 v[174:175], v[174:175], v[216:217] op_sel_hi:[1,0]
    v_cvt_pk_bf16_f32 v200, v160, v161
    v_cvt_pk_bf16_f32 v201, v162, v163
    v_cvt_pk_bf16_f32 v202, v164, v165
    v_cvt_pk_bf16_f32 v203, v166, v167
    v_cvt_pk_bf16_f32 v204, v168, v169
    v_cvt_pk_bf16_f32 v205, v170, v171
    v_cvt_pk_bf16_f32 v206, v172, v173
    v_cvt_pk_bf16_f32 v207, v174, v175
    ds_write_b128 v6, v[200:203] offset:32768
    ds_write_b128 v6, v[204:207] offset:33792
    v_pk_mul_f32 v[176:177], v[176:177], v[216:217] op_sel_hi:[1,0]
    v_pk_mul_f32 v[178:179], v[178:179], v[216:217] op_sel_hi:[1,0]
    v_pk_mul_f32 v[180:181], v[180:181], v[216:217] op_sel_hi:[1,0]
    v_pk_mul_f32 v[182:183], v[182:183], v[216:217] op_sel_hi:[1,0]
    v_pk_mul_f32 v[184:185], v[184:185], v[216:217] op_sel_hi:[1,0]
    v_pk_mul_f32 v[186:187], v[186:187], v[216:217] op_sel_hi:[1,0]
    v_pk_mul_f32 v[188:189], v[188:189], v[216:217] op_sel_hi:[1,0]
    v_pk_mul_f32 v[190:191], v[190:191], v[216:217] op_sel_hi:[1,0]
    v_cvt_pk_bf16_f32 v208, v176, v177
    v_cvt_pk_bf16_f32 v209, v178, v179
    v_cvt_pk_bf16_f32 v210, v180, v181
    v_cvt_pk_bf16_f32 v211, v182, v183
    v_cvt_pk_bf16_f32 v212, v184, v185
    v_cvt_pk_bf16_f32 v213, v186, v187
    v_cvt_pk_bf16_f32 v214, v188, v189
    v_cvt_pk_bf16_f32 v215, v190, v191
    ds_write_b128 v6, v[208:211] offset:40960
    ds_write_b128 v6, v[212:215] offset:41984
    s_waitcnt lgkmcnt(0)
    v_mov_b32 v208, 0xc0135761
    v_mov_b32 v209, 0xbdd2d3e8
    v_mov_b32 v210, 1.0
    s_lshl_b32 s66, s52, 2
    s_lshl_b32 s67, s43, 1
    s_add_u32 s66, s66, s67
    s_mul_i32 s66, s66, 114688
    s_lshl_b32 s67, s51, 13
    s_add_u32 s66, s66, s67
    s_lshl_b32 s67, s44, 11
    s_add_u32 s66, s66, s67
    s_cmp_lt_u32 s41, 28
    s_cselect_b32 s66, s66, 0x7ff00000

    v_pk_mul_f32 v[212:213], v[64:65], v[64:65]
    v_pk_mul_f32 v[214:215], v[66:67], v[66:67]
    v_pk_mul_f32 v[216:217], v[68:69], v[68:69]
    v_pk_mul_f32 v[218:219], v[70:71], v[70:71]
    v_pk_fma_f32 v[212:213], v[212:213], v[208:209], v[208:209] op_sel:[0,1,0] op_sel_hi:[1,1,0]
    v_pk_fma_f32 v[214:215], v[214:215], v[208:209], v[208:209] op_sel:[0,1,0] op_sel_hi:[1,1,0]
    v_pk_fma_f32 v[216:217], v[216:217], v[208:209], v[208:209] op_sel:[0,1,0] op_sel_hi:[1,1,0]
    v_pk_fma_f32 v[218:219], v[218:219], v[208:209], v[208:209] op_sel:[0,1,0] op_sel_hi:[1,1,0]
    v_pk_mul_f32 v[212:213], v[212:213], v[64:65]
    v_pk_mul_f32 v[214:215], v[214:215], v[66:67]
    v_pk_mul_f32 v[216:217], v[216:217], v[68:69]
    v_pk_mul_f32 v[218:219], v[218:219], v[70:71]
    v_exp_f32 v212, v212
    v_exp_f32 v213, v213
    v_exp_f32 v214, v214
    v_exp_f32 v215, v215
    v_exp_f32 v216, v216
    v_exp_f32 v217, v217
    v_exp_f32 v218, v218
    v_exp_f32 v219, v219
    v_pk_mul_f32 v[64:65], v[64:65], v[96:97]
    v_pk_mul_f32 v[66:67], v[66:67], v[98:99]
    v_pk_mul_f32 v[68:69], v[68:69], v[100:101]
    v_pk_mul_f32 v[70:71], v[70:71], v[102:103]
    v_pk_add_f32 v[212:213], v[212:213], v[210:211] op_sel_hi:[1,0]
    v_pk_add_f32 v[214:215], v[214:215], v[210:211] op_sel_hi:[1,0]
    v_pk_add_f32 v[216:217], v[216:217], v[210:211] op_sel_hi:[1,0]
    v_pk_add_f32 v[218:219], v[218:219], v[210:211] op_sel_hi:[1,0]
    v_rcp_f32 v212, v212
    v_rcp_f32 v213, v213
    v_rcp_f32 v214, v214
    v_rcp_f32 v215, v215
    v_rcp_f32 v216, v216
    v_rcp_f32 v217, v217
    v_rcp_f32 v218, v218
    v_rcp_f32 v219, v219
    s_nop 0
    v_pk_mul_f32 v[64:65], v[64:65], v[212:213]
    v_pk_mul_f32 v[66:67], v[66:67], v[214:215]
    v_pk_mul_f32 v[68:69], v[68:69], v[216:217]
    v_pk_mul_f32 v[70:71], v[70:71], v[218:219]
    v_pk_mul_f32 v[212:213], v[72:73], v[72:73]
    v_pk_mul_f32 v[214:215], v[74:75], v[74:75]
    v_pk_mul_f32 v[216:217], v[76:77], v[76:77]
    v_pk_mul_f32 v[218:219], v[78:79], v[78:79]
    v_pk_fma_f32 v[212:213], v[212:213], v[208:209], v[208:209] op_sel:[0,1,0] op_sel_hi:[1,1,0]
    v_pk_fma_f32 v[214:215], v[214:215], v[208:209], v[208:209] op_sel:[0,1,0] op_sel_hi:[1,1,0]
    v_pk_fma_f32 v[216:217], v[216:217], v[208:209], v[208:209] op_sel:[0,1,0] op_sel_hi:[1,1,0]
    v_pk_fma_f32 v[218:219], v[218:219], v[208:209], v[208:209] op_sel:[0,1,0] op_sel_hi:[1,1,0]
    v_pk_mul_f32 v[212:213], v[212:213], v[72:73]
    v_pk_mul_f32 v[214:215], v[214:215], v[74:75]
    v_pk_mul_f32 v[216:217], v[216:217], v[76:77]
    v_pk_mul_f32 v[218:219], v[218:219], v[78:79]
    v_exp_f32 v212, v212
    v_exp_f32 v213, v213
    v_exp_f32 v214, v214
    v_exp_f32 v215, v215
    v_exp_f32 v216, v216
    v_exp_f32 v217, v217
    v_exp_f32 v218, v218
    v_exp_f32 v219, v219
    v_pk_mul_f32 v[72:73], v[72:73], v[104:105]
    v_pk_mul_f32 v[74:75], v[74:75], v[106:107]
    v_pk_mul_f32 v[76:77], v[76:77], v[108:109]
    v_pk_mul_f32 v[78:79], v[78:79], v[110:111]
    v_pk_add_f32 v[212:213], v[212:213], v[210:211] op_sel_hi:[1,0]
    v_pk_add_f32 v[214:215], v[214:215], v[210:211] op_sel_hi:[1,0]
    v_pk_add_f32 v[216:217], v[216:217], v[210:211] op_sel_hi:[1,0]
    v_pk_add_f32 v[218:219], v[218:219], v[210:211] op_sel_hi:[1,0]
    v_rcp_f32 v212, v212
    v_rcp_f32 v213, v213
    v_rcp_f32 v214, v214
    v_rcp_f32 v215, v215
    v_rcp_f32 v216, v216
    v_rcp_f32 v217, v217
    v_rcp_f32 v218, v218
    v_rcp_f32 v219, v219
    s_nop 0
    v_pk_mul_f32 v[72:73], v[72:73], v[212:213]
    v_pk_mul_f32 v[74:75], v[74:75], v[214:215]
    v_pk_mul_f32 v[76:77], v[76:77], v[216:217]
    v_pk_mul_f32 v[78:79], v[78:79], v[218:219]
    v_cvt_pk_bf16_f32 v200, v64, v65
    v_cvt_pk_bf16_f32 v201, v66, v67
    v_cvt_pk_bf16_f32 v202, v68, v69
    v_cvt_pk_bf16_f32 v203, v70, v71
    v_cvt_pk_bf16_f32 v204, v72, v73
    v_cvt_pk_bf16_f32 v205, v74, v75
    v_cvt_pk_bf16_f32 v206, v76, v77
    v_cvt_pk_bf16_f32 v207, v78, v79
    buffer_store_dwordx4 v[200:203], v1, s[32:35], s66 offen sc0 sc1
    buffer_store_dwordx4 v[204:207], v1, s[32:35], s66 offen offset:1024 sc0 sc1
    s_add_u32 s66, s66, 114688
    v_pk_mul_f32 v[212:213], v[80:81], v[80:81]
    v_pk_mul_f32 v[214:215], v[82:83], v[82:83]
    v_pk_mul_f32 v[216:217], v[84:85], v[84:85]
    v_pk_mul_f32 v[218:219], v[86:87], v[86:87]
    v_pk_fma_f32 v[212:213], v[212:213], v[208:209], v[208:209] op_sel:[0,1,0] op_sel_hi:[1,1,0]
    v_pk_fma_f32 v[214:215], v[214:215], v[208:209], v[208:209] op_sel:[0,1,0] op_sel_hi:[1,1,0]
    v_pk_fma_f32 v[216:217], v[216:217], v[208:209], v[208:209] op_sel:[0,1,0] op_sel_hi:[1,1,0]
    v_pk_fma_f32 v[218:219], v[218:219], v[208:209], v[208:209] op_sel:[0,1,0] op_sel_hi:[1,1,0]
    v_pk_mul_f32 v[212:213], v[212:213], v[80:81]
    v_pk_mul_f32 v[214:215], v[214:215], v[82:83]
    v_pk_mul_f32 v[216:217], v[216:217], v[84:85]
    v_pk_mul_f32 v[218:219], v[218:219], v[86:87]
    v_exp_f32 v212, v212
    v_exp_f32 v213, v213
    v_exp_f32 v214, v214
    v_exp_f32 v215, v215
    v_exp_f32 v216, v216
    v_exp_f32 v217, v217
    v_exp_f32 v218, v218
    v_exp_f32 v219, v219
    v_pk_mul_f32 v[80:81], v[80:81], v[112:113]
    v_pk_mul_f32 v[82:83], v[82:83], v[114:115]
    v_pk_mul_f32 v[84:85], v[84:85], v[116:117]
    v_pk_mul_f32 v[86:87], v[86:87], v[118:119]
    v_pk_add_f32 v[212:213], v[212:213], v[210:211] op_sel_hi:[1,0]
    v_pk_add_f32 v[214:215], v[214:215], v[210:211] op_sel_hi:[1,0]
    v_pk_add_f32 v[216:217], v[216:217], v[210:211] op_sel_hi:[1,0]
    v_pk_add_f32 v[218:219], v[218:219], v[210:211] op_sel_hi:[1,0]
    v_rcp_f32 v212, v212
    v_rcp_f32 v213, v213
    v_rcp_f32 v214, v214
    v_rcp_f32 v215, v215
    v_rcp_f32 v216, v216
    v_rcp_f32 v217, v217
    v_rcp_f32 v218, v218
    v_rcp_f32 v219, v219
    s_nop 0
    v_pk_mul_f32 v[80:81], v[80:81], v[212:213]
    v_pk_mul_f32 v[82:83], v[82:83], v[214:215]
    v_pk_mul_f32 v[84:85], v[84:85], v[216:217]
    v_pk_mul_f32 v[86:87], v[86:87], v[218:219]
    v_pk_mul_f32 v[212:213], v[88:89], v[88:89]
    v_pk_mul_f32 v[214:215], v[90:91], v[90:91]
    v_pk_mul_f32 v[216:217], v[92:93], v[92:93]
    v_pk_mul_f32 v[218:219], v[94:95], v[94:95]
    v_pk_fma_f32 v[212:213], v[212:213], v[208:209], v[208:209] op_sel:[0,1,0] op_sel_hi:[1,1,0]
    v_pk_fma_f32 v[214:215], v[214:215], v[208:209], v[208:209] op_sel:[0,1,0] op_sel_hi:[1,1,0]
    v_pk_fma_f32 v[216:217], v[216:217], v[208:209], v[208:209] op_sel:[0,1,0] op_sel_hi:[1,1,0]
    v_pk_fma_f32 v[218:219], v[218:219], v[208:209], v[208:209] op_sel:[0,1,0] op_sel_hi:[1,1,0]
    v_pk_mul_f32 v[212:213], v[212:213], v[88:89]
    v_pk_mul_f32 v[214:215], v[214:215], v[90:91]
    v_pk_mul_f32 v[216:217], v[216:217], v[92:93]
    v_pk_mul_f32 v[218:219], v[218:219], v[94:95]
    v_exp_f32 v212, v212
    v_exp_f32 v213, v213
    v_exp_f32 v214, v214
    v_exp_f32 v215, v215
    v_exp_f32 v216, v216
    v_exp_f32 v217, v217
    v_exp_f32 v218, v218
    v_exp_f32 v219, v219
    v_pk_mul_f32 v[88:89], v[88:89], v[120:121]
    v_pk_mul_f32 v[90:91], v[90:91], v[122:123]
    v_pk_mul_f32 v[92:93], v[92:93], v[124:125]
    v_pk_mul_f32 v[94:95], v[94:95], v[126:127]
    v_pk_add_f32 v[212:213], v[212:213], v[210:211] op_sel_hi:[1,0]
    v_pk_add_f32 v[214:215], v[214:215], v[210:211] op_sel_hi:[1,0]
    v_pk_add_f32 v[216:217], v[216:217], v[210:211] op_sel_hi:[1,0]
    v_pk_add_f32 v[218:219], v[218:219], v[210:211] op_sel_hi:[1,0]
    v_rcp_f32 v212, v212
    v_rcp_f32 v213, v213
    v_rcp_f32 v214, v214
    v_rcp_f32 v215, v215
    v_rcp_f32 v216, v216
    v_rcp_f32 v217, v217
    v_rcp_f32 v218, v218
    v_rcp_f32 v219, v219
    s_nop 0
    v_pk_mul_f32 v[88:89], v[88:89], v[212:213]
    v_pk_mul_f32 v[90:91], v[90:91], v[214:215]
    v_pk_mul_f32 v[92:93], v[92:93], v[216:217]
    v_pk_mul_f32 v[94:95], v[94:95], v[218:219]
    v_cvt_pk_bf16_f32 v200, v80, v81
    v_cvt_pk_bf16_f32 v201, v82, v83
    v_cvt_pk_bf16_f32 v202, v84, v85
    v_cvt_pk_bf16_f32 v203, v86, v87
    v_cvt_pk_bf16_f32 v204, v88, v89
    v_cvt_pk_bf16_f32 v205, v90, v91
    v_cvt_pk_bf16_f32 v206, v92, v93
    v_cvt_pk_bf16_f32 v207, v94, v95
    buffer_store_dwordx4 v[200:203], v1, s[32:35], s66 offen sc0 sc1
    buffer_store_dwordx4 v[204:207], v1, s[32:35], s66 offen offset:1024 sc0 sc1
    s_add_u32 s12, s4, 0x7000000
    s_addc_u32 s13, s5, 0
    s_mov_b32 s14, 0x5c0000
    s_mov_b32 s15, 0x00020000
    s_lshl_b32 s66, s54, 10
    s_add_u32 s67, s66, 2048
    s_cmp_eq_u32 s40, 7
    s_cselect_b32 s67, 0x7ff00000, s67
    s_waitcnt vmcnt(16)

    v_lshl_or_b32 v32, v221, 16, v220
    v_lshl_or_b32 v33, v223, 16, v222
    v_lshl_or_b32 v34, v225, 16, v224
    v_lshl_or_b32 v35, v227, 16, v226
    v_lshl_or_b32 v36, v229, 16, v228
    v_lshl_or_b32 v37, v231, 16, v230
    v_lshl_or_b32 v38, v233, 16, v232
    v_lshl_or_b32 v39, v235, 16, v234
    v_lshl_or_b32 v40, v237, 16, v236
    v_lshl_or_b32 v41, v239, 16, v238
    v_lshl_or_b32 v42, v241, 16, v240
    v_lshl_or_b32 v43, v243, 16, v242
    buffer_store_dwordx4 v[32:35], v1, s[12:15], s66 offen sc0 sc1
    buffer_store_dwordx4 v[36:39], v1, s[12:15], s66 offen offset:1024 sc0 sc1
    buffer_store_dwordx4 v[40:43], v1, s[12:15], s67 offen sc0 sc1

    s_waitcnt lgkmcnt(0)
    s_barrier
    s_cmp_eq_u32 s52, s65
    s_cselect_b32 s66, 0, 32768
    s_cselect_b32 s67, 32768, 0
    s_lshl_b32 s68, s46, 13
    s_add_u32 s68, s68, 98304
    s_add_u32 s66, s66, s68
    s_add_u32 s67, s67, s68
    v_add_u32 v6, s66, v1
    v_add_u32 v7, s67, v1

    ds_read_b128 v[40:43], v6 offset:0
    ds_read_b128 v[44:47], v6 offset:1024
    ds_read_b128 v[48:51], v6 offset:2048
    ds_read_b128 v[52:55], v6 offset:3072
    ds_read_b128 v[56:59], v6 offset:4096
    ds_read_b128 v[60:63], v6 offset:5120
    ds_read_b128 v[64:67], v6 offset:6144
    ds_read_b128 v[68:71], v6 offset:7168
    ds_read_b128 v[72:75], v7 offset:0
    ds_read_b128 v[76:79], v7 offset:1024
    ds_read_b128 v[80:83], v7 offset:2048
    ds_read_b128 v[84:87], v7 offset:3072
    ds_read_b128 v[88:91], v7 offset:4096
    ds_read_b128 v[92:95], v7 offset:5120
    ds_read_b128 v[96:99], v7 offset:6144
    ds_read_b128 v[100:103], v7 offset:7168
    s_waitcnt lgkmcnt(0)
    v_and_b32 v7, 31, v0
    v_lshrrev_b32 v6, 5, v0
    v_lshlrev_b32 v6, 2, v6
    v_sub_u32 v7, v7, v6
    s_lshl_b32 s66, s46, 5
    s_lshl_b32 s67, s45, 6
    s_sub_u32 s66, s66, s67
    v_add_u32 v7, s66, v7
    s_mov_b32 s62, 0
    s_mov_b32 s54, s65
    s_lshl_b32 s66, s45, 14
    v_add_u32 v2, s66, v1
    s_add_u32 s66, s66, 98304
    v_add_u32 v3, s66, v1

    s_waitcnt vmcnt(8)
    s_barrier
blk_top_28:
    v_mov_b64 v[168:169], 0
    v_mov_b64 v[170:171], 0
    v_mov_b64 v[172:173], 0
    v_mov_b64 v[174:175], 0
    v_mov_b64 v[176:177], 0
    v_mov_b64 v[178:179], 0
    v_mov_b64 v[180:181], 0
    v_mov_b64 v[182:183], 0
    v_mov_b64 v[184:185], 0
    v_mov_b64 v[186:187], 0
    v_mov_b64 v[188:189], 0
    v_mov_b64 v[190:191], 0
    v_mov_b64 v[192:193], 0
    v_mov_b64 v[194:195], 0
    v_mov_b64 v[196:197], 0
    v_mov_b64 v[198:199], 0
    v_mov_b64 v[200:201], 0
    v_mov_b64 v[202:203], 0
    v_mov_b64 v[204:205], 0
    v_mov_b64 v[206:207], 0
    v_mov_b64 v[208:209], 0
    v_mov_b64 v[210:211], 0
    v_mov_b64 v[212:213], 0
    v_mov_b64 v[214:215], 0
    v_mov_b64 v[216:217], 0
    v_mov_b64 v[218:219], 0
    v_mov_b64 v[220:221], 0
    v_mov_b64 v[222:223], 0
    v_mov_b64 v[224:225], 0
    v_mov_b64 v[226:227], 0
    v_mov_b64 v[228:229], 0
    v_mov_b64 v[230:231], 0
    v_mov_b64 v[136:137], 0
    v_mov_b64 v[138:139], 0
    v_mov_b64 v[140:141], 0
    v_mov_b64 v[142:143], 0
    v_mov_b64 v[144:145], 0
    v_mov_b64 v[146:147], 0
    v_mov_b64 v[148:149], 0
    v_mov_b64 v[150:151], 0
    v_mov_b32 v4, 0
    v_mov_b32 v245, 0xe0ad78ec
    v_mov_b32 v246, 0x4e800000
    v_mov_b32 v247, 0xf149f2ca
    s_mov_b32 s55, 0

    ds_read_b128 v[8:11], v2 offset:0
    ds_read_b128 v[12:15], v2 offset:1024
    ds_read_b128 v[16:19], v2 offset:2048
    ds_read_b128 v[20:23], v2 offset:3072
    s_cmp_eq_u32 s54, 0
    s_cbranch_scc1 only_29
    s_waitcnt lgkmcnt(0)
    v_mfma_f32_32x32x16_bf16 v[104:119], v[8:11], v[40:43], v[136:151]
    ds_read_b128 v[24:27], v2 offset:4096
    ds_read_b128 v[28:31], v2 offset:5120
    v_mfma_f32_32x32x16_bf16 v[104:119], v[12:15], v[44:47], v[104:119]
    ds_read_b128 v[32:35], v2 offset:6144
    ds_read_b128 v[36:39], v2 offset:7168
    v_mfma_f32_32x32x16_bf16 v[104:119], v[16:19], v[48:51], v[104:119]
    v_mfma_f32_32x32x16_bf16 v[104:119], v[20:23], v[52:55], v[104:119]
    s_waitcnt lgkmcnt(0)
    v_mfma_f32_32x32x16_bf16 v[104:119], v[24:27], v[56:59], v[104:119]
    ds_read_b128 v[8:11], v2 offset:8192
    ds_read_b128 v[12:15], v2 offset:9216
    v_mfma_f32_32x32x16_bf16 v[104:119], v[28:31], v[60:63], v[104:119]
    ds_read_b128 v[16:19], v2 offset:10240
    ds_read_b128 v[20:23], v2 offset:11264
    v_mfma_f32_32x32x16_bf16 v[104:119], v[32:35], v[64:67], v[104:119]
    s_mov_b32 m0, s60
    s_mov_b32 s73, s58
    s_xor_b32 s60, s60, 32768
    s_add_u32 s58, s58, 32768
    s_cmp_eq_u32 s64, s65
    s_cselect_b32 s58, s61, s58
    s_add_u32 s64, s64, 1
    v_xor_b32 v3, 0x8000, v3
    v_mfma_f32_32x32x16_bf16 v[104:119], v[36:39], v[68:71], v[104:119]
    s_waitcnt vmcnt(4)
    s_barrier
    s_waitcnt lgkmcnt(0)
    v_mfma_f32_32x32x16_bf16 v[120:135], v[8:11], v[40:43], v[136:151]
    ds_read_b128 v[24:27], v2 offset:12288
    ds_read_b128 v[28:31], v2 offset:13312
    v_mfma_f32_32x32x16_bf16 v[120:135], v[12:15], v[44:47], v[120:135]
    ds_read_b128 v[32:35], v2 offset:14336
    ds_read_b128 v[36:39], v2 offset:15360
    buffer_load_dwordx4 v1, s[28:31], s73 offen offset:0 lds
    v_mfma_f32_32x32x16_bf16 v[120:135], v[16:19], v[48:51], v[120:135]
    buffer_load_dwordx4 v1, s[28:31], s73 offen offset:1024 lds
    v_max3_f32 v234, v104, v105, v106
    v_max3_f32 v234, v234, v107, v108
    v_max3_f32 v234, v234, v109, v110
    v_max3_f32 v234, v234, v111, v112
    v_max3_f32 v234, v234, v113, v114
    v_max3_f32 v234, v234, v115, v116
    v_max3_f32 v234, v234, v117, v118
    v_max_f32 v234, v234, v119
    v_mov_b32 v235, v234
    s_nop 1
    v_permlane32_swap_b32 v234, v235
    s_nop 1
    v_mfma_f32_32x32x16_bf16 v[120:135], v[20:23], v[52:55], v[120:135]
    buffer_load_dwordx4 v1, s[28:31], s73 offen offset:2048 lds
    v_max_f32 v234, v234, v235
    v_max_f32 v234, v245, v234
    v_sub_f32 v104, v104, v234
    v_sub_f32 v105, v105, v234
    v_sub_f32 v106, v106, v234
    v_sub_f32 v107, v107, v234
    v_sub_f32 v108, v108, v234
    v_sub_f32 v109, v109, v234
    v_sub_f32 v110, v110, v234
    v_sub_f32 v111, v111, v234
    v_sub_f32 v112, v112, v234
    v_sub_f32 v113, v113, v234
    s_waitcnt lgkmcnt(0)
    v_mfma_f32_32x32x16_bf16 v[120:135], v[24:27], v[56:59], v[120:135]
    ds_read_b128 v[8:11], v3 offset:0
    ds_read_b128 v[12:15], v3 offset:2048
    buffer_load_dwordx4 v1, s[28:31], s73 offen offset:3072 lds
    v_sub_f32 v114, v114, v234
    v_sub_f32 v115, v115, v234
    v_sub_f32 v116, v116, v234
    v_sub_f32 v117, v117, v234
    v_sub_f32 v118, v118, v234
    v_sub_f32 v119, v119, v234
    v_exp_f32 v104, v104
    v_exp_f32 v105, v105
    v_exp_f32 v106, v106
    v_exp_f32 v107, v107
    v_add_f32 v244, v4, v104
    v_cvt_pk_bf16_f32 v152, v104, v105
    v_mfma_f32_32x32x16_bf16 v[120:135], v[28:31], v[60:63], v[120:135]
    ds_read_b128 v[16:19], v3 offset:4096
    ds_read_b128 v[20:23], v3 offset:6144
    v_exp_f32 v108, v108
    v_exp_f32 v109, v109
    v_add_f32 v244, v244, v106
    v_add_f32 v232, v105, v107
    v_cvt_pk_bf16_f32 v153, v106, v107
    v_exp_f32 v110, v110
    v_exp_f32 v111, v111
    v_add_f32 v244, v244, v108
    v_add_f32 v232, v232, v109
    v_cvt_pk_bf16_f32 v154, v108, v109
    v_exp_f32 v112, v112
    v_exp_f32 v113, v113
    v_mfma_f32_32x32x16_bf16 v[120:135], v[32:35], v[64:67], v[120:135]
    s_mov_b32 m0, s59
    s_mov_b32 s72, s57
    s_xor_b32 s59, s59, 32768
    s_add_u32 s57, s57, 32768
    s_cmp_eq_u32 s63, s65
    s_cselect_b32 s57, s61, s57
    s_add_u32 s63, s63, 1
    v_xor_b32 v2, 0x8000, v2
    v_add_f32 v244, v244, v110
    v_add_f32 v232, v232, v111
    v_cvt_pk_bf16_f32 v155, v110, v111
    v_exp_f32 v114, v114
    v_exp_f32 v115, v115
    v_add_f32 v244, v244, v112
    v_add_f32 v232, v232, v113
    v_cvt_pk_bf16_f32 v156, v112, v113
    v_exp_f32 v116, v116
    v_exp_f32 v117, v117
    v_add_f32 v244, v244, v114
    v_mfma_f32_32x32x16_bf16 v[120:135], v[36:39], v[68:71], v[120:135]
    v_add_f32 v232, v232, v115
    v_cvt_pk_bf16_f32 v157, v114, v115
    v_exp_f32 v118, v118
    v_exp_f32 v119, v119
    v_add_f32 v244, v244, v116
    v_add_f32 v232, v232, v117
    v_cvt_pk_bf16_f32 v158, v116, v117
    v_add_f32 v244, v244, v118
    v_add_f32 v232, v232, v119
    v_cvt_pk_bf16_f32 v159, v118, v119
    v_add_f32 v244, v244, v232
    v_cmp_nle_f32 vcc, v244, v246
    s_cbranch_vccnz resc_33
back_34:
    s_waitcnt vmcnt(4)
    s_barrier
    s_cmp_lg_u32 s40, 7
    s_cbranch_scc1 st3_35
    s_lshl_b32 s66, s62, 7
    s_or_b32 s66, s66, s74
    s_or_b32 s66, s66, 0x60
    v_mov_b32 v237, 0
    v_mov_b32 v236, s66
    s_mov_b64 exec, 1
    buffer_store_byte v236, v237, s[76:79], s2 offen sc0 sc1
    s_mov_b64 exec, -1
st3_35:
    s_waitcnt lgkmcnt(0)
    v_mfma_f32_32x32x16_bf16 v[168:183], v[8:11], v[152:155], v[168:183]
    ds_read_b128 v[24:27], v3 offset:1024
    ds_read_b128 v[28:31], v3 offset:3072
    v_mfma_f32_32x32x16_bf16 v[184:199], v[12:15], v[152:155], v[184:199]
    ds_read_b128 v[32:35], v3 offset:5120
    ds_read_b128 v[36:39], v3 offset:7168
    buffer_load_dwordx4 v1, s[24:27], s72 offen offset:0 lds
    v_mfma_f32_32x32x16_bf16 v[200:215], v[16:19], v[152:155], v[200:215]
    v_sub_f32 v136, 0, v234
    v_sub_f32 v137, 0, v234
    v_sub_f32 v138, 0, v234
    v_sub_f32 v139, 0, v234
    v_sub_f32 v140, 0, v234
    v_sub_f32 v141, 0, v234
    v_sub_f32 v142, 0, v234
    v_sub_f32 v143, 0, v234
    v_sub_f32 v144, 0, v234
    v_mfma_f32_32x32x16_bf16 v[216:231], v[20:23], v[152:155], v[216:231]
    buffer_load_dwordx4 v1, s[24:27], s72 offen offset:1024 lds
    v_sub_f32 v145, 0, v234
    v_sub_f32 v146, 0, v234
    v_sub_f32 v147, 0, v234
    v_sub_f32 v148, 0, v234
    v_sub_f32 v149, 0, v234
    v_sub_f32 v150, 0, v234
    v_sub_f32 v151, 0, v234
    v_sub_f32 v120, v120, v234
    v_sub_f32 v121, v121, v234
    s_waitcnt lgkmcnt(0)
    v_mfma_f32_32x32x16_bf16 v[168:183], v[24:27], v[156:159], v[168:183]
    ds_read_b128 v[8:11], v2 offset:0
    ds_read_b128 v[12:15], v2 offset:1024
    v_sub_f32 v122, v122, v234
    v_sub_f32 v123, v123, v234
    v_sub_f32 v124, v124, v234
    v_sub_f32 v125, v125, v234
    v_sub_f32 v126, v126, v234
    v_sub_f32 v127, v127, v234
    v_sub_f32 v128, v128, v234
    v_sub_f32 v129, v129, v234
    v_mfma_f32_32x32x16_bf16 v[184:199], v[28:31], v[156:159], v[184:199]
    ds_read_b128 v[16:19], v2 offset:2048
    ds_read_b128 v[20:23], v2 offset:3072
    buffer_load_dwordx4 v1, s[24:27], s72 offen offset:2048 lds
    v_sub_f32 v130, v130, v234
    v_sub_f32 v131, v131, v234
    v_sub_f32 v132, v132, v234
    v_sub_f32 v133, v133, v234
    v_sub_f32 v134, v134, v234
    v_sub_f32 v135, v135, v234
    v_exp_f32 v120, v120
    v_exp_f32 v121, v121
    v_mfma_f32_32x32x16_bf16 v[200:215], v[32:35], v[156:159], v[200:215]
    v_exp_f32 v122, v122
    v_exp_f32 v123, v123
    v_add_f32 v4, v244, v120
    v_cvt_pk_bf16_f32 v160, v120, v121
    v_exp_f32 v124, v124
    v_exp_f32 v125, v125
    v_add_f32 v4, v4, v122
    v_add_f32 v233, v121, v123
    v_mfma_f32_32x32x16_bf16 v[216:231], v[36:39], v[156:159], v[216:231]
    buffer_load_dwordx4 v1, s[24:27], s72 offen offset:3072 lds
    v_cvt_pk_bf16_f32 v161, v122, v123
    v_exp_f32 v126, v126
    v_exp_f32 v127, v127
    v_add_f32 v4, v4, v124
    v_add_f32 v233, v233, v125
    v_cvt_pk_bf16_f32 v162, v124, v125
    v_exp_f32 v128, v128
    v_exp_f32 v129, v129
    s_mov_b32 s55, 1
    s_cmp_ge_u32 s55, s54
    s_cbranch_scc1 last_31
.p2align 6
mid_30:
    s_waitcnt lgkmcnt(0)
    v_mfma_f32_32x32x16_bf16 v[104:119], v[8:11], v[40:43], v[136:151]
    ds_read_b128 v[24:27], v2 offset:4096
    ds_read_b128 v[28:31], v2 offset:5120
    v_add_f32 v4, v4, v126
    v_add_f32 v233, v233, v127
    v_cvt_pk_bf16_f32 v163, v126, v127
    v_mfma_f32_32x32x16_bf16 v[104:119], v[12:15], v[44:47], v[104:119]
    ds_read_b128 v[32:35], v2 offset:6144
    ds_read_b128 v[36:39], v2 offset:7168
    v_exp_f32 v130, v130
    v_exp_f32 v131, v131
    v_add_f32 v4, v4, v128
    v_mfma_f32_32x32x16_bf16 v[104:119], v[16:19], v[48:51], v[104:119]
    v_add_f32 v233, v233, v129
    v_cvt_pk_bf16_f32 v164, v128, v129
    v_exp_f32 v132, v132
    v_mfma_f32_32x32x16_bf16 v[104:119], v[20:23], v[52:55], v[104:119]
    v_exp_f32 v133, v133
    v_add_f32 v4, v4, v130
    v_add_f32 v233, v233, v131
    s_waitcnt lgkmcnt(0)
    v_mfma_f32_32x32x16_bf16 v[104:119], v[24:27], v[56:59], v[104:119]
    ds_read_b128 v[8:11], v3 offset:8192
    ds_read_b128 v[12:15], v3 offset:10240
    v_cvt_pk_bf16_f32 v165, v130, v131
    v_exp_f32 v134, v134
    v_exp_f32 v135, v135
    v_mfma_f32_32x32x16_bf16 v[104:119], v[28:31], v[60:63], v[104:119]
    ds_read_b128 v[16:19], v3 offset:12288
    ds_read_b128 v[20:23], v3 offset:14336
    v_add_f32 v4, v4, v132
    v_add_f32 v233, v233, v133
    v_cvt_pk_bf16_f32 v166, v132, v133
    v_mfma_f32_32x32x16_bf16 v[104:119], v[32:35], v[64:67], v[104:119]
    v_add_f32 v4, v4, v134
    v_add_f32 v233, v233, v135
    v_mfma_f32_32x32x16_bf16 v[104:119], v[36:39], v[68:71], v[104:119]
    v_cvt_pk_bf16_f32 v167, v134, v135
    v_add_f32 v4, v4, v233
    v_cmp_nle_f32 vcc, v4, v246
    s_cbranch_vccnz resc_36
back_37:
    s_waitcnt lgkmcnt(0)
    v_mfma_f32_32x32x16_bf16 v[168:183], v[8:11], v[160:163], v[168:183]
    ds_read_b128 v[24:27], v3 offset:9216
    ds_read_b128 v[28:31], v3 offset:11264
    v_mfma_f32_32x32x16_bf16 v[184:199], v[12:15], v[160:163], v[184:199]
    ds_read_b128 v[32:35], v3 offset:13312
    ds_read_b128 v[36:39], v3 offset:15360
    v_mfma_f32_32x32x16_bf16 v[200:215], v[16:19], v[160:163], v[200:215]
    v_exp_f32 v104, v104
    v_exp_f32 v105, v105
    v_exp_f32 v106, v106
    v_mfma_f32_32x32x16_bf16 v[216:231], v[20:23], v[160:163], v[216:231]
    v_exp_f32 v107, v107
    v_add_f32 v244, v4, v104
    v_cvt_pk_bf16_f32 v152, v104, v105
    s_waitcnt lgkmcnt(0)
    v_mfma_f32_32x32x16_bf16 v[168:183], v[24:27], v[164:167], v[168:183]
    ds_read_b128 v[8:11], v2 offset:8192
    ds_read_b128 v[12:15], v2 offset:9216
    v_exp_f32 v108, v108
    v_exp_f32 v109, v109
    v_add_f32 v244, v244, v106
    v_mfma_f32_32x32x16_bf16 v[184:199], v[28:31], v[164:167], v[184:199]
    ds_read_b128 v[16:19], v2 offset:10240
    ds_read_b128 v[20:23], v2 offset:11264
    v_add_f32 v232, v105, v107
    v_cvt_pk_bf16_f32 v153, v106, v107
    v_exp_f32 v110, v110
    v_mfma_f32_32x32x16_bf16 v[200:215], v[32:35], v[164:167], v[200:215]
    s_mov_b32 m0, s60
    s_mov_b32 s73, s58
    s_xor_b32 s60, s60, 32768
    s_add_u32 s58, s58, 32768
    s_cmp_eq_u32 s64, s65
    s_cselect_b32 s58, s61, s58
    s_add_u32 s64, s64, 1
    v_xor_b32 v3, 0x8000, v3
    v_exp_f32 v111, v111
    v_add_f32 v244, v244, v108
    v_add_f32 v232, v232, v109
    v_mfma_f32_32x32x16_bf16 v[216:231], v[36:39], v[164:167], v[216:231]
    v_cvt_pk_bf16_f32 v154, v108, v109
    v_exp_f32 v112, v112
    s_waitcnt vmcnt(4)
    s_barrier
    s_waitcnt lgkmcnt(0)
    v_mfma_f32_32x32x16_bf16 v[120:135], v[8:11], v[40:43], v[136:151]
    ds_read_b128 v[24:27], v2 offset:12288
    ds_read_b128 v[28:31], v2 offset:13312
    v_exp_f32 v113, v113
    v_add_f32 v244, v244, v110
    v_add_f32 v232, v232, v111
    v_mfma_f32_32x32x16_bf16 v[120:135], v[12:15], v[44:47], v[120:135]
    ds_read_b128 v[32:35], v2 offset:14336
    ds_read_b128 v[36:39], v2 offset:15360
    buffer_load_dwordx4 v1, s[28:31], s73 offen offset:0 lds
    v_cvt_pk_bf16_f32 v155, v110, v111
    v_exp_f32 v114, v114
    v_exp_f32 v115, v115
    v_mfma_f32_32x32x16_bf16 v[120:135], v[16:19], v[48:51], v[120:135]
    buffer_load_dwordx4 v1, s[28:31], s73 offen offset:1024 lds
    v_add_f32 v244, v244, v112
    v_add_f32 v232, v232, v113
    v_cvt_pk_bf16_f32 v156, v112, v113
    v_mfma_f32_32x32x16_bf16 v[120:135], v[20:23], v[52:55], v[120:135]
    buffer_load_dwordx4 v1, s[28:31], s73 offen offset:2048 lds
    v_exp_f32 v116, v116
    v_exp_f32 v117, v117
    v_add_f32 v244, v244, v114
    s_waitcnt lgkmcnt(0)
    v_mfma_f32_32x32x16_bf16 v[120:135], v[24:27], v[56:59], v[120:135]
    ds_read_b128 v[8:11], v3 offset:0
    ds_read_b128 v[12:15], v3 offset:2048
    buffer_load_dwordx4 v1, s[28:31], s73 offen offset:3072 lds
    v_add_f32 v232, v232, v115
    v_cvt_pk_bf16_f32 v157, v114, v115
    v_exp_f32 v118, v118
    v_mfma_f32_32x32x16_bf16 v[120:135], v[28:31], v[60:63], v[120:135]
    ds_read_b128 v[16:19], v3 offset:4096
    ds_read_b128 v[20:23], v3 offset:6144
    v_exp_f32 v119, v119
    v_add_f32 v244, v244, v116
    v_add_f32 v232, v232, v117
    v_mfma_f32_32x32x16_bf16 v[120:135], v[32:35], v[64:67], v[120:135]
    s_mov_b32 m0, s59
    s_mov_b32 s72, s57
    s_xor_b32 s59, s59, 32768
    s_add_u32 s57, s57, 32768
    s_cmp_eq_u32 s63, s65
    s_cselect_b32 s57, s61, s57
    s_add_u32 s63, s63, 1
    v_xor_b32 v2, 0x8000, v2
    v_cvt_pk_bf16_f32 v158, v116, v117
    v_add_f32 v244, v244, v118
    v_add_f32 v232, v232, v119
    v_mfma_f32_32x32x16_bf16 v[120:135], v[36:39], v[68:71], v[120:135]
    v_cvt_pk_bf16_f32 v159, v118, v119
    v_add_f32 v244, v244, v232
    v_cmp_nle_f32 vcc, v244, v246
    s_cbranch_vccnz resc_38
back_39:
    s_waitcnt vmcnt(4)
    s_barrier
    s_waitcnt lgkmcnt(0)
    v_mfma_f32_32x32x16_bf16 v[168:183], v[8:11], v[152:155], v[168:183]
    ds_read_b128 v[24:27], v3 offset:1024
    ds_read_b128 v[28:31], v3 offset:3072
    v_mfma_f32_32x32x16_bf16 v[184:199], v[12:15], v[152:155], v[184:199]
    ds_read_b128 v[32:35], v3 offset:5120
    ds_read_b128 v[36:39], v3 offset:7168
    buffer_load_dwordx4 v1, s[24:27], s72 offen offset:0 lds
    v_mfma_f32_32x32x16_bf16 v[200:215], v[16:19], v[152:155], v[200:215]
    v_exp_f32 v120, v120
    v_exp_f32 v121, v121
    v_exp_f32 v122, v122
    v_mfma_f32_32x32x16_bf16 v[216:231], v[20:23], v[152:155], v[216:231]
    buffer_load_dwordx4 v1, s[24:27], s72 offen offset:1024 lds
    v_exp_f32 v123, v123
    v_add_f32 v4, v244, v120
    v_cvt_pk_bf16_f32 v160, v120, v121
    s_waitcnt lgkmcnt(0)
    v_mfma_f32_32x32x16_bf16 v[168:183], v[24:27], v[156:159], v[168:183]
    ds_read_b128 v[8:11], v2 offset:0
    ds_read_b128 v[12:15], v2 offset:1024
    v_exp_f32 v124, v124
    v_exp_f32 v125, v125
    v_add_f32 v4, v4, v122
    v_mfma_f32_32x32x16_bf16 v[184:199], v[28:31], v[156:159], v[184:199]
    ds_read_b128 v[16:19], v2 offset:2048
    ds_read_b128 v[20:23], v2 offset:3072
    buffer_load_dwordx4 v1, s[24:27], s72 offen offset:2048 lds
    v_add_f32 v233, v121, v123
    v_cvt_pk_bf16_f32 v161, v122, v123
    v_exp_f32 v126, v126
    v_mfma_f32_32x32x16_bf16 v[200:215], v[32:35], v[156:159], v[200:215]
    v_exp_f32 v127, v127
    v_add_f32 v4, v4, v124
    v_add_f32 v233, v233, v125
    v_mfma_f32_32x32x16_bf16 v[216:231], v[36:39], v[156:159], v[216:231]
    buffer_load_dwordx4 v1, s[24:27], s72 offen offset:3072 lds
    v_cvt_pk_bf16_f32 v162, v124, v125
    v_exp_f32 v128, v128
    v_exp_f32 v129, v129
    s_add_u32 s55, s55, 1
    s_cmp_lt_u32 s55, s54
    s_cbranch_scc1 mid_30
last_31:
    s_waitcnt lgkmcnt(0)
    s_cmp_lt_i32 s56, 1
    s_cbranch_scc1 msk_40
    v_mfma_f32_32x32x16_bf16 v[104:119], v[8:11], v[40:43], v[136:151]
msk_40:
    ds_read_b128 v[24:27], v2 offset:4096
    ds_read_b128 v[28:31], v2 offset:5120
    v_add_f32 v4, v4, v126
    v_add_f32 v233, v233, v127
    v_cvt_pk_bf16_f32 v163, v126, v127
    s_cmp_lt_i32 s56, 1
    s_cbranch_scc1 msk_41
    v_mfma_f32_32x32x16_bf16 v[104:119], v[12:15], v[44:47], v[104:119]
msk_41:
    ds_read_b128 v[32:35], v2 offset:6144
    ds_read_b128 v[36:39], v2 offset:7168
    v_exp_f32 v130, v130
    v_exp_f32 v131, v131
    v_add_f32 v4, v4, v128
    s_cmp_lt_i32 s56, 1
    s_cbranch_scc1 msk_42
    v_mfma_f32_32x32x16_bf16 v[104:119], v[16:19], v[48:51], v[104:119]
msk_42:
    v_add_f32 v233, v233, v129
    v_cvt_pk_bf16_f32 v164, v128, v129
    v_exp_f32 v132, v132
    s_cmp_lt_i32 s56, 1
    s_cbranch_scc1 msk_43
    v_mfma_f32_32x32x16_bf16 v[104:119], v[20:23], v[52:55], v[104:119]
msk_43:
    v_exp_f32 v133, v133
    v_add_f32 v4, v4, v130
    v_add_f32 v233, v233, v131
    s_waitcnt lgkmcnt(0)
    s_cmp_lt_i32 s56, 1
    s_cbranch_scc1 msk_44
    v_mfma_f32_32x32x16_bf16 v[104:119], v[24:27], v[56:59], v[104:119]
msk_44:
    ds_read_b128 v[8:11], v3 offset:8192
    ds_read_b128 v[12:15], v3 offset:10240
    v_cvt_pk_bf16_f32 v165, v130, v131
    v_exp_f32 v134, v134
    v_exp_f32 v135, v135
    s_cmp_lt_i32 s56, 1
    s_cbranch_scc1 msk_45
    v_mfma_f32_32x32x16_bf16 v[104:119], v[28:31], v[60:63], v[104:119]
msk_45:
    ds_read_b128 v[16:19], v3 offset:12288
    ds_read_b128 v[20:23], v3 offset:14336
    v_add_f32 v4, v4, v132
    v_add_f32 v233, v233, v133
    v_cvt_pk_bf16_f32 v166, v132, v133
    s_cmp_lt_i32 s56, 1
    s_cbranch_scc1 msk_46
    v_mfma_f32_32x32x16_bf16 v[104:119], v[32:35], v[64:67], v[104:119]
msk_46:
    v_add_f32 v4, v4, v134
    v_add_f32 v233, v233, v135
    s_cmp_lt_i32 s56, 1
    s_cbranch_scc1 msk_47
    v_mfma_f32_32x32x16_bf16 v[104:119], v[36:39], v[68:71], v[104:119]
msk_47:
    v_cvt_pk_bf16_f32 v167, v134, v135
    v_add_f32 v4, v4, v233
    v_cmp_nle_f32 vcc, v4, v246
    s_cbranch_vccnz resc_48
back_49:
    s_waitcnt lgkmcnt(0)
    v_mfma_f32_32x32x16_bf16 v[168:183], v[8:11], v[160:163], v[168:183]
    ds_read_b128 v[24:27], v3 offset:9216
    ds_read_b128 v[28:31], v3 offset:11264
    v_mfma_f32_32x32x16_bf16 v[184:199], v[12:15], v[160:163], v[184:199]
    ds_read_b128 v[32:35], v3 offset:13312
    ds_read_b128 v[36:39], v3 offset:15360
    v_mfma_f32_32x32x16_bf16 v[200:215], v[16:19], v[160:163], v[200:215]
    v_cmp_gt_i32 s[12:13], 0, v7
    v_cmp_gt_i32 s[14:15], 1, v7
    v_cmp_gt_i32 s[16:17], 2, v7
    v_cmp_gt_i32 s[18:19], 3, v7
    v_cndmask_b32 v104, v104, v247, s[12:13]
    v_mfma_f32_32x32x16_bf16 v[216:231], v[20:23], v[160:163], v[216:231]
    v_cndmask_b32 v105, v105, v247, s[14:15]
    v_cndmask_b32 v106, v106, v247, s[16:17]
    v_cndmask_b32 v107, v107, v247, s[18:19]
    v_cmp_gt_i32 s[12:13], 8, v7
    v_cmp_gt_i32 s[14:15], 9, v7
    s_waitcnt lgkmcnt(0)
    v_mfma_f32_32x32x16_bf16 v[168:183], v[24:27], v[164:167], v[168:183]
    ds_read_b128 v[8:11], v2 offset:8192
    ds_read_b128 v[12:15], v2 offset:9216
    v_cmp_gt_i32 s[16:17], 10, v7
    v_cmp_gt_i32 s[18:19], 11, v7
    v_cndmask_b32 v108, v108, v247, s[12:13]
    v_cndmask_b32 v109, v109, v247, s[14:15]
    v_cndmask_b32 v110, v110, v247, s[16:17]
    v_mfma_f32_32x32x16_bf16 v[184:199], v[28:31], v[164:167], v[184:199]
    ds_read_b128 v[16:19], v2 offset:10240
    ds_read_b128 v[20:23], v2 offset:11264
    v_cndmask_b32 v111, v111, v247, s[18:19]
    v_cmp_gt_i32 s[12:13], 16, v7
    v_cmp_gt_i32 s[14:15], 17, v7
    v_cmp_gt_i32 s[16:17], 18, v7
    v_cmp_gt_i32 s[18:19], 19, v7
    v_mfma_f32_32x32x16_bf16 v[200:215], v[32:35], v[164:167], v[200:215]
    s_mov_b32 m0, s60
    s_mov_b32 s73, s58
    s_xor_b32 s60, s60, 32768
    s_add_u32 s58, s58, 32768
    s_cmp_eq_u32 s64, s65
    s_cselect_b32 s58, s61, s58
    s_add_u32 s64, s64, 1
    v_xor_b32 v3, 0x8000, v3
    v_cndmask_b32 v112, v112, v247, s[12:13]
    v_cndmask_b32 v113, v113, v247, s[14:15]
    v_cndmask_b32 v114, v114, v247, s[16:17]
    v_cndmask_b32 v115, v115, v247, s[18:19]
    v_cmp_gt_i32 s[12:13], 24, v7
    v_mfma_f32_32x32x16_bf16 v[216:231], v[36:39], v[164:167], v[216:231]
    v_cmp_gt_i32 s[14:15], 25, v7
    v_cmp_gt_i32 s[16:17], 26, v7
    v_cmp_gt_i32 s[18:19], 27, v7
    v_cndmask_b32 v116, v116, v247, s[12:13]
    v_cndmask_b32 v117, v117, v247, s[14:15]
    s_waitcnt vmcnt(4)
    s_barrier
    s_waitcnt lgkmcnt(0)
    s_cmp_lt_i32 s56, 2
    s_cbranch_scc1 msk_50
    v_mfma_f32_32x32x16_bf16 v[120:135], v[8:11], v[40:43], v[136:151]
msk_50:
    ds_read_b128 v[24:27], v2 offset:12288
    ds_read_b128 v[28:31], v2 offset:13312
    v_cndmask_b32 v118, v118, v247, s[16:17]
    v_cndmask_b32 v119, v119, v247, s[18:19]
    v_exp_f32 v104, v104
    v_exp_f32 v105, v105
    v_exp_f32 v106, v106
    v_exp_f32 v107, v107
    s_cmp_lt_i32 s56, 2
    s_cbranch_scc1 msk_51
    v_mfma_f32_32x32x16_bf16 v[120:135], v[12:15], v[44:47], v[120:135]
msk_51:
    ds_read_b128 v[32:35], v2 offset:14336
    ds_read_b128 v[36:39], v2 offset:15360
    buffer_load_dwordx4 v1, s[28:31], s73 offen offset:0 lds
    v_add_f32 v244, v4, v104
    v_cvt_pk_bf16_f32 v152, v104, v105
    v_exp_f32 v108, v108
    v_exp_f32 v109, v109
    v_add_f32 v244, v244, v106
    v_add_f32 v232, v105, v107
    s_cmp_lt_i32 s56, 2
    s_cbranch_scc1 msk_52
    v_mfma_f32_32x32x16_bf16 v[120:135], v[16:19], v[48:51], v[120:135]
msk_52:
    buffer_load_dwordx4 v1, s[28:31], s73 offen offset:1024 lds
    v_cvt_pk_bf16_f32 v153, v106, v107
    v_exp_f32 v110, v110
    v_exp_f32 v111, v111
    v_add_f32 v244, v244, v108
    v_add_f32 v232, v232, v109
    s_cmp_lt_i32 s56, 2
    s_cbranch_scc1 msk_53
    v_mfma_f32_32x32x16_bf16 v[120:135], v[20:23], v[52:55], v[120:135]
msk_53:
    buffer_load_dwordx4 v1, s[28:31], s73 offen offset:2048 lds
    v_cvt_pk_bf16_f32 v154, v108, v109
    v_exp_f32 v112, v112
    v_exp_f32 v113, v113
    v_add_f32 v244, v244, v110
    v_add_f32 v232, v232, v111
    s_waitcnt lgkmcnt(0)
    s_cmp_lt_i32 s56, 2
    s_cbranch_scc1 msk_54
    v_mfma_f32_32x32x16_bf16 v[120:135], v[24:27], v[56:59], v[120:135]
msk_54:
    ds_read_b128 v[8:11], v3 offset:0
    ds_read_b128 v[12:15], v3 offset:2048
    buffer_load_dwordx4 v1, s[28:31], s73 offen offset:3072 lds
    v_cvt_pk_bf16_f32 v155, v110, v111
    v_exp_f32 v114, v114
    v_exp_f32 v115, v115
    v_add_f32 v244, v244, v112
    v_add_f32 v232, v232, v113
    s_cmp_lt_i32 s56, 2
    s_cbranch_scc1 msk_55
    v_mfma_f32_32x32x16_bf16 v[120:135], v[28:31], v[60:63], v[120:135]
msk_55:
    ds_read_b128 v[16:19], v3 offset:4096
    ds_read_b128 v[20:23], v3 offset:6144
    v_cvt_pk_bf16_f32 v156, v112, v113
    v_exp_f32 v116, v116
    v_exp_f32 v117, v117
    v_add_f32 v244, v244, v114
    v_add_f32 v232, v232, v115
    s_cmp_lt_i32 s56, 2
    s_cbranch_scc1 msk_56
    v_mfma_f32_32x32x16_bf16 v[120:135], v[32:35], v[64:67], v[120:135]
msk_56:
    v_xor_b32 v2, 0x8000, v2
    v_cvt_pk_bf16_f32 v157, v114, v115
    v_exp_f32 v118, v118
    v_exp_f32 v119, v119
    v_add_f32 v244, v244, v116
    v_add_f32 v232, v232, v117
    s_cmp_lt_i32 s56, 2
    s_cbranch_scc1 msk_57
    v_mfma_f32_32x32x16_bf16 v[120:135], v[36:39], v[68:71], v[120:135]
msk_57:
    v_cvt_pk_bf16_f32 v158, v116, v117
    v_add_f32 v244, v244, v118
    v_add_f32 v232, v232, v119
    v_cvt_pk_bf16_f32 v159, v118, v119
    v_add_f32 v244, v244, v232
    v_cmp_nle_f32 vcc, v244, v246
    s_cbranch_vccnz resc_58
back_59:
    s_waitcnt vmcnt(4)
    s_barrier
    s_waitcnt lgkmcnt(0)
    s_cmp_lt_i32 s56, 1
    s_cbranch_scc1 msk_60
    v_mfma_f32_32x32x16_bf16 v[168:183], v[8:11], v[152:155], v[168:183]
msk_60:
    ds_read_b128 v[24:27], v3 offset:1024
    ds_read_b128 v[28:31], v3 offset:3072
    s_cmp_lt_i32 s56, 1
    s_cbranch_scc1 msk_61
    v_mfma_f32_32x32x16_bf16 v[184:199], v[12:15], v[152:155], v[184:199]
msk_61:
    ds_read_b128 v[32:35], v3 offset:5120
    ds_read_b128 v[36:39], v3 offset:7168
    s_cmp_lt_i32 s56, 1
    s_cbranch_scc1 msk_62
    v_mfma_f32_32x32x16_bf16 v[200:215], v[16:19], v[152:155], v[200:215]
msk_62:
    v_cmp_gt_i32 s[12:13], 32, v7
    v_cmp_gt_i32 s[14:15], 33, v7
    v_cmp_gt_i32 s[16:17], 34, v7
    v_cmp_gt_i32 s[18:19], 35, v7
    v_cndmask_b32 v120, v120, v247, s[12:13]
    v_cndmask_b32 v121, v121, v247, s[14:15]
    v_cndmask_b32 v122, v122, v247, s[16:17]
    v_cndmask_b32 v123, v123, v247, s[18:19]
    v_cmp_gt_i32 s[12:13], 40, v7
    s_cmp_lt_i32 s56, 1
    s_cbranch_scc1 msk_63
    v_mfma_f32_32x32x16_bf16 v[216:231], v[20:23], v[152:155], v[216:231]
msk_63:
    v_cmp_gt_i32 s[14:15], 41, v7
    v_cmp_gt_i32 s[16:17], 42, v7
    v_cmp_gt_i32 s[18:19], 43, v7
    v_cndmask_b32 v124, v124, v247, s[12:13]
    v_cndmask_b32 v125, v125, v247, s[14:15]
    v_cndmask_b32 v126, v126, v247, s[16:17]
    v_cndmask_b32 v127, v127, v247, s[18:19]
    v_cmp_gt_i32 s[12:13], 48, v7
    v_cmp_gt_i32 s[14:15], 49, v7
    s_waitcnt lgkmcnt(0)
    s_cmp_lt_i32 s56, 1
    s_cbranch_scc1 msk_64
    v_mfma_f32_32x32x16_bf16 v[168:183], v[24:27], v[156:159], v[168:183]
msk_64:
    ds_read_b128 v[8:11], v3 offset:8192
    ds_read_b128 v[12:15], v3 offset:10240
    v_cmp_gt_i32 s[16:17], 50, v7
    v_cmp_gt_i32 s[18:19], 51, v7
    v_cndmask_b32 v128, v128, v247, s[12:13]
    v_cndmask_b32 v129, v129, v247, s[14:15]
    v_cndmask_b32 v130, v130, v247, s[16:17]
    v_cndmask_b32 v131, v131, v247, s[18:19]
    v_cmp_gt_i32 s[12:13], 56, v7
    v_cmp_gt_i32 s[14:15], 57, v7
    s_cmp_lt_i32 s56, 1
    s_cbranch_scc1 msk_65
    v_mfma_f32_32x32x16_bf16 v[184:199], v[28:31], v[156:159], v[184:199]
msk_65:
    ds_read_b128 v[16:19], v3 offset:12288
    ds_read_b128 v[20:23], v3 offset:14336
    v_cmp_gt_i32 s[16:17], 58, v7
    v_cmp_gt_i32 s[18:19], 59, v7
    v_cndmask_b32 v132, v132, v247, s[12:13]
    v_cndmask_b32 v133, v133, v247, s[14:15]
    v_cndmask_b32 v134, v134, v247, s[16:17]
    v_cndmask_b32 v135, v135, v247, s[18:19]
    v_exp_f32 v120, v120
    v_exp_f32 v121, v121
    s_cmp_lt_i32 s56, 1
    s_cbranch_scc1 msk_66
    v_mfma_f32_32x32x16_bf16 v[200:215], v[32:35], v[156:159], v[200:215]
msk_66:
    v_exp_f32 v122, v122
    v_exp_f32 v123, v123
    v_add_f32 v4, v244, v120
    v_cvt_pk_bf16_f32 v160, v120, v121
    v_exp_f32 v124, v124
    v_exp_f32 v125, v125
    v_add_f32 v4, v4, v122
    v_add_f32 v233, v121, v123
    s_cmp_lt_i32 s56, 1
    s_cbranch_scc1 msk_67
    v_mfma_f32_32x32x16_bf16 v[216:231], v[36:39], v[156:159], v[216:231]
msk_67:
    v_cvt_pk_bf16_f32 v161, v122, v123
    v_exp_f32 v126, v126
    v_exp_f32 v127, v127
    v_add_f32 v4, v4, v124
    v_add_f32 v233, v233, v125
    v_cvt_pk_bf16_f32 v162, v124, v125
    v_exp_f32 v128, v128
    v_exp_f32 v129, v129
    v_add_f32 v4, v4, v126
    v_add_f32 v233, v233, v127
    v_cvt_pk_bf16_f32 v163, v126, v127
    v_exp_f32 v130, v130
    v_exp_f32 v131, v131
    v_add_f32 v4, v4, v128
    v_add_f32 v233, v233, v129
    v_cvt_pk_bf16_f32 v164, v128, v129
    v_exp_f32 v132, v132
    v_exp_f32 v133, v133
    v_add_f32 v4, v4, v130
    v_add_f32 v233, v233, v131
    v_cvt_pk_bf16_f32 v165, v130, v131
    v_exp_f32 v134, v134
    v_exp_f32 v135, v135
    v_add_f32 v4, v4, v132
    v_add_f32 v233, v233, v133
    v_cvt_pk_bf16_f32 v166, v132, v133
    v_add_f32 v4, v4, v134
    v_add_f32 v233, v233, v135
    v_cvt_pk_bf16_f32 v167, v134, v135
    v_add_f32 v4, v4, v233
    v_cmp_nle_f32 vcc, v4, v246
    s_cbranch_vccnz resc_68
back_69:
    s_nop 0
    s_waitcnt lgkmcnt(0)
    s_cmp_lt_i32 s56, 2
    s_cbranch_scc1 msk_70
    v_mfma_f32_32x32x16_bf16 v[168:183], v[8:11], v[160:163], v[168:183]
msk_70:
    ds_read_b128 v[24:27], v3 offset:9216
    ds_read_b128 v[28:31], v3 offset:11264
    s_cmp_lt_i32 s56, 2
    s_cbranch_scc1 msk_71
    v_mfma_f32_32x32x16_bf16 v[184:199], v[12:15], v[160:163], v[184:199]
msk_71:
    ds_read_b128 v[32:35], v3 offset:13312
    ds_read_b128 v[36:39], v3 offset:15360
    s_cmp_lt_i32 s56, 2
    s_cbranch_scc1 msk_72
    v_mfma_f32_32x32x16_bf16 v[200:215], v[16:19], v[160:163], v[200:215]
msk_72:
    s_cmp_lt_i32 s56, 2
    s_cbranch_scc1 msk_73
    v_mfma_f32_32x32x16_bf16 v[216:231], v[20:23], v[160:163], v[216:231]
msk_73:
    s_waitcnt lgkmcnt(0)
    s_cmp_lt_i32 s56, 2
    s_cbranch_scc1 msk_74
    v_mfma_f32_32x32x16_bf16 v[168:183], v[24:27], v[164:167], v[168:183]
msk_74:
    s_cmp_lt_i32 s56, 2
    s_cbranch_scc1 msk_75
    v_mfma_f32_32x32x16_bf16 v[184:199], v[28:31], v[164:167], v[184:199]
msk_75:
    s_cmp_lt_i32 s56, 2
    s_cbranch_scc1 msk_76
    v_mfma_f32_32x32x16_bf16 v[200:215], v[32:35], v[164:167], v[200:215]
msk_76:
    s_cmp_lt_i32 s56, 2
    s_cbranch_scc1 msk_77
    v_mfma_f32_32x32x16_bf16 v[216:231], v[36:39], v[164:167], v[216:231]
msk_77:
    s_branch merge_32
only_29:
    s_waitcnt lgkmcnt(0)
    s_cmp_lt_i32 s56, 1
    s_cbranch_scc1 msk_78
    v_mfma_f32_32x32x16_bf16 v[104:119], v[8:11], v[40:43], v[136:151]
msk_78:
    ds_read_b128 v[24:27], v2 offset:4096
    ds_read_b128 v[28:31], v2 offset:5120
    s_cmp_lt_i32 s56, 1
    s_cbranch_scc1 msk_79
    v_mfma_f32_32x32x16_bf16 v[104:119], v[12:15], v[44:47], v[104:119]
msk_79:
    ds_read_b128 v[32:35], v2 offset:6144
    ds_read_b128 v[36:39], v2 offset:7168
    s_cmp_lt_i32 s56, 1
    s_cbranch_scc1 msk_80
    v_mfma_f32_32x32x16_bf16 v[104:119], v[16:19], v[48:51], v[104:119]
msk_80:
    s_cmp_lt_i32 s56, 1
    s_cbranch_scc1 msk_81
    v_mfma_f32_32x32x16_bf16 v[104:119], v[20:23], v[52:55], v[104:119]
msk_81:
    s_waitcnt lgkmcnt(0)
    s_cmp_lt_i32 s56, 1
    s_cbranch_scc1 msk_82
    v_mfma_f32_32x32x16_bf16 v[104:119], v[24:27], v[56:59], v[104:119]
msk_82:
    ds_read_b128 v[8:11], v2 offset:8192
    ds_read_b128 v[12:15], v2 offset:9216
    s_cmp_lt_i32 s56, 1
    s_cbranch_scc1 msk_83
    v_mfma_f32_32x32x16_bf16 v[104:119], v[28:31], v[60:63], v[104:119]
msk_83:
    ds_read_b128 v[16:19], v2 offset:10240
    ds_read_b128 v[20:23], v2 offset:11264
    s_cmp_lt_i32 s56, 1
    s_cbranch_scc1 msk_84
    v_mfma_f32_32x32x16_bf16 v[104:119], v[32:35], v[64:67], v[104:119]
msk_84:
    s_mov_b32 m0, s60
    s_mov_b32 s73, s58
    s_xor_b32 s60, s60, 32768
    s_add_u32 s58, s58, 32768
    s_cmp_eq_u32 s64, s65
    s_cselect_b32 s58, s61, s58
    s_add_u32 s64, s64, 1
    v_xor_b32 v3, 0x8000, v3
    s_cmp_lt_i32 s56, 1
    s_cbranch_scc1 msk_85
    v_mfma_f32_32x32x16_bf16 v[104:119], v[36:39], v[68:71], v[104:119]
msk_85:
    s_waitcnt vmcnt(4)
    s_barrier
    s_waitcnt lgkmcnt(0)
    s_cmp_lt_i32 s56, 2
    s_cbranch_scc1 msk_86
    v_mfma_f32_32x32x16_bf16 v[120:135], v[8:11], v[40:43], v[136:151]
msk_86:
    ds_read_b128 v[24:27], v2 offset:12288
    ds_read_b128 v[28:31], v2 offset:13312
    s_cmp_lt_i32 s56, 2
    s_cbranch_scc1 msk_87
    v_mfma_f32_32x32x16_bf16 v[120:135], v[12:15], v[44:47], v[120:135]
msk_87:
    ds_read_b128 v[32:35], v2 offset:14336
    ds_read_b128 v[36:39], v2 offset:15360
    buffer_load_dwordx4 v1, s[28:31], s73 offen offset:0 lds
    s_cmp_lt_i32 s56, 2
    s_cbranch_scc1 msk_88
    v_mfma_f32_32x32x16_bf16 v[120:135], v[16:19], v[48:51], v[120:135]
msk_88:
    buffer_load_dwordx4 v1, s[28:31], s73 offen offset:1024 lds
    v_cmp_gt_i32 s[12:13], 0, v7
    v_cmp_gt_i32 s[14:15], 1, v7
    v_cmp_gt_i32 s[16:17], 2, v7
    v_cmp_gt_i32 s[18:19], 3, v7
    v_cndmask_b32 v104, v104, v247, s[12:13]
    v_cndmask_b32 v105, v105, v247, s[14:15]
    v_cndmask_b32 v106, v106, v247, s[16:17]
    v_cndmask_b32 v107, v107, v247, s[18:19]
    v_cmp_gt_i32 s[12:13], 8, v7
    v_cmp_gt_i32 s[14:15], 9, v7
    v_cmp_gt_i32 s[16:17], 10, v7
    v_cmp_gt_i32 s[18:19], 11, v7
    v_cndmask_b32 v108, v108, v247, s[12:13]
    v_cndmask_b32 v109, v109, v247, s[14:15]
    v_cndmask_b32 v110, v110, v247, s[16:17]
    v_cndmask_b32 v111, v111, v247, s[18:19]
    v_cmp_gt_i32 s[12:13], 16, v7
    s_cmp_lt_i32 s56, 2
    s_cbranch_scc1 msk_89
    v_mfma_f32_32x32x16_bf16 v[120:135], v[20:23], v[52:55], v[120:135]
msk_89:
    buffer_load_dwordx4 v1, s[28:31], s73 offen offset:2048 lds
    v_cmp_gt_i32 s[14:15], 17, v7
    v_cmp_gt_i32 s[16:17], 18, v7
    v_cmp_gt_i32 s[18:19], 19, v7
    v_cndmask_b32 v112, v112, v247, s[12:13]
    v_cndmask_b32 v113, v113, v247, s[14:15]
    v_cndmask_b32 v114, v114, v247, s[16:17]
    v_cndmask_b32 v115, v115, v247, s[18:19]
    v_cmp_gt_i32 s[12:13], 24, v7
    v_cmp_gt_i32 s[14:15], 25, v7
    v_cmp_gt_i32 s[16:17], 26, v7
    v_cmp_gt_i32 s[18:19], 27, v7
    v_cndmask_b32 v116, v116, v247, s[12:13]
    v_cndmask_b32 v117, v117, v247, s[14:15]
    v_cndmask_b32 v118, v118, v247, s[16:17]
    v_cndmask_b32 v119, v119, v247, s[18:19]
    v_max3_f32 v234, v104, v105, v106
    v_max3_f32 v234, v234, v107, v108
    s_waitcnt lgkmcnt(0)
    s_cmp_lt_i32 s56, 2
    s_cbranch_scc1 msk_90
    v_mfma_f32_32x32x16_bf16 v[120:135], v[24:27], v[56:59], v[120:135]
msk_90:
    ds_read_b128 v[8:11], v3 offset:0
    ds_read_b128 v[12:15], v3 offset:2048
    buffer_load_dwordx4 v1, s[28:31], s73 offen offset:3072 lds
    v_max3_f32 v234, v234, v109, v110
    v_max3_f32 v234, v234, v111, v112
    v_max3_f32 v234, v234, v113, v114
    v_max3_f32 v234, v234, v115, v116
    v_max3_f32 v234, v234, v117, v118
    v_max_f32 v234, v234, v119
    v_mov_b32 v235, v234
    s_nop 1
    v_permlane32_swap_b32 v234, v235
    s_nop 1
    v_max_f32 v234, v234, v235
    v_max_f32 v234, v245, v234
    v_sub_f32 v104, v104, v234
    v_sub_f32 v105, v105, v234
    v_sub_f32 v106, v106, v234
    v_sub_f32 v107, v107, v234
    v_sub_f32 v108, v108, v234
    s_cmp_lt_i32 s56, 2
    s_cbranch_scc1 msk_91
    v_mfma_f32_32x32x16_bf16 v[120:135], v[28:31], v[60:63], v[120:135]
msk_91:
    ds_read_b128 v[16:19], v3 offset:4096
    ds_read_b128 v[20:23], v3 offset:6144
    v_sub_f32 v109, v109, v234
    v_sub_f32 v110, v110, v234
    v_sub_f32 v111, v111, v234
    v_sub_f32 v112, v112, v234
    v_sub_f32 v113, v113, v234
    v_sub_f32 v114, v114, v234
    v_sub_f32 v115, v115, v234
    v_sub_f32 v116, v116, v234
    v_sub_f32 v117, v117, v234
    v_sub_f32 v118, v118, v234
    v_sub_f32 v119, v119, v234
    v_exp_f32 v104, v104
    v_exp_f32 v105, v105
    v_exp_f32 v106, v106
    v_exp_f32 v107, v107
    v_add_f32 v244, v4, v104
    v_cvt_pk_bf16_f32 v152, v104, v105
    s_cmp_lt_i32 s56, 2
    s_cbranch_scc1 msk_92
    v_mfma_f32_32x32x16_bf16 v[120:135], v[32:35], v[64:67], v[120:135]
msk_92:
    v_xor_b32 v2, 0x8000, v2
    v_exp_f32 v108, v108
    v_exp_f32 v109, v109
    v_add_f32 v244, v244, v106
    v_add_f32 v232, v105, v107
    v_cvt_pk_bf16_f32 v153, v106, v107
    v_exp_f32 v110, v110
    v_exp_f32 v111, v111
    v_add_f32 v244, v244, v108
    v_add_f32 v232, v232, v109
    v_cvt_pk_bf16_f32 v154, v108, v109
    v_exp_f32 v112, v112
    v_exp_f32 v113, v113
    v_add_f32 v244, v244, v110
    v_add_f32 v232, v232, v111
    v_cvt_pk_bf16_f32 v155, v110, v111
    v_exp_f32 v114, v114
    v_exp_f32 v115, v115
    s_cmp_lt_i32 s56, 2
    s_cbranch_scc1 msk_93
    v_mfma_f32_32x32x16_bf16 v[120:135], v[36:39], v[68:71], v[120:135]
msk_93:
    v_add_f32 v244, v244, v112
    v_add_f32 v232, v232, v113
    v_cvt_pk_bf16_f32 v156, v112, v113
    v_exp_f32 v116, v116
    v_exp_f32 v117, v117
    v_add_f32 v244, v244, v114
    v_add_f32 v232, v232, v115
    v_cvt_pk_bf16_f32 v157, v114, v115
    v_exp_f32 v118, v118
    v_exp_f32 v119, v119
    v_add_f32 v244, v244, v116
    v_add_f32 v232, v232, v117
    v_cvt_pk_bf16_f32 v158, v116, v117
    v_add_f32 v244, v244, v118
    v_add_f32 v232, v232, v119
    v_cvt_pk_bf16_f32 v159, v118, v119
    v_add_f32 v244, v244, v232
    v_cmp_nle_f32 vcc, v244, v246
    s_cbranch_vccnz resc_94
back_95:
    s_waitcnt vmcnt(4)
    s_barrier
    s_cmp_lg_u32 s40, 7
    s_cbranch_scc1 st3_96
    s_lshl_b32 s66, s62, 7
    s_or_b32 s66, s66, s74
    s_or_b32 s66, s66, 0x60
    v_mov_b32 v237, 0
    v_mov_b32 v236, s66
    s_mov_b64 exec, 1
    buffer_store_byte v236, v237, s[76:79], s2 offen sc0 sc1
    s_mov_b64 exec, -1
st3_96:
    s_waitcnt lgkmcnt(0)
    s_cmp_lt_i32 s56, 1
    s_cbranch_scc1 msk_97
    v_mfma_f32_32x32x16_bf16 v[168:183], v[8:11], v[152:155], v[168:183]
msk_97:
    ds_read_b128 v[24:27], v3 offset:1024
    ds_read_b128 v[28:31], v3 offset:3072
    s_cmp_lt_i32 s56, 1
    s_cbranch_scc1 msk_98
    v_mfma_f32_32x32x16_bf16 v[184:199], v[12:15], v[152:155], v[184:199]
msk_98:
    ds_read_b128 v[32:35], v3 offset:5120
    ds_read_b128 v[36:39], v3 offset:7168
    s_cmp_lt_i32 s56, 1
    s_cbranch_scc1 msk_99
    v_mfma_f32_32x32x16_bf16 v[200:215], v[16:19], v[152:155], v[200:215]
msk_99:
    v_sub_f32 v136, 0, v234
    v_sub_f32 v137, 0, v234
    v_sub_f32 v138, 0, v234
    v_sub_f32 v139, 0, v234
    v_sub_f32 v140, 0, v234
    v_sub_f32 v141, 0, v234
    v_sub_f32 v142, 0, v234
    v_sub_f32 v143, 0, v234
    v_sub_f32 v144, 0, v234
    v_sub_f32 v145, 0, v234
    v_sub_f32 v146, 0, v234
    v_sub_f32 v147, 0, v234
    v_sub_f32 v148, 0, v234
    v_sub_f32 v149, 0, v234
    s_cmp_lt_i32 s56, 1
    s_cbranch_scc1 msk_100
    v_mfma_f32_32x32x16_bf16 v[216:231], v[20:23], v[152:155], v[216:231]
msk_100:
    v_sub_f32 v150, 0, v234
    v_sub_f32 v151, 0, v234
    v_sub_f32 v120, v120, v234
    v_sub_f32 v121, v121, v234
    v_sub_f32 v122, v122, v234
    v_sub_f32 v123, v123, v234
    v_sub_f32 v124, v124, v234
    v_sub_f32 v125, v125, v234
    v_sub_f32 v126, v126, v234
    v_sub_f32 v127, v127, v234
    v_sub_f32 v128, v128, v234
    v_sub_f32 v129, v129, v234
    v_sub_f32 v130, v130, v234
    v_sub_f32 v131, v131, v234
    s_waitcnt lgkmcnt(0)
    s_cmp_lt_i32 s56, 1
    s_cbranch_scc1 msk_101
    v_mfma_f32_32x32x16_bf16 v[168:183], v[24:27], v[156:159], v[168:183]
msk_101:
    ds_read_b128 v[8:11], v3 offset:8192
    ds_read_b128 v[12:15], v3 offset:10240
    v_sub_f32 v132, v132, v234
    v_sub_f32 v133, v133, v234
    v_sub_f32 v134, v134, v234
    v_sub_f32 v135, v135, v234
    v_cmp_gt_i32 s[12:13], 32, v7
    v_cmp_gt_i32 s[14:15], 33, v7
    v_cmp_gt_i32 s[16:17], 34, v7
    v_cmp_gt_i32 s[18:19], 35, v7
    v_cndmask_b32 v120, v120, v247, s[12:13]
    v_cndmask_b32 v121, v121, v247, s[14:15]
    v_cndmask_b32 v122, v122, v247, s[16:17]
    v_cndmask_b32 v123, v123, v247, s[18:19]
    v_cmp_gt_i32 s[12:13], 40, v7
    v_cmp_gt_i32 s[14:15], 41, v7
    s_cmp_lt_i32 s56, 1
    s_cbranch_scc1 msk_102
    v_mfma_f32_32x32x16_bf16 v[184:199], v[28:31], v[156:159], v[184:199]
msk_102:
    ds_read_b128 v[16:19], v3 offset:12288
    ds_read_b128 v[20:23], v3 offset:14336
    v_cmp_gt_i32 s[16:17], 42, v7
    v_cmp_gt_i32 s[18:19], 43, v7
    v_cndmask_b32 v124, v124, v247, s[12:13]
    v_cndmask_b32 v125, v125, v247, s[14:15]
    v_cndmask_b32 v126, v126, v247, s[16:17]
    v_cndmask_b32 v127, v127, v247, s[18:19]
    v_cmp_gt_i32 s[12:13], 48, v7
    v_cmp_gt_i32 s[14:15], 49, v7
    v_cmp_gt_i32 s[16:17], 50, v7
    v_cmp_gt_i32 s[18:19], 51, v7
    v_cndmask_b32 v128, v128, v247, s[12:13]
    v_cndmask_b32 v129, v129, v247, s[14:15]
    v_cndmask_b32 v130, v130, v247, s[16:17]
    v_cndmask_b32 v131, v131, v247, s[18:19]
    s_cmp_lt_i32 s56, 1
    s_cbranch_scc1 msk_103
    v_mfma_f32_32x32x16_bf16 v[200:215], v[32:35], v[156:159], v[200:215]
msk_103:
    v_cmp_gt_i32 s[12:13], 56, v7
    v_cmp_gt_i32 s[14:15], 57, v7
    v_cmp_gt_i32 s[16:17], 58, v7
    v_cmp_gt_i32 s[18:19], 59, v7
    v_cndmask_b32 v132, v132, v247, s[12:13]
    v_cndmask_b32 v133, v133, v247, s[14:15]
    v_cndmask_b32 v134, v134, v247, s[16:17]
    v_cndmask_b32 v135, v135, v247, s[18:19]
    v_exp_f32 v120, v120
    v_exp_f32 v121, v121
    v_exp_f32 v122, v122
    v_exp_f32 v123, v123
    v_add_f32 v4, v244, v120
    s_cmp_lt_i32 s56, 1
    s_cbranch_scc1 msk_104
    v_mfma_f32_32x32x16_bf16 v[216:231], v[36:39], v[156:159], v[216:231]
msk_104:
    v_cvt_pk_bf16_f32 v160, v120, v121
    v_exp_f32 v124, v124
    v_exp_f32 v125, v125
    v_add_f32 v4, v4, v122
    v_add_f32 v233, v121, v123
    v_cvt_pk_bf16_f32 v161, v122, v123
    v_exp_f32 v126, v126
    v_exp_f32 v127, v127
    v_add_f32 v4, v4, v124
    v_add_f32 v233, v233, v125
    v_cvt_pk_bf16_f32 v162, v124, v125
    v_exp_f32 v128, v128
    v_exp_f32 v129, v129
    v_add_f32 v4, v4, v126
    v_add_f32 v233, v233, v127
    v_cvt_pk_bf16_f32 v163, v126, v127
    v_exp_f32 v130, v130
    v_exp_f32 v131, v131
    v_add_f32 v4, v4, v128
    v_add_f32 v233, v233, v129
    v_cvt_pk_bf16_f32 v164, v128, v129
    v_exp_f32 v132, v132
    v_exp_f32 v133, v133
    v_add_f32 v4, v4, v130
    v_add_f32 v233, v233, v131
    v_cvt_pk_bf16_f32 v165, v130, v131
    v_exp_f32 v134, v134
    v_exp_f32 v135, v135
    v_add_f32 v4, v4, v132
    v_add_f32 v233, v233, v133
    v_cvt_pk_bf16_f32 v166, v132, v133
    v_add_f32 v4, v4, v134
    v_add_f32 v233, v233, v135
    v_cvt_pk_bf16_f32 v167, v134, v135
    v_add_f32 v4, v4, v233
    v_cmp_nle_f32 vcc, v4, v246
    s_cbranch_vccnz resc_105
back_106:
    s_nop 0
    s_waitcnt lgkmcnt(0)
    s_cmp_lt_i32 s56, 2
    s_cbranch_scc1 msk_107
    v_mfma_f32_32x32x16_bf16 v[168:183], v[8:11], v[160:163], v[168:183]
msk_107:
    ds_read_b128 v[24:27], v3 offset:9216
    ds_read_b128 v[28:31], v3 offset:11264
    s_cmp_lt_i32 s56, 2
    s_cbranch_scc1 msk_108
    v_mfma_f32_32x32x16_bf16 v[184:199], v[12:15], v[160:163], v[184:199]
msk_108:
    ds_read_b128 v[32:35], v3 offset:13312
    ds_read_b128 v[36:39], v3 offset:15360
    s_cmp_lt_i32 s56, 2
    s_cbranch_scc1 msk_109
    v_mfma_f32_32x32x16_bf16 v[200:215], v[16:19], v[160:163], v[200:215]
msk_109:
    s_cmp_lt_i32 s56, 2
    s_cbranch_scc1 msk_110
    v_mfma_f32_32x32x16_bf16 v[216:231], v[20:23], v[160:163], v[216:231]
msk_110:
    s_waitcnt lgkmcnt(0)
    s_cmp_lt_i32 s56, 2
    s_cbranch_scc1 msk_111
    v_mfma_f32_32x32x16_bf16 v[168:183], v[24:27], v[164:167], v[168:183]
msk_111:
    s_cmp_lt_i32 s56, 2
    s_cbranch_scc1 msk_112
    v_mfma_f32_32x32x16_bf16 v[184:199], v[28:31], v[164:167], v[184:199]
msk_112:
    s_cmp_lt_i32 s56, 2
    s_cbranch_scc1 msk_113
    v_mfma_f32_32x32x16_bf16 v[200:215], v[32:35], v[164:167], v[200:215]
msk_113:
    s_cmp_lt_i32 s56, 2
    s_cbranch_scc1 msk_114
    v_mfma_f32_32x32x16_bf16 v[216:231], v[36:39], v[164:167], v[216:231]
msk_114:
merge_32:
    s_lshl_b32 s66, s40, 1
    s_add_u32 s66, s66, s62
    s_cmp_lg_u32 s66, 1
    s_cbranch_scc1 m_nw0_115
    v_lshlrev_b32 v246, 2, v0
    buffer_load_dword v247, v246, s[76:79], 0 offen sc1
m_nw0_115:
    v_mov_b32 v232, v4
    s_nop 1
    v_permlane32_swap_b32 v4, v232
    s_nop 1
    v_add_f32 v4, v4, v232
    s_barrier
    s_and_b32 s66, s59, 32768
    s_xor_b32 s67, s60, 32768
    s_and_b32 s67, s67, 98304
    s_xor_b32 s67, s67, 32768
    s_cmp_eq_u32 s45, 0
    s_cselect_b32 s68, s66, s67
    s_cselect_b32 s69, s67, s66
    s_lshl_b32 s66, s46, 13
    s_add_u32 s68, s68, s66
    s_add_u32 s69, s69, s66
    v_add_u32 v234, s68, v1
    v_add_u32 v235, s69, v1
    v_lshlrev_b32 v236, 3, v0
    s_lshl_b32 s66, s45, 2
    s_add_u32 s66, s66, s46
    s_lshl_b32 s66, s66, 9
    s_add_u32 s66, s66, 131072
    v_add_u32 v237, s66, v236
    s_xor_b32 s66, s66, 2048
    v_add_u32 v236, s66, v236
    v_mov_b32 v238, v136
    v_mov_b32 v239, v4
    ds_write_b64 v237, v[238:239]

    s_cmp_eq_u32 s45, 0
    s_cbranch_scc0 mg1_116
    ds_write_b128 v234, v[200:203] offset:0
    ds_write_b128 v234, v[204:207] offset:1024
    ds_write_b128 v234, v[208:211] offset:2048
    ds_write_b128 v234, v[212:215] offset:3072
    ds_write_b128 v234, v[216:219] offset:4096
    ds_write_b128 v234, v[220:223] offset:5120
    ds_write_b128 v234, v[224:227] offset:6144
    ds_write_b128 v234, v[228:231] offset:7168
    s_waitcnt lgkmcnt(0)
    s_barrier
    ds_read_b64 v[240:241], v236
    ds_read_b128 v[200:203], v235 offset:0
    ds_read_b128 v[204:207], v235 offset:1024
    ds_read_b128 v[208:211], v235 offset:2048
    ds_read_b128 v[212:215], v235 offset:3072
    ds_read_b128 v[216:219], v235 offset:4096
    ds_read_b128 v[220:223], v235 offset:5120
    ds_read_b128 v[224:227], v235 offset:6144
    ds_read_b128 v[228:231], v235 offset:7168
    s_waitcnt lgkmcnt(8)
    v_min_f32 v242, v136, v240
    v_sub_f32 v243, v242, v136
    v_sub_f32 v244, v242, v240
    v_exp_f32 v243, v243
    v_exp_f32 v244, v244
    s_nop 0
    v_mul_f32 v242, v4, v243
    v_fmac_f32 v242, v241, v244
    v_rcp_f32 v242, v242
    s_nop 0
    v_mul_f32 v243, v243, v242
    v_mul_f32 v244, v244, v242
    s_waitcnt lgkmcnt(0)

    v_pk_mul_f32 v[168:169], v[168:169], v[242:243] op_sel:[0,1] op_sel_hi:[1,1]
    v_pk_fma_f32 v[168:169], v[200:201], v[244:245], v[168:169] op_sel_hi:[1,0,1]
    v_pk_mul_f32 v[170:171], v[170:171], v[242:243] op_sel:[0,1] op_sel_hi:[1,1]
    v_pk_fma_f32 v[170:171], v[202:203], v[244:245], v[170:171] op_sel_hi:[1,0,1]
    v_pk_mul_f32 v[172:173], v[172:173], v[242:243] op_sel:[0,1] op_sel_hi:[1,1]
    v_pk_fma_f32 v[172:173], v[204:205], v[244:245], v[172:173] op_sel_hi:[1,0,1]
    v_pk_mul_f32 v[174:175], v[174:175], v[242:243] op_sel:[0,1] op_sel_hi:[1,1]
    v_pk_fma_f32 v[174:175], v[206:207], v[244:245], v[174:175] op_sel_hi:[1,0,1]
    v_pk_mul_f32 v[176:177], v[176:177], v[242:243] op_sel:[0,1] op_sel_hi:[1,1]
    v_pk_fma_f32 v[176:177], v[208:209], v[244:245], v[176:177] op_sel_hi:[1,0,1]
    v_pk_mul_f32 v[178:179], v[178:179], v[242:243] op_sel:[0,1] op_sel_hi:[1,1]
    v_pk_fma_f32 v[178:179], v[210:211], v[244:245], v[178:179] op_sel_hi:[1,0,1]
    v_pk_mul_f32 v[180:181], v[180:181], v[242:243] op_sel:[0,1] op_sel_hi:[1,1]
    v_pk_fma_f32 v[180:181], v[212:213], v[244:245], v[180:181] op_sel_hi:[1,0,1]
    v_pk_mul_f32 v[182:183], v[182:183], v[242:243] op_sel:[0,1] op_sel_hi:[1,1]
    v_pk_fma_f32 v[182:183], v[214:215], v[244:245], v[182:183] op_sel_hi:[1,0,1]
    v_pk_mul_f32 v[184:185], v[184:185], v[242:243] op_sel:[0,1] op_sel_hi:[1,1]
    v_pk_fma_f32 v[184:185], v[216:217], v[244:245], v[184:185] op_sel_hi:[1,0,1]
    v_pk_mul_f32 v[186:187], v[186:187], v[242:243] op_sel:[0,1] op_sel_hi:[1,1]
    v_pk_fma_f32 v[186:187], v[218:219], v[244:245], v[186:187] op_sel_hi:[1,0,1]
    v_pk_mul_f32 v[188:189], v[188:189], v[242:243] op_sel:[0,1] op_sel_hi:[1,1]
    v_pk_fma_f32 v[188:189], v[220:221], v[244:245], v[188:189] op_sel_hi:[1,0,1]
    v_pk_mul_f32 v[190:191], v[190:191], v[242:243] op_sel:[0,1] op_sel_hi:[1,1]
    v_pk_fma_f32 v[190:191], v[222:223], v[244:245], v[190:191] op_sel_hi:[1,0,1]
    v_pk_mul_f32 v[192:193], v[192:193], v[242:243] op_sel:[0,1] op_sel_hi:[1,1]
    v_pk_fma_f32 v[192:193], v[224:225], v[244:245], v[192:193] op_sel_hi:[1,0,1]
    v_pk_mul_f32 v[194:195], v[194:195], v[242:243] op_sel:[0,1] op_sel_hi:[1,1]
    v_pk_fma_f32 v[194:195], v[226:227], v[244:245], v[194:195] op_sel_hi:[1,0,1]
    v_pk_mul_f32 v[196:197], v[196:197], v[242:243] op_sel:[0,1] op_sel_hi:[1,1]
    v_pk_fma_f32 v[196:197], v[228:229], v[244:245], v[196:197] op_sel_hi:[1,0,1]
    v_pk_mul_f32 v[198:199], v[198:199], v[242:243] op_sel:[0,1] op_sel_hi:[1,1]
    v_pk_fma_f32 v[198:199], v[230:231], v[244:245], v[198:199] op_sel_hi:[1,0,1]
    v_cvt_pk_bf16_f32 v104, v168, v169
    v_cvt_pk_bf16_f32 v105, v170, v171
    v_cvt_pk_bf16_f32 v106, v172, v173
    v_cvt_pk_bf16_f32 v107, v174, v175
    v_cvt_pk_bf16_f32 v108, v176, v177
    v_cvt_pk_bf16_f32 v109, v178, v179
    v_cvt_pk_bf16_f32 v110, v180, v181
    v_cvt_pk_bf16_f32 v111, v182, v183
    v_cvt_pk_bf16_f32 v112, v184, v185
    v_cvt_pk_bf16_f32 v113, v186, v187
    v_cvt_pk_bf16_f32 v114, v188, v189
    v_cvt_pk_bf16_f32 v115, v190, v191
    v_cvt_pk_bf16_f32 v116, v192, v193
    v_cvt_pk_bf16_f32 v117, v194, v195
    v_cvt_pk_bf16_f32 v118, v196, v197
    v_cvt_pk_bf16_f32 v119, v198, v199
    s_branch mgd_117
mg1_116:
    ds_write_b128 v234, v[168:171] offset:0
    ds_write_b128 v234, v[172:175] offset:1024
    ds_write_b128 v234, v[176:179] offset:2048
    ds_write_b128 v234, v[180:183] offset:3072
    ds_write_b128 v234, v[184:187] offset:4096
    ds_write_b128 v234, v[188:191] offset:5120
    ds_write_b128 v234, v[192:195] offset:6144
    ds_write_b128 v234, v[196:199] offset:7168
    s_waitcnt lgkmcnt(0)
    s_barrier
    ds_read_b64 v[240:241], v236
    ds_read_b128 v[168:171], v235 offset:0
    ds_read_b128 v[172:175], v235 offset:1024
    ds_read_b128 v[176:179], v235 offset:2048
    ds_read_b128 v[180:183], v235 offset:3072
    ds_read_b128 v[184:187], v235 offset:4096
    ds_read_b128 v[188:191], v235 offset:5120
    ds_read_b128 v[192:195], v235 offset:6144
    ds_read_b128 v[196:199], v235 offset:7168
    s_waitcnt lgkmcnt(8)
    v_min_f32 v242, v136, v240
    v_sub_f32 v243, v242, v136
    v_sub_f32 v244, v242, v240
    v_exp_f32 v243, v243
    v_exp_f32 v244, v244
    s_nop 0
    v_mul_f32 v242, v4, v243
    v_fmac_f32 v242, v241, v244
    v_rcp_f32 v242, v242
    s_nop 0
    v_mul_f32 v243, v243, v242
    v_mul_f32 v244, v244, v242
    s_waitcnt lgkmcnt(0)

    v_pk_mul_f32 v[200:201], v[200:201], v[242:243] op_sel:[0,1] op_sel_hi:[1,1]
    v_pk_fma_f32 v[200:201], v[168:169], v[244:245], v[200:201] op_sel_hi:[1,0,1]
    v_pk_mul_f32 v[202:203], v[202:203], v[242:243] op_sel:[0,1] op_sel_hi:[1,1]
    v_pk_fma_f32 v[202:203], v[170:171], v[244:245], v[202:203] op_sel_hi:[1,0,1]
    v_pk_mul_f32 v[204:205], v[204:205], v[242:243] op_sel:[0,1] op_sel_hi:[1,1]
    v_pk_fma_f32 v[204:205], v[172:173], v[244:245], v[204:205] op_sel_hi:[1,0,1]
    v_pk_mul_f32 v[206:207], v[206:207], v[242:243] op_sel:[0,1] op_sel_hi:[1,1]
    v_pk_fma_f32 v[206:207], v[174:175], v[244:245], v[206:207] op_sel_hi:[1,0,1]
    v_pk_mul_f32 v[208:209], v[208:209], v[242:243] op_sel:[0,1] op_sel_hi:[1,1]
    v_pk_fma_f32 v[208:209], v[176:177], v[244:245], v[208:209] op_sel_hi:[1,0,1]
    v_pk_mul_f32 v[210:211], v[210:211], v[242:243] op_sel:[0,1] op_sel_hi:[1,1]
    v_pk_fma_f32 v[210:211], v[178:179], v[244:245], v[210:211] op_sel_hi:[1,0,1]
    v_pk_mul_f32 v[212:213], v[212:213], v[242:243] op_sel:[0,1] op_sel_hi:[1,1]
    v_pk_fma_f32 v[212:213], v[180:181], v[244:245], v[212:213] op_sel_hi:[1,0,1]
    v_pk_mul_f32 v[214:215], v[214:215], v[242:243] op_sel:[0,1] op_sel_hi:[1,1]
    v_pk_fma_f32 v[214:215], v[182:183], v[244:245], v[214:215] op_sel_hi:[1,0,1]
    v_pk_mul_f32 v[216:217], v[216:217], v[242:243] op_sel:[0,1] op_sel_hi:[1,1]
    v_pk_fma_f32 v[216:217], v[184:185], v[244:245], v[216:217] op_sel_hi:[1,0,1]
    v_pk_mul_f32 v[218:219], v[218:219], v[242:243] op_sel:[0,1] op_sel_hi:[1,1]
    v_pk_fma_f32 v[218:219], v[186:187], v[244:245], v[218:219] op_sel_hi:[1,0,1]
    v_pk_mul_f32 v[220:221], v[220:221], v[242:243] op_sel:[0,1] op_sel_hi:[1,1]
    v_pk_fma_f32 v[220:221], v[188:189], v[244:245], v[220:221] op_sel_hi:[1,0,1]
    v_pk_mul_f32 v[222:223], v[222:223], v[242:243] op_sel:[0,1] op_sel_hi:[1,1]
    v_pk_fma_f32 v[222:223], v[190:191], v[244:245], v[222:223] op_sel_hi:[1,0,1]
    v_pk_mul_f32 v[224:225], v[224:225], v[242:243] op_sel:[0,1] op_sel_hi:[1,1]
    v_pk_fma_f32 v[224:225], v[192:193], v[244:245], v[224:225] op_sel_hi:[1,0,1]
    v_pk_mul_f32 v[226:227], v[226:227], v[242:243] op_sel:[0,1] op_sel_hi:[1,1]
    v_pk_fma_f32 v[226:227], v[194:195], v[244:245], v[226:227] op_sel_hi:[1,0,1]
    v_pk_mul_f32 v[228:229], v[228:229], v[242:243] op_sel:[0,1] op_sel_hi:[1,1]
    v_pk_fma_f32 v[228:229], v[196:197], v[244:245], v[228:229] op_sel_hi:[1,0,1]
    v_pk_mul_f32 v[230:231], v[230:231], v[242:243] op_sel:[0,1] op_sel_hi:[1,1]
    v_pk_fma_f32 v[230:231], v[198:199], v[244:245], v[230:231] op_sel_hi:[1,0,1]
    v_cvt_pk_bf16_f32 v104, v200, v201
    v_cvt_pk_bf16_f32 v105, v202, v203
    v_cvt_pk_bf16_f32 v106, v204, v205
    v_cvt_pk_bf16_f32 v107, v206, v207
    v_cvt_pk_bf16_f32 v108, v208, v209
    v_cvt_pk_bf16_f32 v109, v210, v211
    v_cvt_pk_bf16_f32 v110, v212, v213
    v_cvt_pk_bf16_f32 v111, v214, v215
    v_cvt_pk_bf16_f32 v112, v216, v217
    v_cvt_pk_bf16_f32 v113, v218, v219
    v_cvt_pk_bf16_f32 v114, v220, v221
    v_cvt_pk_bf16_f32 v115, v222, v223
    v_cvt_pk_bf16_f32 v116, v224, v225
    v_cvt_pk_bf16_f32 v117, v226, v227
    v_cvt_pk_bf16_f32 v118, v228, v229
    v_cvt_pk_bf16_f32 v119, v230, v231
mgd_117:
    s_lshl_b32 s66, s40, 1
    s_add_u32 s66, s66, s62
    s_cmp_lg_u32 s66, 1
    s_cbranch_scc1 m_nw0b_118
    v_mov_b32 v244, v246
    s_waitcnt vmcnt(0)
    v_mov_b32 v199, v247
    s_mov_b32 s73, 0
fl_spin_120:
    v_and_b32 v245, 0x40404040, v199
    v_cmp_eq_u32 vcc, 0x40404040, v245
    s_cmp_eq_u64 vcc, -1

    s_cbranch_scc1 fl_ok_119
    s_add_u32 s73, s73, 1
    s_cmp_ge_u32 s73, 262144
    s_cbranch_scc1 fl_ok_119
    s_sleep 16

    buffer_load_dword v199, v244, s[76:79], 0 offen sc1
    s_waitcnt vmcnt(0)
    s_branch fl_spin_120
fl_ok_119:
    s_cmp_lt_u32 s41, 16
    s_cbranch_scc1 m_nw0b_118
    s_mov_b32 s73, 0
fl_spin_122:
    v_and_b32 v245, 0x80808080, v199
    v_cmp_eq_u32 vcc, 0x80808080, v245
    s_lshl_b32 s70, s42, 3
    s_lshr_b64 s[68:69], vcc, s70
    s_and_b32 s68, s68, 0xff
    s_cmp_eq_u32 s68, 0xff

    s_cbranch_scc1 fl_ok_121
    s_add_u32 s73, s73, 1
    s_cmp_ge_u32 s73, 262144
    s_cbranch_scc1 fl_ok_121
    s_sleep 16

    buffer_load_dword v199, v244, s[76:79], 0 offen sc1
    s_waitcnt vmcnt(0)
    s_branch fl_spin_122
fl_ok_121:
m_nw0b_118:
    s_barrier
    s_cmp_eq_u32 s62, 1
    s_cbranch_scc1 nokv_123
    s_mov_b32 m0, s59
    s_mov_b32 s72, s57
    s_xor_b32 s59, s59, 32768
    s_add_u32 s57, s57, 32768
    s_cmp_eq_u32 s63, s65
    s_cselect_b32 s57, s61, s57
    s_add_u32 s63, s63, 1
    buffer_load_dwordx4 v1, s[24:27], s72 offen offset:0 lds
    buffer_load_dwordx4 v1, s[24:27], s72 offen offset:1024 lds
    buffer_load_dwordx4 v1, s[24:27], s72 offen offset:2048 lds
    buffer_load_dwordx4 v1, s[24:27], s72 offen offset:3072 lds
nokv_123:
    s_cmp_eq_u32 s62, 1
    s_cbranch_scc1 k2_fin_124
    s_lshl_b32 s66, s54, 2
    s_add_u32 s66, s66, s46
    s_lshl_b32 s66, s66, 18
    s_lshl_b32 s67, s41, 13
    s_add_u32 s66, s66, s67
    s_lshl_b32 s67, s45, 12
    s_add_u32 s66, s66, s67

    buffer_store_dwordx4 v[104:107], v1, s[36:39], s66 offen offset:0 sc0 sc1
    buffer_store_dwordx4 v[108:111], v1, s[36:39], s66 offen offset:1024 sc0 sc1
    buffer_store_dwordx4 v[112:115], v1, s[36:39], s66 offen offset:2048 sc0 sc1
    buffer_store_dwordx4 v[116:119], v1, s[36:39], s66 offen offset:3072 sc0 sc1
    s_mov_b32 s62, 1
    s_mov_b32 s54, s42
    v_mov_b64 v[40:41], v[72:73]
    v_mov_b64 v[42:43], v[74:75]
    v_mov_b64 v[44:45], v[76:77]
    v_mov_b64 v[46:47], v[78:79]
    v_mov_b64 v[48:49], v[80:81]
    v_mov_b64 v[50:51], v[82:83]
    v_mov_b64 v[52:53], v[84:85]
    v_mov_b64 v[54:55], v[86:87]
    v_mov_b64 v[56:57], v[88:89]
    v_mov_b64 v[58:59], v[90:91]
    v_mov_b64 v[60:61], v[92:93]
    v_mov_b64 v[62:63], v[94:95]
    v_mov_b64 v[64:65], v[96:97]
    v_mov_b64 v[66:67], v[98:99]
    v_mov_b64 v[68:69], v[100:101]
    v_mov_b64 v[70:71], v[102:103]
    s_branch blk_top_28
resc_33:
    s_nop 15
    s_nop 15
    s_sub_u32 s66, s55, 0
    s_lshl_b32 s66, s66, 1
    s_add_u32 s66, s66, s45
    s_lshl_b32 s66, s66, 14
    s_lshl_b32 s67, s41, 19
    s_add_u32 s66, s66, s67
    s_add_u32 s66, s66, 0
    s_add_u32 s67, s66, 4096

    buffer_load_dwordx4 v[236:239], v1, s[24:27], s66 offen offset:0
    s_waitcnt vmcnt(0)
    v_mfma_f32_32x32x16_bf16 v[104:119], v[236:239], v[40:43], v[136:151]
    s_nop 7
    buffer_load_dwordx4 v[236:239], v1, s[24:27], s66 offen offset:1024
    s_waitcnt vmcnt(0)
    v_mfma_f32_32x32x16_bf16 v[104:119], v[236:239], v[44:47], v[104:119]
    s_nop 7
    buffer_load_dwordx4 v[236:239], v1, s[24:27], s66 offen offset:2048
    s_waitcnt vmcnt(0)
    v_mfma_f32_32x32x16_bf16 v[104:119], v[236:239], v[48:51], v[104:119]
    s_nop 7
    buffer_load_dwordx4 v[236:239], v1, s[24:27], s66 offen offset:3072
    s_waitcnt vmcnt(0)
    v_mfma_f32_32x32x16_bf16 v[104:119], v[236:239], v[52:55], v[104:119]
    s_nop 7
    buffer_load_dwordx4 v[236:239], v1, s[24:27], s67 offen offset:0
    s_waitcnt vmcnt(0)
    v_mfma_f32_32x32x16_bf16 v[104:119], v[236:239], v[56:59], v[104:119]
    s_nop 7
    buffer_load_dwordx4 v[236:239], v1, s[24:27], s67 offen offset:1024
    s_waitcnt vmcnt(0)
    v_mfma_f32_32x32x16_bf16 v[104:119], v[236:239], v[60:63], v[104:119]
    s_nop 7
    buffer_load_dwordx4 v[236:239], v1, s[24:27], s67 offen offset:2048
    s_waitcnt vmcnt(0)
    v_mfma_f32_32x32x16_bf16 v[104:119], v[236:239], v[64:67], v[104:119]
    s_nop 7
    buffer_load_dwordx4 v[236:239], v1, s[24:27], s67 offen offset:3072
    s_waitcnt vmcnt(0)
    v_mfma_f32_32x32x16_bf16 v[104:119], v[236:239], v[68:71], v[104:119]
    s_nop 7
    s_nop 15
    v_max3_f32 v234, v104, v105, v106
    v_max3_f32 v234, v234, v107, v108
    v_max3_f32 v234, v234, v109, v110
    v_max3_f32 v234, v234, v111, v112
    v_max3_f32 v234, v234, v113, v114
    v_max3_f32 v234, v234, v115, v116
    v_max3_f32 v234, v234, v117, v118
    v_max_f32 v234, v234, v119
    v_mov_b32 v235, v234
    s_nop 1
    v_permlane32_swap_b32 v234, v235
    s_nop 1
    v_max_f32 v234, v234, v235
    v_max_f32 v234, 0, v234
    v_sub_f32 v235, 0, v234
    v_exp_f32 v235, v235
    v_sub_f32 v136, v136, v234
    v_sub_f32 v137, v137, v234
    v_sub_f32 v138, v138, v234
    v_sub_f32 v139, v139, v234
    v_sub_f32 v140, v140, v234
    v_sub_f32 v141, v141, v234
    v_sub_f32 v142, v142, v234
    v_sub_f32 v143, v143, v234
    v_sub_f32 v144, v144, v234
    v_sub_f32 v145, v145, v234
    v_sub_f32 v146, v146, v234
    v_sub_f32 v147, v147, v234
    v_sub_f32 v148, v148, v234
    v_sub_f32 v149, v149, v234
    v_sub_f32 v150, v150, v234
    v_sub_f32 v151, v151, v234
    v_sub_f32 v104, v104, v234
    v_sub_f32 v105, v105, v234
    v_sub_f32 v106, v106, v234
    v_sub_f32 v107, v107, v234
    v_sub_f32 v108, v108, v234
    v_sub_f32 v109, v109, v234
    v_sub_f32 v110, v110, v234
    v_sub_f32 v111, v111, v234
    v_sub_f32 v112, v112, v234
    v_sub_f32 v113, v113, v234
    v_sub_f32 v114, v114, v234
    v_sub_f32 v115, v115, v234
    v_sub_f32 v116, v116, v234
    v_sub_f32 v117, v117, v234
    v_sub_f32 v118, v118, v234
    v_sub_f32 v119, v119, v234
    v_sub_f32 v120, v120, v234
    v_sub_f32 v121, v121, v234
    v_sub_f32 v122, v122, v234
    v_sub_f32 v123, v123, v234
    v_sub_f32 v124, v124, v234
    v_sub_f32 v125, v125, v234
    v_sub_f32 v126, v126, v234
    v_sub_f32 v127, v127, v234
    v_sub_f32 v128, v128, v234
    v_sub_f32 v129, v129, v234
    v_sub_f32 v130, v130, v234
    v_sub_f32 v131, v131, v234
    v_sub_f32 v132, v132, v234
    v_sub_f32 v133, v133, v234
    v_sub_f32 v134, v134, v234
    v_sub_f32 v135, v135, v234
    v_mul_f32 v168, v168, v235
    v_mul_f32 v169, v169, v235
    v_mul_f32 v170, v170, v235
    v_mul_f32 v171, v171, v235
    v_mul_f32 v172, v172, v235
    v_mul_f32 v173, v173, v235
    v_mul_f32 v174, v174, v235
    v_mul_f32 v175, v175, v235
    v_mul_f32 v176, v176, v235
    v_mul_f32 v177, v177, v235
    v_mul_f32 v178, v178, v235
    v_mul_f32 v179, v179, v235
    v_mul_f32 v180, v180, v235
    v_mul_f32 v181, v181, v235
    v_mul_f32 v182, v182, v235
    v_mul_f32 v183, v183, v235
    v_mul_f32 v184, v184, v235
    v_mul_f32 v185, v185, v235
    v_mul_f32 v186, v186, v235
    v_mul_f32 v187, v187, v235
    v_mul_f32 v188, v188, v235
    v_mul_f32 v189, v189, v235
    v_mul_f32 v190, v190, v235
    v_mul_f32 v191, v191, v235
    v_mul_f32 v192, v192, v235
    v_mul_f32 v193, v193, v235
    v_mul_f32 v194, v194, v235
    v_mul_f32 v195, v195, v235
    v_mul_f32 v196, v196, v235
    v_mul_f32 v197, v197, v235
    v_mul_f32 v198, v198, v235
    v_mul_f32 v199, v199, v235
    v_mul_f32 v200, v200, v235
    v_mul_f32 v201, v201, v235
    v_mul_f32 v202, v202, v235
    v_mul_f32 v203, v203, v235
    v_mul_f32 v204, v204, v235
    v_mul_f32 v205, v205, v235
    v_mul_f32 v206, v206, v235
    v_mul_f32 v207, v207, v235
    v_mul_f32 v208, v208, v235
    v_mul_f32 v209, v209, v235
    v_mul_f32 v210, v210, v235
    v_mul_f32 v211, v211, v235
    v_mul_f32 v212, v212, v235
    v_mul_f32 v213, v213, v235
    v_mul_f32 v214, v214, v235
    v_mul_f32 v215, v215, v235
    v_mul_f32 v216, v216, v235
    v_mul_f32 v217, v217, v235
    v_mul_f32 v218, v218, v235
    v_mul_f32 v219, v219, v235
    v_mul_f32 v220, v220, v235
    v_mul_f32 v221, v221, v235
    v_mul_f32 v222, v222, v235
    v_mul_f32 v223, v223, v235
    v_mul_f32 v224, v224, v235
    v_mul_f32 v225, v225, v235
    v_mul_f32 v226, v226, v235
    v_mul_f32 v227, v227, v235
    v_mul_f32 v228, v228, v235
    v_mul_f32 v229, v229, v235
    v_mul_f32 v230, v230, v235
    v_mul_f32 v231, v231, v235
    v_mul_f32 v4, v4, v235
    v_exp_f32 v104, v104
    v_exp_f32 v105, v105
    v_exp_f32 v106, v106
    v_exp_f32 v107, v107
    v_add_f32 v244, v4, v104
    v_cvt_pk_bf16_f32 v152, v104, v105
    v_exp_f32 v108, v108
    v_exp_f32 v109, v109
    v_add_f32 v244, v244, v106
    v_add_f32 v232, v105, v107
    v_cvt_pk_bf16_f32 v153, v106, v107
    v_exp_f32 v110, v110
    v_exp_f32 v111, v111
    v_add_f32 v244, v244, v108
    v_add_f32 v232, v232, v109
    v_cvt_pk_bf16_f32 v154, v108, v109
    v_exp_f32 v112, v112
    v_exp_f32 v113, v113
    v_add_f32 v244, v244, v110
    v_add_f32 v232, v232, v111
    v_cvt_pk_bf16_f32 v155, v110, v111
    v_exp_f32 v114, v114
    v_exp_f32 v115, v115
    v_add_f32 v244, v244, v112
    v_add_f32 v232, v232, v113
    v_cvt_pk_bf16_f32 v156, v112, v113
    v_exp_f32 v116, v116
    v_exp_f32 v117, v117
    v_add_f32 v244, v244, v114
    v_add_f32 v232, v232, v115
    v_cvt_pk_bf16_f32 v157, v114, v115
    v_exp_f32 v118, v118
    v_exp_f32 v119, v119
    v_add_f32 v244, v244, v116
    v_add_f32 v232, v232, v117
    v_cvt_pk_bf16_f32 v158, v116, v117
    v_add_f32 v244, v244, v118
    v_add_f32 v232, v232, v119
    v_cvt_pk_bf16_f32 v159, v118, v119
    v_add_f32 v244, v244, v232
    s_nop 1
    s_branch back_34
resc_36:
    s_nop 15
    s_nop 15
    s_sub_u32 s66, s55, 1
    s_lshl_b32 s66, s66, 1
    s_add_u32 s66, s66, s45
    s_lshl_b32 s66, s66, 14
    s_lshl_b32 s67, s41, 19
    s_add_u32 s66, s66, s67
    s_add_u32 s66, s66, 8192
    s_add_u32 s67, s66, 4096

    buffer_load_dwordx4 v[236:239], v1, s[24:27], s66 offen offset:0
    s_waitcnt vmcnt(0)
    v_mfma_f32_32x32x16_bf16 v[120:135], v[236:239], v[40:43], v[136:151]
    s_nop 7
    buffer_load_dwordx4 v[236:239], v1, s[24:27], s66 offen offset:1024
    s_waitcnt vmcnt(0)
    v_mfma_f32_32x32x16_bf16 v[120:135], v[236:239], v[44:47], v[120:135]
    s_nop 7
    buffer_load_dwordx4 v[236:239], v1, s[24:27], s66 offen offset:2048
    s_waitcnt vmcnt(0)
    v_mfma_f32_32x32x16_bf16 v[120:135], v[236:239], v[48:51], v[120:135]
    s_nop 7
    buffer_load_dwordx4 v[236:239], v1, s[24:27], s66 offen offset:3072
    s_waitcnt vmcnt(0)
    v_mfma_f32_32x32x16_bf16 v[120:135], v[236:239], v[52:55], v[120:135]
    s_nop 7
    buffer_load_dwordx4 v[236:239], v1, s[24:27], s67 offen offset:0
    s_waitcnt vmcnt(0)
    v_mfma_f32_32x32x16_bf16 v[120:135], v[236:239], v[56:59], v[120:135]
    s_nop 7
    buffer_load_dwordx4 v[236:239], v1, s[24:27], s67 offen offset:1024
    s_waitcnt vmcnt(0)
    v_mfma_f32_32x32x16_bf16 v[120:135], v[236:239], v[60:63], v[120:135]
    s_nop 7
    buffer_load_dwordx4 v[236:239], v1, s[24:27], s67 offen offset:2048
    s_waitcnt vmcnt(0)
    v_mfma_f32_32x32x16_bf16 v[120:135], v[236:239], v[64:67], v[120:135]
    s_nop 7
    buffer_load_dwordx4 v[236:239], v1, s[24:27], s67 offen offset:3072
    s_waitcnt vmcnt(0)
    v_mfma_f32_32x32x16_bf16 v[120:135], v[236:239], v[68:71], v[120:135]
    s_nop 7
    s_nop 15
    v_max3_f32 v234, v120, v121, v122
    v_max3_f32 v234, v234, v123, v124
    v_max3_f32 v234, v234, v125, v126
    v_max3_f32 v234, v234, v127, v128
    v_max3_f32 v234, v234, v129, v130
    v_max3_f32 v234, v234, v131, v132
    v_max3_f32 v234, v234, v133, v134
    v_max_f32 v234, v234, v135
    v_mov_b32 v235, v234
    s_nop 1
    v_permlane32_swap_b32 v234, v235
    s_nop 1
    v_max_f32 v234, v234, v235
    v_max_f32 v234, 0, v234
    v_sub_f32 v235, 0, v234
    v_exp_f32 v235, v235
    v_sub_f32 v136, v136, v234
    v_sub_f32 v137, v137, v234
    v_sub_f32 v138, v138, v234
    v_sub_f32 v139, v139, v234
    v_sub_f32 v140, v140, v234
    v_sub_f32 v141, v141, v234
    v_sub_f32 v142, v142, v234
    v_sub_f32 v143, v143, v234
    v_sub_f32 v144, v144, v234
    v_sub_f32 v145, v145, v234
    v_sub_f32 v146, v146, v234
    v_sub_f32 v147, v147, v234
    v_sub_f32 v148, v148, v234
    v_sub_f32 v149, v149, v234
    v_sub_f32 v150, v150, v234
    v_sub_f32 v151, v151, v234
    v_sub_f32 v104, v104, v234
    v_sub_f32 v105, v105, v234
    v_sub_f32 v106, v106, v234
    v_sub_f32 v107, v107, v234
    v_sub_f32 v108, v108, v234
    v_sub_f32 v109, v109, v234
    v_sub_f32 v110, v110, v234
    v_sub_f32 v111, v111, v234
    v_sub_f32 v112, v112, v234
    v_sub_f32 v113, v113, v234
    v_sub_f32 v114, v114, v234
    v_sub_f32 v115, v115, v234
    v_sub_f32 v116, v116, v234
    v_sub_f32 v117, v117, v234
    v_sub_f32 v118, v118, v234
    v_sub_f32 v119, v119, v234
    v_sub_f32 v120, v120, v234
    v_sub_f32 v121, v121, v234
    v_sub_f32 v122, v122, v234
    v_sub_f32 v123, v123, v234
    v_sub_f32 v124, v124, v234
    v_sub_f32 v125, v125, v234
    v_sub_f32 v126, v126, v234
    v_sub_f32 v127, v127, v234
    v_sub_f32 v128, v128, v234
    v_sub_f32 v129, v129, v234
    v_sub_f32 v130, v130, v234
    v_sub_f32 v131, v131, v234
    v_sub_f32 v132, v132, v234
    v_sub_f32 v133, v133, v234
    v_sub_f32 v134, v134, v234
    v_sub_f32 v135, v135, v234
    v_mul_f32 v168, v168, v235
    v_mul_f32 v169, v169, v235
    v_mul_f32 v170, v170, v235
    v_mul_f32 v171, v171, v235
    v_mul_f32 v172, v172, v235
    v_mul_f32 v173, v173, v235
    v_mul_f32 v174, v174, v235
    v_mul_f32 v175, v175, v235
    v_mul_f32 v176, v176, v235
    v_mul_f32 v177, v177, v235
    v_mul_f32 v178, v178, v235
    v_mul_f32 v179, v179, v235
    v_mul_f32 v180, v180, v235
    v_mul_f32 v181, v181, v235
    v_mul_f32 v182, v182, v235
    v_mul_f32 v183, v183, v235
    v_mul_f32 v184, v184, v235
    v_mul_f32 v185, v185, v235
    v_mul_f32 v186, v186, v235
    v_mul_f32 v187, v187, v235
    v_mul_f32 v188, v188, v235
    v_mul_f32 v189, v189, v235
    v_mul_f32 v190, v190, v235
    v_mul_f32 v191, v191, v235
    v_mul_f32 v192, v192, v235
    v_mul_f32 v193, v193, v235
    v_mul_f32 v194, v194, v235
    v_mul_f32 v195, v195, v235
    v_mul_f32 v196, v196, v235
    v_mul_f32 v197, v197, v235
    v_mul_f32 v198, v198, v235
    v_mul_f32 v199, v199, v235
    v_mul_f32 v200, v200, v235
    v_mul_f32 v201, v201, v235
    v_mul_f32 v202, v202, v235
    v_mul_f32 v203, v203, v235
    v_mul_f32 v204, v204, v235
    v_mul_f32 v205, v205, v235
    v_mul_f32 v206, v206, v235
    v_mul_f32 v207, v207, v235
    v_mul_f32 v208, v208, v235
    v_mul_f32 v209, v209, v235
    v_mul_f32 v210, v210, v235
    v_mul_f32 v211, v211, v235
    v_mul_f32 v212, v212, v235
    v_mul_f32 v213, v213, v235
    v_mul_f32 v214, v214, v235
    v_mul_f32 v215, v215, v235
    v_mul_f32 v216, v216, v235
    v_mul_f32 v217, v217, v235
    v_mul_f32 v218, v218, v235
    v_mul_f32 v219, v219, v235
    v_mul_f32 v220, v220, v235
    v_mul_f32 v221, v221, v235
    v_mul_f32 v222, v222, v235
    v_mul_f32 v223, v223, v235
    v_mul_f32 v224, v224, v235
    v_mul_f32 v225, v225, v235
    v_mul_f32 v226, v226, v235
    v_mul_f32 v227, v227, v235
    v_mul_f32 v228, v228, v235
    v_mul_f32 v229, v229, v235
    v_mul_f32 v230, v230, v235
    v_mul_f32 v231, v231, v235
    v_mul_f32 v244, v244, v235
    v_exp_f32 v120, v120
    v_exp_f32 v121, v121
    v_exp_f32 v122, v122
    v_exp_f32 v123, v123
    v_add_f32 v4, v244, v120
    v_cvt_pk_bf16_f32 v160, v120, v121
    v_exp_f32 v124, v124
    v_exp_f32 v125, v125
    v_add_f32 v4, v4, v122
    v_add_f32 v233, v121, v123
    v_cvt_pk_bf16_f32 v161, v122, v123
    v_exp_f32 v126, v126
    v_exp_f32 v127, v127
    v_add_f32 v4, v4, v124
    v_add_f32 v233, v233, v125
    v_cvt_pk_bf16_f32 v162, v124, v125
    v_exp_f32 v128, v128
    v_exp_f32 v129, v129
    v_add_f32 v4, v4, v126
    v_add_f32 v233, v233, v127
    v_cvt_pk_bf16_f32 v163, v126, v127
    v_exp_f32 v130, v130
    v_exp_f32 v131, v131
    v_add_f32 v4, v4, v128
    v_add_f32 v233, v233, v129
    v_cvt_pk_bf16_f32 v164, v128, v129
    v_exp_f32 v132, v132
    v_exp_f32 v133, v133
    v_add_f32 v4, v4, v130
    v_add_f32 v233, v233, v131
    v_cvt_pk_bf16_f32 v165, v130, v131
    v_exp_f32 v134, v134
    v_exp_f32 v135, v135
    v_add_f32 v4, v4, v132
    v_add_f32 v233, v233, v133
    v_cvt_pk_bf16_f32 v166, v132, v133
    v_add_f32 v4, v4, v134
    v_add_f32 v233, v233, v135
    v_cvt_pk_bf16_f32 v167, v134, v135
    v_add_f32 v4, v4, v233
    s_nop 1
    s_branch back_37
resc_38:
    s_nop 15
    s_nop 15
    s_sub_u32 s66, s55, 0
    s_lshl_b32 s66, s66, 1
    s_add_u32 s66, s66, s45
    s_lshl_b32 s66, s66, 14
    s_lshl_b32 s67, s41, 19
    s_add_u32 s66, s66, s67
    s_add_u32 s66, s66, 0
    s_add_u32 s67, s66, 4096

    buffer_load_dwordx4 v[236:239], v1, s[24:27], s66 offen offset:0
    s_waitcnt vmcnt(0)
    v_mfma_f32_32x32x16_bf16 v[104:119], v[236:239], v[40:43], v[136:151]
    s_nop 7
    buffer_load_dwordx4 v[236:239], v1, s[24:27], s66 offen offset:1024
    s_waitcnt vmcnt(0)
    v_mfma_f32_32x32x16_bf16 v[104:119], v[236:239], v[44:47], v[104:119]
    s_nop 7
    buffer_load_dwordx4 v[236:239], v1, s[24:27], s66 offen offset:2048
    s_waitcnt vmcnt(0)
    v_mfma_f32_32x32x16_bf16 v[104:119], v[236:239], v[48:51], v[104:119]
    s_nop 7
    buffer_load_dwordx4 v[236:239], v1, s[24:27], s66 offen offset:3072
    s_waitcnt vmcnt(0)
    v_mfma_f32_32x32x16_bf16 v[104:119], v[236:239], v[52:55], v[104:119]
    s_nop 7
    buffer_load_dwordx4 v[236:239], v1, s[24:27], s67 offen offset:0
    s_waitcnt vmcnt(0)
    v_mfma_f32_32x32x16_bf16 v[104:119], v[236:239], v[56:59], v[104:119]
    s_nop 7
    buffer_load_dwordx4 v[236:239], v1, s[24:27], s67 offen offset:1024
    s_waitcnt vmcnt(0)
    v_mfma_f32_32x32x16_bf16 v[104:119], v[236:239], v[60:63], v[104:119]
    s_nop 7
    buffer_load_dwordx4 v[236:239], v1, s[24:27], s67 offen offset:2048
    s_waitcnt vmcnt(0)
    v_mfma_f32_32x32x16_bf16 v[104:119], v[236:239], v[64:67], v[104:119]
    s_nop 7
    buffer_load_dwordx4 v[236:239], v1, s[24:27], s67 offen offset:3072
    s_waitcnt vmcnt(0)
    v_mfma_f32_32x32x16_bf16 v[104:119], v[236:239], v[68:71], v[104:119]
    s_nop 7
    s_nop 15
    v_max3_f32 v234, v104, v105, v106
    v_max3_f32 v234, v234, v107, v108
    v_max3_f32 v234, v234, v109, v110
    v_max3_f32 v234, v234, v111, v112
    v_max3_f32 v234, v234, v113, v114
    v_max3_f32 v234, v234, v115, v116
    v_max3_f32 v234, v234, v117, v118
    v_max_f32 v234, v234, v119
    v_mov_b32 v235, v234
    s_nop 1
    v_permlane32_swap_b32 v234, v235
    s_nop 1
    v_max_f32 v234, v234, v235
    v_max_f32 v234, 0, v234
    v_sub_f32 v235, 0, v234
    v_exp_f32 v235, v235
    v_sub_f32 v136, v136, v234
    v_sub_f32 v137, v137, v234
    v_sub_f32 v138, v138, v234
    v_sub_f32 v139, v139, v234
    v_sub_f32 v140, v140, v234
    v_sub_f32 v141, v141, v234
    v_sub_f32 v142, v142, v234
    v_sub_f32 v143, v143, v234
    v_sub_f32 v144, v144, v234
    v_sub_f32 v145, v145, v234
    v_sub_f32 v146, v146, v234
    v_sub_f32 v147, v147, v234
    v_sub_f32 v148, v148, v234
    v_sub_f32 v149, v149, v234
    v_sub_f32 v150, v150, v234
    v_sub_f32 v151, v151, v234
    v_sub_f32 v104, v104, v234
    v_sub_f32 v105, v105, v234
    v_sub_f32 v106, v106, v234
    v_sub_f32 v107, v107, v234
    v_sub_f32 v108, v108, v234
    v_sub_f32 v109, v109, v234
    v_sub_f32 v110, v110, v234
    v_sub_f32 v111, v111, v234
    v_sub_f32 v112, v112, v234
    v_sub_f32 v113, v113, v234
    v_sub_f32 v114, v114, v234
    v_sub_f32 v115, v115, v234
    v_sub_f32 v116, v116, v234
    v_sub_f32 v117, v117, v234
    v_sub_f32 v118, v118, v234
    v_sub_f32 v119, v119, v234
    v_sub_f32 v120, v120, v234
    v_sub_f32 v121, v121, v234
    v_sub_f32 v122, v122, v234
    v_sub_f32 v123, v123, v234
    v_sub_f32 v124, v124, v234
    v_sub_f32 v125, v125, v234
    v_sub_f32 v126, v126, v234
    v_sub_f32 v127, v127, v234
    v_sub_f32 v128, v128, v234
    v_sub_f32 v129, v129, v234
    v_sub_f32 v130, v130, v234
    v_sub_f32 v131, v131, v234
    v_sub_f32 v132, v132, v234
    v_sub_f32 v133, v133, v234
    v_sub_f32 v134, v134, v234
    v_sub_f32 v135, v135, v234
    v_mul_f32 v168, v168, v235
    v_mul_f32 v169, v169, v235
    v_mul_f32 v170, v170, v235
    v_mul_f32 v171, v171, v235
    v_mul_f32 v172, v172, v235
    v_mul_f32 v173, v173, v235
    v_mul_f32 v174, v174, v235
    v_mul_f32 v175, v175, v235
    v_mul_f32 v176, v176, v235
    v_mul_f32 v177, v177, v235
    v_mul_f32 v178, v178, v235
    v_mul_f32 v179, v179, v235
    v_mul_f32 v180, v180, v235
    v_mul_f32 v181, v181, v235
    v_mul_f32 v182, v182, v235
    v_mul_f32 v183, v183, v235
    v_mul_f32 v184, v184, v235
    v_mul_f32 v185, v185, v235
    v_mul_f32 v186, v186, v235
    v_mul_f32 v187, v187, v235
    v_mul_f32 v188, v188, v235
    v_mul_f32 v189, v189, v235
    v_mul_f32 v190, v190, v235
    v_mul_f32 v191, v191, v235
    v_mul_f32 v192, v192, v235
    v_mul_f32 v193, v193, v235
    v_mul_f32 v194, v194, v235
    v_mul_f32 v195, v195, v235
    v_mul_f32 v196, v196, v235
    v_mul_f32 v197, v197, v235
    v_mul_f32 v198, v198, v235
    v_mul_f32 v199, v199, v235
    v_mul_f32 v200, v200, v235
    v_mul_f32 v201, v201, v235
    v_mul_f32 v202, v202, v235
    v_mul_f32 v203, v203, v235
    v_mul_f32 v204, v204, v235
    v_mul_f32 v205, v205, v235
    v_mul_f32 v206, v206, v235
    v_mul_f32 v207, v207, v235
    v_mul_f32 v208, v208, v235
    v_mul_f32 v209, v209, v235
    v_mul_f32 v210, v210, v235
    v_mul_f32 v211, v211, v235
    v_mul_f32 v212, v212, v235
    v_mul_f32 v213, v213, v235
    v_mul_f32 v214, v214, v235
    v_mul_f32 v215, v215, v235
    v_mul_f32 v216, v216, v235
    v_mul_f32 v217, v217, v235
    v_mul_f32 v218, v218, v235
    v_mul_f32 v219, v219, v235
    v_mul_f32 v220, v220, v235
    v_mul_f32 v221, v221, v235
    v_mul_f32 v222, v222, v235
    v_mul_f32 v223, v223, v235
    v_mul_f32 v224, v224, v235
    v_mul_f32 v225, v225, v235
    v_mul_f32 v226, v226, v235
    v_mul_f32 v227, v227, v235
    v_mul_f32 v228, v228, v235
    v_mul_f32 v229, v229, v235
    v_mul_f32 v230, v230, v235
    v_mul_f32 v231, v231, v235
    v_mul_f32 v4, v4, v235
    v_exp_f32 v104, v104
    v_exp_f32 v105, v105
    v_exp_f32 v106, v106
    v_exp_f32 v107, v107
    v_add_f32 v244, v4, v104
    v_cvt_pk_bf16_f32 v152, v104, v105
    v_exp_f32 v108, v108
    v_exp_f32 v109, v109
    v_add_f32 v244, v244, v106
    v_add_f32 v232, v105, v107
    v_cvt_pk_bf16_f32 v153, v106, v107
    v_exp_f32 v110, v110
    v_exp_f32 v111, v111
    v_add_f32 v244, v244, v108
    v_add_f32 v232, v232, v109
    v_cvt_pk_bf16_f32 v154, v108, v109
    v_exp_f32 v112, v112
    v_exp_f32 v113, v113
    v_add_f32 v244, v244, v110
    v_add_f32 v232, v232, v111
    v_cvt_pk_bf16_f32 v155, v110, v111
    v_exp_f32 v114, v114
    v_exp_f32 v115, v115
    v_add_f32 v244, v244, v112
    v_add_f32 v232, v232, v113
    v_cvt_pk_bf16_f32 v156, v112, v113
    v_exp_f32 v116, v116
    v_exp_f32 v117, v117
    v_add_f32 v244, v244, v114
    v_add_f32 v232, v232, v115
    v_cvt_pk_bf16_f32 v157, v114, v115
    v_exp_f32 v118, v118
    v_exp_f32 v119, v119
    v_add_f32 v244, v244, v116
    v_add_f32 v232, v232, v117
    v_cvt_pk_bf16_f32 v158, v116, v117
    v_add_f32 v244, v244, v118
    v_add_f32 v232, v232, v119
    v_cvt_pk_bf16_f32 v159, v118, v119
    v_add_f32 v244, v244, v232
    s_nop 1
    s_branch back_39
resc_48:
    s_nop 15
    s_nop 15
    s_sub_u32 s66, s55, 1
    s_lshl_b32 s66, s66, 1
    s_add_u32 s66, s66, s45
    s_lshl_b32 s66, s66, 14
    s_lshl_b32 s67, s41, 19
    s_add_u32 s66, s66, s67
    s_add_u32 s66, s66, 8192
    s_add_u32 s67, s66, 4096

    buffer_load_dwordx4 v[236:239], v1, s[24:27], s66 offen offset:0
    s_waitcnt vmcnt(0)
    v_mfma_f32_32x32x16_bf16 v[120:135], v[236:239], v[40:43], v[136:151]
    s_nop 7
    buffer_load_dwordx4 v[236:239], v1, s[24:27], s66 offen offset:1024
    s_waitcnt vmcnt(0)
    v_mfma_f32_32x32x16_bf16 v[120:135], v[236:239], v[44:47], v[120:135]
    s_nop 7
    buffer_load_dwordx4 v[236:239], v1, s[24:27], s66 offen offset:2048
    s_waitcnt vmcnt(0)
    v_mfma_f32_32x32x16_bf16 v[120:135], v[236:239], v[48:51], v[120:135]
    s_nop 7
    buffer_load_dwordx4 v[236:239], v1, s[24:27], s66 offen offset:3072
    s_waitcnt vmcnt(0)
    v_mfma_f32_32x32x16_bf16 v[120:135], v[236:239], v[52:55], v[120:135]
    s_nop 7
    buffer_load_dwordx4 v[236:239], v1, s[24:27], s67 offen offset:0
    s_waitcnt vmcnt(0)
    v_mfma_f32_32x32x16_bf16 v[120:135], v[236:239], v[56:59], v[120:135]
    s_nop 7
    buffer_load_dwordx4 v[236:239], v1, s[24:27], s67 offen offset:1024
    s_waitcnt vmcnt(0)
    v_mfma_f32_32x32x16_bf16 v[120:135], v[236:239], v[60:63], v[120:135]
    s_nop 7
    buffer_load_dwordx4 v[236:239], v1, s[24:27], s67 offen offset:2048
    s_waitcnt vmcnt(0)
    v_mfma_f32_32x32x16_bf16 v[120:135], v[236:239], v[64:67], v[120:135]
    s_nop 7
    buffer_load_dwordx4 v[236:239], v1, s[24:27], s67 offen offset:3072
    s_waitcnt vmcnt(0)
    v_mfma_f32_32x32x16_bf16 v[120:135], v[236:239], v[68:71], v[120:135]
    s_nop 7
    s_nop 15
    v_max3_f32 v234, v120, v121, v122
    v_max3_f32 v234, v234, v123, v124
    v_max3_f32 v234, v234, v125, v126
    v_max3_f32 v234, v234, v127, v128
    v_max3_f32 v234, v234, v129, v130
    v_max3_f32 v234, v234, v131, v132
    v_max3_f32 v234, v234, v133, v134
    v_max_f32 v234, v234, v135
    v_mov_b32 v235, v234
    s_nop 1
    v_permlane32_swap_b32 v234, v235
    s_nop 1
    v_max_f32 v234, v234, v235
    v_max_f32 v234, 0, v234
    v_sub_f32 v235, 0, v234
    v_exp_f32 v235, v235
    v_sub_f32 v136, v136, v234
    v_sub_f32 v137, v137, v234
    v_sub_f32 v138, v138, v234
    v_sub_f32 v139, v139, v234
    v_sub_f32 v140, v140, v234
    v_sub_f32 v141, v141, v234
    v_sub_f32 v142, v142, v234
    v_sub_f32 v143, v143, v234
    v_sub_f32 v144, v144, v234
    v_sub_f32 v145, v145, v234
    v_sub_f32 v146, v146, v234
    v_sub_f32 v147, v147, v234
    v_sub_f32 v148, v148, v234
    v_sub_f32 v149, v149, v234
    v_sub_f32 v150, v150, v234
    v_sub_f32 v151, v151, v234
    v_sub_f32 v104, v104, v234
    v_sub_f32 v105, v105, v234
    v_sub_f32 v106, v106, v234
    v_sub_f32 v107, v107, v234
    v_sub_f32 v108, v108, v234
    v_sub_f32 v109, v109, v234
    v_sub_f32 v110, v110, v234
    v_sub_f32 v111, v111, v234
    v_sub_f32 v112, v112, v234
    v_sub_f32 v113, v113, v234
    v_sub_f32 v114, v114, v234
    v_sub_f32 v115, v115, v234
    v_sub_f32 v116, v116, v234
    v_sub_f32 v117, v117, v234
    v_sub_f32 v118, v118, v234
    v_sub_f32 v119, v119, v234
    v_sub_f32 v120, v120, v234
    v_sub_f32 v121, v121, v234
    v_sub_f32 v122, v122, v234
    v_sub_f32 v123, v123, v234
    v_sub_f32 v124, v124, v234
    v_sub_f32 v125, v125, v234
    v_sub_f32 v126, v126, v234
    v_sub_f32 v127, v127, v234
    v_sub_f32 v128, v128, v234
    v_sub_f32 v129, v129, v234
    v_sub_f32 v130, v130, v234
    v_sub_f32 v131, v131, v234
    v_sub_f32 v132, v132, v234
    v_sub_f32 v133, v133, v234
    v_sub_f32 v134, v134, v234
    v_sub_f32 v135, v135, v234
    v_mul_f32 v168, v168, v235
    v_mul_f32 v169, v169, v235
    v_mul_f32 v170, v170, v235
    v_mul_f32 v171, v171, v235
    v_mul_f32 v172, v172, v235
    v_mul_f32 v173, v173, v235
    v_mul_f32 v174, v174, v235
    v_mul_f32 v175, v175, v235
    v_mul_f32 v176, v176, v235
    v_mul_f32 v177, v177, v235
    v_mul_f32 v178, v178, v235
    v_mul_f32 v179, v179, v235
    v_mul_f32 v180, v180, v235
    v_mul_f32 v181, v181, v235
    v_mul_f32 v182, v182, v235
    v_mul_f32 v183, v183, v235
    v_mul_f32 v184, v184, v235
    v_mul_f32 v185, v185, v235
    v_mul_f32 v186, v186, v235
    v_mul_f32 v187, v187, v235
    v_mul_f32 v188, v188, v235
    v_mul_f32 v189, v189, v235
    v_mul_f32 v190, v190, v235
    v_mul_f32 v191, v191, v235
    v_mul_f32 v192, v192, v235
    v_mul_f32 v193, v193, v235
    v_mul_f32 v194, v194, v235
    v_mul_f32 v195, v195, v235
    v_mul_f32 v196, v196, v235
    v_mul_f32 v197, v197, v235
    v_mul_f32 v198, v198, v235
    v_mul_f32 v199, v199, v235
    v_mul_f32 v200, v200, v235
    v_mul_f32 v201, v201, v235
    v_mul_f32 v202, v202, v235
    v_mul_f32 v203, v203, v235
    v_mul_f32 v204, v204, v235
    v_mul_f32 v205, v205, v235
    v_mul_f32 v206, v206, v235
    v_mul_f32 v207, v207, v235
    v_mul_f32 v208, v208, v235
    v_mul_f32 v209, v209, v235
    v_mul_f32 v210, v210, v235
    v_mul_f32 v211, v211, v235
    v_mul_f32 v212, v212, v235
    v_mul_f32 v213, v213, v235
    v_mul_f32 v214, v214, v235
    v_mul_f32 v215, v215, v235
    v_mul_f32 v216, v216, v235
    v_mul_f32 v217, v217, v235
    v_mul_f32 v218, v218, v235
    v_mul_f32 v219, v219, v235
    v_mul_f32 v220, v220, v235
    v_mul_f32 v221, v221, v235
    v_mul_f32 v222, v222, v235
    v_mul_f32 v223, v223, v235
    v_mul_f32 v224, v224, v235
    v_mul_f32 v225, v225, v235
    v_mul_f32 v226, v226, v235
    v_mul_f32 v227, v227, v235
    v_mul_f32 v228, v228, v235
    v_mul_f32 v229, v229, v235
    v_mul_f32 v230, v230, v235
    v_mul_f32 v231, v231, v235
    v_mul_f32 v244, v244, v235
    v_exp_f32 v120, v120
    v_exp_f32 v121, v121
    v_exp_f32 v122, v122
    v_exp_f32 v123, v123
    v_add_f32 v4, v244, v120
    v_cvt_pk_bf16_f32 v160, v120, v121
    v_exp_f32 v124, v124
    v_exp_f32 v125, v125
    v_add_f32 v4, v4, v122
    v_add_f32 v233, v121, v123
    v_cvt_pk_bf16_f32 v161, v122, v123
    v_exp_f32 v126, v126
    v_exp_f32 v127, v127
    v_add_f32 v4, v4, v124
    v_add_f32 v233, v233, v125
    v_cvt_pk_bf16_f32 v162, v124, v125
    v_exp_f32 v128, v128
    v_exp_f32 v129, v129
    v_add_f32 v4, v4, v126
    v_add_f32 v233, v233, v127
    v_cvt_pk_bf16_f32 v163, v126, v127
    v_exp_f32 v130, v130
    v_exp_f32 v131, v131
    v_add_f32 v4, v4, v128
    v_add_f32 v233, v233, v129
    v_cvt_pk_bf16_f32 v164, v128, v129
    v_exp_f32 v132, v132
    v_exp_f32 v133, v133
    v_add_f32 v4, v4, v130
    v_add_f32 v233, v233, v131
    v_cvt_pk_bf16_f32 v165, v130, v131
    v_exp_f32 v134, v134
    v_exp_f32 v135, v135
    v_add_f32 v4, v4, v132
    v_add_f32 v233, v233, v133
    v_cvt_pk_bf16_f32 v166, v132, v133
    v_add_f32 v4, v4, v134
    v_add_f32 v233, v233, v135
    v_cvt_pk_bf16_f32 v167, v134, v135
    v_add_f32 v4, v4, v233
    s_nop 1
    s_branch back_49
resc_58:
    s_nop 15
    s_nop 15
    s_sub_u32 s66, s55, 0
    s_lshl_b32 s66, s66, 1
    s_add_u32 s66, s66, s45
    s_lshl_b32 s66, s66, 14
    s_lshl_b32 s67, s41, 19
    s_add_u32 s66, s66, s67
    s_add_u32 s66, s66, 0
    s_add_u32 s67, s66, 4096

    buffer_load_dwordx4 v[236:239], v1, s[24:27], s66 offen offset:0
    s_waitcnt vmcnt(0)
    v_mfma_f32_32x32x16_bf16 v[104:119], v[236:239], v[40:43], v[136:151]
    s_nop 7
    buffer_load_dwordx4 v[236:239], v1, s[24:27], s66 offen offset:1024
    s_waitcnt vmcnt(0)
    v_mfma_f32_32x32x16_bf16 v[104:119], v[236:239], v[44:47], v[104:119]
    s_nop 7
    buffer_load_dwordx4 v[236:239], v1, s[24:27], s66 offen offset:2048
    s_waitcnt vmcnt(0)
    v_mfma_f32_32x32x16_bf16 v[104:119], v[236:239], v[48:51], v[104:119]
    s_nop 7
    buffer_load_dwordx4 v[236:239], v1, s[24:27], s66 offen offset:3072
    s_waitcnt vmcnt(0)
    v_mfma_f32_32x32x16_bf16 v[104:119], v[236:239], v[52:55], v[104:119]
    s_nop 7
    buffer_load_dwordx4 v[236:239], v1, s[24:27], s67 offen offset:0
    s_waitcnt vmcnt(0)
    v_mfma_f32_32x32x16_bf16 v[104:119], v[236:239], v[56:59], v[104:119]
    s_nop 7
    buffer_load_dwordx4 v[236:239], v1, s[24:27], s67 offen offset:1024
    s_waitcnt vmcnt(0)
    v_mfma_f32_32x32x16_bf16 v[104:119], v[236:239], v[60:63], v[104:119]
    s_nop 7
    buffer_load_dwordx4 v[236:239], v1, s[24:27], s67 offen offset:2048
    s_waitcnt vmcnt(0)
    v_mfma_f32_32x32x16_bf16 v[104:119], v[236:239], v[64:67], v[104:119]
    s_nop 7
    buffer_load_dwordx4 v[236:239], v1, s[24:27], s67 offen offset:3072
    s_waitcnt vmcnt(0)
    v_mfma_f32_32x32x16_bf16 v[104:119], v[236:239], v[68:71], v[104:119]
    s_nop 7
    s_nop 15
    v_cmp_gt_i32 s[12:13], 0, v7
    v_cmp_gt_i32 s[14:15], 1, v7
    v_cmp_gt_i32 s[16:17], 2, v7
    v_cmp_gt_i32 s[18:19], 3, v7
    v_cndmask_b32 v104, v104, v247, s[12:13]
    v_cndmask_b32 v105, v105, v247, s[14:15]
    v_cndmask_b32 v106, v106, v247, s[16:17]
    v_cndmask_b32 v107, v107, v247, s[18:19]
    v_cmp_gt_i32 s[12:13], 8, v7
    v_cmp_gt_i32 s[14:15], 9, v7
    v_cmp_gt_i32 s[16:17], 10, v7
    v_cmp_gt_i32 s[18:19], 11, v7
    v_cndmask_b32 v108, v108, v247, s[12:13]
    v_cndmask_b32 v109, v109, v247, s[14:15]
    v_cndmask_b32 v110, v110, v247, s[16:17]
    v_cndmask_b32 v111, v111, v247, s[18:19]
    v_cmp_gt_i32 s[12:13], 16, v7
    v_cmp_gt_i32 s[14:15], 17, v7
    v_cmp_gt_i32 s[16:17], 18, v7
    v_cmp_gt_i32 s[18:19], 19, v7
    v_cndmask_b32 v112, v112, v247, s[12:13]
    v_cndmask_b32 v113, v113, v247, s[14:15]
    v_cndmask_b32 v114, v114, v247, s[16:17]
    v_cndmask_b32 v115, v115, v247, s[18:19]
    v_cmp_gt_i32 s[12:13], 24, v7
    v_cmp_gt_i32 s[14:15], 25, v7
    v_cmp_gt_i32 s[16:17], 26, v7
    v_cmp_gt_i32 s[18:19], 27, v7
    v_cndmask_b32 v116, v116, v247, s[12:13]
    v_cndmask_b32 v117, v117, v247, s[14:15]
    v_cndmask_b32 v118, v118, v247, s[16:17]
    v_cndmask_b32 v119, v119, v247, s[18:19]
    v_max3_f32 v234, v104, v105, v106
    v_max3_f32 v234, v234, v107, v108
    v_max3_f32 v234, v234, v109, v110
    v_max3_f32 v234, v234, v111, v112
    v_max3_f32 v234, v234, v113, v114
    v_max3_f32 v234, v234, v115, v116
    v_max3_f32 v234, v234, v117, v118
    v_max_f32 v234, v234, v119
    v_mov_b32 v235, v234
    s_nop 1
    v_permlane32_swap_b32 v234, v235
    s_nop 1
    v_max_f32 v234, v234, v235
    v_max_f32 v234, 0, v234
    v_sub_f32 v235, 0, v234
    v_exp_f32 v235, v235
    v_sub_f32 v136, v136, v234
    v_sub_f32 v137, v137, v234
    v_sub_f32 v138, v138, v234
    v_sub_f32 v139, v139, v234
    v_sub_f32 v140, v140, v234
    v_sub_f32 v141, v141, v234
    v_sub_f32 v142, v142, v234
    v_sub_f32 v143, v143, v234
    v_sub_f32 v144, v144, v234
    v_sub_f32 v145, v145, v234
    v_sub_f32 v146, v146, v234
    v_sub_f32 v147, v147, v234
    v_sub_f32 v148, v148, v234
    v_sub_f32 v149, v149, v234
    v_sub_f32 v150, v150, v234
    v_sub_f32 v151, v151, v234
    v_sub_f32 v104, v104, v234
    v_sub_f32 v105, v105, v234
    v_sub_f32 v106, v106, v234
    v_sub_f32 v107, v107, v234
    v_sub_f32 v108, v108, v234
    v_sub_f32 v109, v109, v234
    v_sub_f32 v110, v110, v234
    v_sub_f32 v111, v111, v234
    v_sub_f32 v112, v112, v234
    v_sub_f32 v113, v113, v234
    v_sub_f32 v114, v114, v234
    v_sub_f32 v115, v115, v234
    v_sub_f32 v116, v116, v234
    v_sub_f32 v117, v117, v234
    v_sub_f32 v118, v118, v234
    v_sub_f32 v119, v119, v234
    v_sub_f32 v120, v120, v234
    v_sub_f32 v121, v121, v234
    v_sub_f32 v122, v122, v234
    v_sub_f32 v123, v123, v234
    v_sub_f32 v124, v124, v234
    v_sub_f32 v125, v125, v234
    v_sub_f32 v126, v126, v234
    v_sub_f32 v127, v127, v234
    v_sub_f32 v128, v128, v234
    v_sub_f32 v129, v129, v234
    v_sub_f32 v130, v130, v234
    v_sub_f32 v131, v131, v234
    v_sub_f32 v132, v132, v234
    v_sub_f32 v133, v133, v234
    v_sub_f32 v134, v134, v234
    v_sub_f32 v135, v135, v234
    v_mul_f32 v168, v168, v235
    v_mul_f32 v169, v169, v235
    v_mul_f32 v170, v170, v235
    v_mul_f32 v171, v171, v235
    v_mul_f32 v172, v172, v235
    v_mul_f32 v173, v173, v235
    v_mul_f32 v174, v174, v235
    v_mul_f32 v175, v175, v235
    v_mul_f32 v176, v176, v235
    v_mul_f32 v177, v177, v235
    v_mul_f32 v178, v178, v235
    v_mul_f32 v179, v179, v235
    v_mul_f32 v180, v180, v235
    v_mul_f32 v181, v181, v235
    v_mul_f32 v182, v182, v235
    v_mul_f32 v183, v183, v235
    v_mul_f32 v184, v184, v235
    v_mul_f32 v185, v185, v235
    v_mul_f32 v186, v186, v235
    v_mul_f32 v187, v187, v235
    v_mul_f32 v188, v188, v235
    v_mul_f32 v189, v189, v235
    v_mul_f32 v190, v190, v235
    v_mul_f32 v191, v191, v235
    v_mul_f32 v192, v192, v235
    v_mul_f32 v193, v193, v235
    v_mul_f32 v194, v194, v235
    v_mul_f32 v195, v195, v235
    v_mul_f32 v196, v196, v235
    v_mul_f32 v197, v197, v235
    v_mul_f32 v198, v198, v235
    v_mul_f32 v199, v199, v235
    v_mul_f32 v200, v200, v235
    v_mul_f32 v201, v201, v235
    v_mul_f32 v202, v202, v235
    v_mul_f32 v203, v203, v235
    v_mul_f32 v204, v204, v235
    v_mul_f32 v205, v205, v235
    v_mul_f32 v206, v206, v235
    v_mul_f32 v207, v207, v235
    v_mul_f32 v208, v208, v235
    v_mul_f32 v209, v209, v235
    v_mul_f32 v210, v210, v235
    v_mul_f32 v211, v211, v235
    v_mul_f32 v212, v212, v235
    v_mul_f32 v213, v213, v235
    v_mul_f32 v214, v214, v235
    v_mul_f32 v215, v215, v235
    v_mul_f32 v216, v216, v235
    v_mul_f32 v217, v217, v235
    v_mul_f32 v218, v218, v235
    v_mul_f32 v219, v219, v235
    v_mul_f32 v220, v220, v235
    v_mul_f32 v221, v221, v235
    v_mul_f32 v222, v222, v235
    v_mul_f32 v223, v223, v235
    v_mul_f32 v224, v224, v235
    v_mul_f32 v225, v225, v235
    v_mul_f32 v226, v226, v235
    v_mul_f32 v227, v227, v235
    v_mul_f32 v228, v228, v235
    v_mul_f32 v229, v229, v235
    v_mul_f32 v230, v230, v235
    v_mul_f32 v231, v231, v235
    v_mul_f32 v4, v4, v235
    v_exp_f32 v104, v104
    v_exp_f32 v105, v105
    v_exp_f32 v106, v106
    v_exp_f32 v107, v107
    v_add_f32 v244, v4, v104
    v_cvt_pk_bf16_f32 v152, v104, v105
    v_exp_f32 v108, v108
    v_exp_f32 v109, v109
    v_add_f32 v244, v244, v106
    v_add_f32 v232, v105, v107
    v_cvt_pk_bf16_f32 v153, v106, v107
    v_exp_f32 v110, v110
    v_exp_f32 v111, v111
    v_add_f32 v244, v244, v108
    v_add_f32 v232, v232, v109
    v_cvt_pk_bf16_f32 v154, v108, v109
    v_exp_f32 v112, v112
    v_exp_f32 v113, v113
    v_add_f32 v244, v244, v110
    v_add_f32 v232, v232, v111
    v_cvt_pk_bf16_f32 v155, v110, v111
    v_exp_f32 v114, v114
    v_exp_f32 v115, v115
    v_add_f32 v244, v244, v112
    v_add_f32 v232, v232, v113
    v_cvt_pk_bf16_f32 v156, v112, v113
    v_exp_f32 v116, v116
    v_exp_f32 v117, v117
    v_add_f32 v244, v244, v114
    v_add_f32 v232, v232, v115
    v_cvt_pk_bf16_f32 v157, v114, v115
    v_exp_f32 v118, v118
    v_exp_f32 v119, v119
    v_add_f32 v244, v244, v116
    v_add_f32 v232, v232, v117
    v_cvt_pk_bf16_f32 v158, v116, v117
    v_add_f32 v244, v244, v118
    v_add_f32 v232, v232, v119
    v_cvt_pk_bf16_f32 v159, v118, v119
    v_add_f32 v244, v244, v232
    s_nop 1
    s_branch back_59
resc_68:
    s_nop 15
    s_nop 15
    s_sub_u32 s66, s55, 0
    s_lshl_b32 s66, s66, 1
    s_add_u32 s66, s66, s45
    s_lshl_b32 s66, s66, 14
    s_lshl_b32 s67, s41, 19
    s_add_u32 s66, s66, s67
    s_add_u32 s66, s66, 8192
    s_add_u32 s67, s66, 4096

    buffer_load_dwordx4 v[236:239], v1, s[24:27], s66 offen offset:0
    s_waitcnt vmcnt(0)
    v_mfma_f32_32x32x16_bf16 v[120:135], v[236:239], v[40:43], v[136:151]
    s_nop 7
    buffer_load_dwordx4 v[236:239], v1, s[24:27], s66 offen offset:1024
    s_waitcnt vmcnt(0)
    v_mfma_f32_32x32x16_bf16 v[120:135], v[236:239], v[44:47], v[120:135]
    s_nop 7
    buffer_load_dwordx4 v[236:239], v1, s[24:27], s66 offen offset:2048
    s_waitcnt vmcnt(0)
    v_mfma_f32_32x32x16_bf16 v[120:135], v[236:239], v[48:51], v[120:135]
    s_nop 7
    buffer_load_dwordx4 v[236:239], v1, s[24:27], s66 offen offset:3072
    s_waitcnt vmcnt(0)
    v_mfma_f32_32x32x16_bf16 v[120:135], v[236:239], v[52:55], v[120:135]
    s_nop 7
    buffer_load_dwordx4 v[236:239], v1, s[24:27], s67 offen offset:0
    s_waitcnt vmcnt(0)
    v_mfma_f32_32x32x16_bf16 v[120:135], v[236:239], v[56:59], v[120:135]
    s_nop 7
    buffer_load_dwordx4 v[236:239], v1, s[24:27], s67 offen offset:1024
    s_waitcnt vmcnt(0)
    v_mfma_f32_32x32x16_bf16 v[120:135], v[236:239], v[60:63], v[120:135]
    s_nop 7
    buffer_load_dwordx4 v[236:239], v1, s[24:27], s67 offen offset:2048
    s_waitcnt vmcnt(0)
    v_mfma_f32_32x32x16_bf16 v[120:135], v[236:239], v[64:67], v[120:135]
    s_nop 7
    buffer_load_dwordx4 v[236:239], v1, s[24:27], s67 offen offset:3072
    s_waitcnt vmcnt(0)
    v_mfma_f32_32x32x16_bf16 v[120:135], v[236:239], v[68:71], v[120:135]
    s_nop 7
    s_nop 15
    v_cmp_gt_i32 s[12:13], 32, v7
    v_cmp_gt_i32 s[14:15], 33, v7
    v_cmp_gt_i32 s[16:17], 34, v7
    v_cmp_gt_i32 s[18:19], 35, v7
    v_cndmask_b32 v120, v120, v247, s[12:13]
    v_cndmask_b32 v121, v121, v247, s[14:15]
    v_cndmask_b32 v122, v122, v247, s[16:17]
    v_cndmask_b32 v123, v123, v247, s[18:19]
    v_cmp_gt_i32 s[12:13], 40, v7
    v_cmp_gt_i32 s[14:15], 41, v7
    v_cmp_gt_i32 s[16:17], 42, v7
    v_cmp_gt_i32 s[18:19], 43, v7
    v_cndmask_b32 v124, v124, v247, s[12:13]
    v_cndmask_b32 v125, v125, v247, s[14:15]
    v_cndmask_b32 v126, v126, v247, s[16:17]
    v_cndmask_b32 v127, v127, v247, s[18:19]
    v_cmp_gt_i32 s[12:13], 48, v7
    v_cmp_gt_i32 s[14:15], 49, v7
    v_cmp_gt_i32 s[16:17], 50, v7
    v_cmp_gt_i32 s[18:19], 51, v7
    v_cndmask_b32 v128, v128, v247, s[12:13]
    v_cndmask_b32 v129, v129, v247, s[14:15]
    v_cndmask_b32 v130, v130, v247, s[16:17]
    v_cndmask_b32 v131, v131, v247, s[18:19]
    v_cmp_gt_i32 s[12:13], 56, v7
    v_cmp_gt_i32 s[14:15], 57, v7
    v_cmp_gt_i32 s[16:17], 58, v7
    v_cmp_gt_i32 s[18:19], 59, v7
    v_cndmask_b32 v132, v132, v247, s[12:13]
    v_cndmask_b32 v133, v133, v247, s[14:15]
    v_cndmask_b32 v134, v134, v247, s[16:17]
    v_cndmask_b32 v135, v135, v247, s[18:19]
    v_max3_f32 v234, v120, v121, v122
    v_max3_f32 v234, v234, v123, v124
    v_max3_f32 v234, v234, v125, v126
    v_max3_f32 v234, v234, v127, v128
    v_max3_f32 v234, v234, v129, v130
    v_max3_f32 v234, v234, v131, v132
    v_max3_f32 v234, v234, v133, v134
    v_max_f32 v234, v234, v135
    v_mov_b32 v235, v234
    s_nop 1
    v_permlane32_swap_b32 v234, v235
    s_nop 1
    v_max_f32 v234, v234, v235
    v_max_f32 v234, 0, v234
    v_sub_f32 v235, 0, v234
    v_exp_f32 v235, v235
    v_sub_f32 v136, v136, v234
    v_sub_f32 v137, v137, v234
    v_sub_f32 v138, v138, v234
    v_sub_f32 v139, v139, v234
    v_sub_f32 v140, v140, v234
    v_sub_f32 v141, v141, v234
    v_sub_f32 v142, v142, v234
    v_sub_f32 v143, v143, v234
    v_sub_f32 v144, v144, v234
    v_sub_f32 v145, v145, v234
    v_sub_f32 v146, v146, v234
    v_sub_f32 v147, v147, v234
    v_sub_f32 v148, v148, v234
    v_sub_f32 v149, v149, v234
    v_sub_f32 v150, v150, v234
    v_sub_f32 v151, v151, v234
    v_sub_f32 v104, v104, v234
    v_sub_f32 v105, v105, v234
    v_sub_f32 v106, v106, v234
    v_sub_f32 v107, v107, v234
    v_sub_f32 v108, v108, v234
    v_sub_f32 v109, v109, v234
    v_sub_f32 v110, v110, v234
    v_sub_f32 v111, v111, v234
    v_sub_f32 v112, v112, v234
    v_sub_f32 v113, v113, v234
    v_sub_f32 v114, v114, v234
    v_sub_f32 v115, v115, v234
    v_sub_f32 v116, v116, v234
    v_sub_f32 v117, v117, v234
    v_sub_f32 v118, v118, v234
    v_sub_f32 v119, v119, v234
    v_sub_f32 v120, v120, v234
    v_sub_f32 v121, v121, v234
    v_sub_f32 v122, v122, v234
    v_sub_f32 v123, v123, v234
    v_sub_f32 v124, v124, v234
    v_sub_f32 v125, v125, v234
    v_sub_f32 v126, v126, v234
    v_sub_f32 v127, v127, v234
    v_sub_f32 v128, v128, v234
    v_sub_f32 v129, v129, v234
    v_sub_f32 v130, v130, v234
    v_sub_f32 v131, v131, v234
    v_sub_f32 v132, v132, v234
    v_sub_f32 v133, v133, v234
    v_sub_f32 v134, v134, v234
    v_sub_f32 v135, v135, v234
    v_mul_f32 v168, v168, v235
    v_mul_f32 v169, v169, v235
    v_mul_f32 v170, v170, v235
    v_mul_f32 v171, v171, v235
    v_mul_f32 v172, v172, v235
    v_mul_f32 v173, v173, v235
    v_mul_f32 v174, v174, v235
    v_mul_f32 v175, v175, v235
    v_mul_f32 v176, v176, v235
    v_mul_f32 v177, v177, v235
    v_mul_f32 v178, v178, v235
    v_mul_f32 v179, v179, v235
    v_mul_f32 v180, v180, v235
    v_mul_f32 v181, v181, v235
    v_mul_f32 v182, v182, v235
    v_mul_f32 v183, v183, v235
    v_mul_f32 v184, v184, v235
    v_mul_f32 v185, v185, v235
    v_mul_f32 v186, v186, v235
    v_mul_f32 v187, v187, v235
    v_mul_f32 v188, v188, v235
    v_mul_f32 v189, v189, v235
    v_mul_f32 v190, v190, v235
    v_mul_f32 v191, v191, v235
    v_mul_f32 v192, v192, v235
    v_mul_f32 v193, v193, v235
    v_mul_f32 v194, v194, v235
    v_mul_f32 v195, v195, v235
    v_mul_f32 v196, v196, v235
    v_mul_f32 v197, v197, v235
    v_mul_f32 v198, v198, v235
    v_mul_f32 v199, v199, v235
    v_mul_f32 v200, v200, v235
    v_mul_f32 v201, v201, v235
    v_mul_f32 v202, v202, v235
    v_mul_f32 v203, v203, v235
    v_mul_f32 v204, v204, v235
    v_mul_f32 v205, v205, v235
    v_mul_f32 v206, v206, v235
    v_mul_f32 v207, v207, v235
    v_mul_f32 v208, v208, v235
    v_mul_f32 v209, v209, v235
    v_mul_f32 v210, v210, v235
    v_mul_f32 v211, v211, v235
    v_mul_f32 v212, v212, v235
    v_mul_f32 v213, v213, v235
    v_mul_f32 v214, v214, v235
    v_mul_f32 v215, v215, v235
    v_mul_f32 v216, v216, v235
    v_mul_f32 v217, v217, v235
    v_mul_f32 v218, v218, v235
    v_mul_f32 v219, v219, v235
    v_mul_f32 v220, v220, v235
    v_mul_f32 v221, v221, v235
    v_mul_f32 v222, v222, v235
    v_mul_f32 v223, v223, v235
    v_mul_f32 v224, v224, v235
    v_mul_f32 v225, v225, v235
    v_mul_f32 v226, v226, v235
    v_mul_f32 v227, v227, v235
    v_mul_f32 v228, v228, v235
    v_mul_f32 v229, v229, v235
    v_mul_f32 v230, v230, v235
    v_mul_f32 v231, v231, v235
    v_mul_f32 v244, v244, v235
    v_exp_f32 v120, v120
    v_exp_f32 v121, v121
    v_exp_f32 v122, v122
    v_exp_f32 v123, v123
    v_add_f32 v4, v244, v120
    v_cvt_pk_bf16_f32 v160, v120, v121
    v_exp_f32 v124, v124
    v_exp_f32 v125, v125
    v_add_f32 v4, v4, v122
    v_add_f32 v233, v121, v123
    v_cvt_pk_bf16_f32 v161, v122, v123
    v_exp_f32 v126, v126
    v_exp_f32 v127, v127
    v_add_f32 v4, v4, v124
    v_add_f32 v233, v233, v125
    v_cvt_pk_bf16_f32 v162, v124, v125
    v_exp_f32 v128, v128
    v_exp_f32 v129, v129
    v_add_f32 v4, v4, v126
    v_add_f32 v233, v233, v127
    v_cvt_pk_bf16_f32 v163, v126, v127
    v_exp_f32 v130, v130
    v_exp_f32 v131, v131
    v_add_f32 v4, v4, v128
    v_add_f32 v233, v233, v129
    v_cvt_pk_bf16_f32 v164, v128, v129
    v_exp_f32 v132, v132
    v_exp_f32 v133, v133
    v_add_f32 v4, v4, v130
    v_add_f32 v233, v233, v131
    v_cvt_pk_bf16_f32 v165, v130, v131
    v_exp_f32 v134, v134
    v_exp_f32 v135, v135
    v_add_f32 v4, v4, v132
    v_add_f32 v233, v233, v133
    v_cvt_pk_bf16_f32 v166, v132, v133
    v_add_f32 v4, v4, v134
    v_add_f32 v233, v233, v135
    v_cvt_pk_bf16_f32 v167, v134, v135
    v_add_f32 v4, v4, v233
    s_nop 1
    s_branch back_69
resc_94:
    s_nop 15
    s_nop 15
    s_sub_u32 s66, s55, 0
    s_lshl_b32 s66, s66, 1
    s_add_u32 s66, s66, s45
    s_lshl_b32 s66, s66, 14
    s_lshl_b32 s67, s41, 19
    s_add_u32 s66, s66, s67
    s_add_u32 s66, s66, 0
    s_add_u32 s67, s66, 4096

    buffer_load_dwordx4 v[236:239], v1, s[24:27], s66 offen offset:0
    s_waitcnt vmcnt(0)
    v_mfma_f32_32x32x16_bf16 v[104:119], v[236:239], v[40:43], v[136:151]
    s_nop 7
    buffer_load_dwordx4 v[236:239], v1, s[24:27], s66 offen offset:1024
    s_waitcnt vmcnt(0)
    v_mfma_f32_32x32x16_bf16 v[104:119], v[236:239], v[44:47], v[104:119]
    s_nop 7
    buffer_load_dwordx4 v[236:239], v1, s[24:27], s66 offen offset:2048
    s_waitcnt vmcnt(0)
    v_mfma_f32_32x32x16_bf16 v[104:119], v[236:239], v[48:51], v[104:119]
    s_nop 7
    buffer_load_dwordx4 v[236:239], v1, s[24:27], s66 offen offset:3072
    s_waitcnt vmcnt(0)
    v_mfma_f32_32x32x16_bf16 v[104:119], v[236:239], v[52:55], v[104:119]
    s_nop 7
    buffer_load_dwordx4 v[236:239], v1, s[24:27], s67 offen offset:0
    s_waitcnt vmcnt(0)
    v_mfma_f32_32x32x16_bf16 v[104:119], v[236:239], v[56:59], v[104:119]
    s_nop 7
    buffer_load_dwordx4 v[236:239], v1, s[24:27], s67 offen offset:1024
    s_waitcnt vmcnt(0)
    v_mfma_f32_32x32x16_bf16 v[104:119], v[236:239], v[60:63], v[104:119]
    s_nop 7
    buffer_load_dwordx4 v[236:239], v1, s[24:27], s67 offen offset:2048
    s_waitcnt vmcnt(0)
    v_mfma_f32_32x32x16_bf16 v[104:119], v[236:239], v[64:67], v[104:119]
    s_nop 7
    buffer_load_dwordx4 v[236:239], v1, s[24:27], s67 offen offset:3072
    s_waitcnt vmcnt(0)
    v_mfma_f32_32x32x16_bf16 v[104:119], v[236:239], v[68:71], v[104:119]
    s_nop 7
    s_nop 15
    v_cmp_gt_i32 s[12:13], 0, v7
    v_cmp_gt_i32 s[14:15], 1, v7
    v_cmp_gt_i32 s[16:17], 2, v7
    v_cmp_gt_i32 s[18:19], 3, v7
    v_cndmask_b32 v104, v104, v247, s[12:13]
    v_cndmask_b32 v105, v105, v247, s[14:15]
    v_cndmask_b32 v106, v106, v247, s[16:17]
    v_cndmask_b32 v107, v107, v247, s[18:19]
    v_cmp_gt_i32 s[12:13], 8, v7
    v_cmp_gt_i32 s[14:15], 9, v7
    v_cmp_gt_i32 s[16:17], 10, v7
    v_cmp_gt_i32 s[18:19], 11, v7
    v_cndmask_b32 v108, v108, v247, s[12:13]
    v_cndmask_b32 v109, v109, v247, s[14:15]
    v_cndmask_b32 v110, v110, v247, s[16:17]
    v_cndmask_b32 v111, v111, v247, s[18:19]
    v_cmp_gt_i32 s[12:13], 16, v7
    v_cmp_gt_i32 s[14:15], 17, v7
    v_cmp_gt_i32 s[16:17], 18, v7
    v_cmp_gt_i32 s[18:19], 19, v7
    v_cndmask_b32 v112, v112, v247, s[12:13]
    v_cndmask_b32 v113, v113, v247, s[14:15]
    v_cndmask_b32 v114, v114, v247, s[16:17]
    v_cndmask_b32 v115, v115, v247, s[18:19]
    v_cmp_gt_i32 s[12:13], 24, v7
    v_cmp_gt_i32 s[14:15], 25, v7
    v_cmp_gt_i32 s[16:17], 26, v7
    v_cmp_gt_i32 s[18:19], 27, v7
    v_cndmask_b32 v116, v116, v247, s[12:13]
    v_cndmask_b32 v117, v117, v247, s[14:15]
    v_cndmask_b32 v118, v118, v247, s[16:17]
    v_cndmask_b32 v119, v119, v247, s[18:19]
    v_max3_f32 v234, v104, v105, v106
    v_max3_f32 v234, v234, v107, v108
    v_max3_f32 v234, v234, v109, v110
    v_max3_f32 v234, v234, v111, v112
    v_max3_f32 v234, v234, v113, v114
    v_max3_f32 v234, v234, v115, v116
    v_max3_f32 v234, v234, v117, v118
    v_max_f32 v234, v234, v119
    v_mov_b32 v235, v234
    s_nop 1
    v_permlane32_swap_b32 v234, v235
    s_nop 1
    v_max_f32 v234, v234, v235
    v_max_f32 v234, 0, v234
    v_sub_f32 v235, 0, v234
    v_exp_f32 v235, v235
    v_sub_f32 v136, v136, v234
    v_sub_f32 v137, v137, v234
    v_sub_f32 v138, v138, v234
    v_sub_f32 v139, v139, v234
    v_sub_f32 v140, v140, v234
    v_sub_f32 v141, v141, v234
    v_sub_f32 v142, v142, v234
    v_sub_f32 v143, v143, v234
    v_sub_f32 v144, v144, v234
    v_sub_f32 v145, v145, v234
    v_sub_f32 v146, v146, v234
    v_sub_f32 v147, v147, v234
    v_sub_f32 v148, v148, v234
    v_sub_f32 v149, v149, v234
    v_sub_f32 v150, v150, v234
    v_sub_f32 v151, v151, v234
    v_sub_f32 v104, v104, v234
    v_sub_f32 v105, v105, v234
    v_sub_f32 v106, v106, v234
    v_sub_f32 v107, v107, v234
    v_sub_f32 v108, v108, v234
    v_sub_f32 v109, v109, v234
    v_sub_f32 v110, v110, v234
    v_sub_f32 v111, v111, v234
    v_sub_f32 v112, v112, v234
    v_sub_f32 v113, v113, v234
    v_sub_f32 v114, v114, v234
    v_sub_f32 v115, v115, v234
    v_sub_f32 v116, v116, v234
    v_sub_f32 v117, v117, v234
    v_sub_f32 v118, v118, v234
    v_sub_f32 v119, v119, v234
    v_sub_f32 v120, v120, v234
    v_sub_f32 v121, v121, v234
    v_sub_f32 v122, v122, v234
    v_sub_f32 v123, v123, v234
    v_sub_f32 v124, v124, v234
    v_sub_f32 v125, v125, v234
    v_sub_f32 v126, v126, v234
    v_sub_f32 v127, v127, v234
    v_sub_f32 v128, v128, v234
    v_sub_f32 v129, v129, v234
    v_sub_f32 v130, v130, v234
    v_sub_f32 v131, v131, v234
    v_sub_f32 v132, v132, v234
    v_sub_f32 v133, v133, v234
    v_sub_f32 v134, v134, v234
    v_sub_f32 v135, v135, v234
    v_mul_f32 v168, v168, v235
    v_mul_f32 v169, v169, v235
    v_mul_f32 v170, v170, v235
    v_mul_f32 v171, v171, v235
    v_mul_f32 v172, v172, v235
    v_mul_f32 v173, v173, v235
    v_mul_f32 v174, v174, v235
    v_mul_f32 v175, v175, v235
    v_mul_f32 v176, v176, v235
    v_mul_f32 v177, v177, v235
    v_mul_f32 v178, v178, v235
    v_mul_f32 v179, v179, v235
    v_mul_f32 v180, v180, v235
    v_mul_f32 v181, v181, v235
    v_mul_f32 v182, v182, v235
    v_mul_f32 v183, v183, v235
    v_mul_f32 v184, v184, v235
    v_mul_f32 v185, v185, v235
    v_mul_f32 v186, v186, v235
    v_mul_f32 v187, v187, v235
    v_mul_f32 v188, v188, v235
    v_mul_f32 v189, v189, v235
    v_mul_f32 v190, v190, v235
    v_mul_f32 v191, v191, v235
    v_mul_f32 v192, v192, v235
    v_mul_f32 v193, v193, v235
    v_mul_f32 v194, v194, v235
    v_mul_f32 v195, v195, v235
    v_mul_f32 v196, v196, v235
    v_mul_f32 v197, v197, v235
    v_mul_f32 v198, v198, v235
    v_mul_f32 v199, v199, v235
    v_mul_f32 v200, v200, v235
    v_mul_f32 v201, v201, v235
    v_mul_f32 v202, v202, v235
    v_mul_f32 v203, v203, v235
    v_mul_f32 v204, v204, v235
    v_mul_f32 v205, v205, v235
    v_mul_f32 v206, v206, v235
    v_mul_f32 v207, v207, v235
    v_mul_f32 v208, v208, v235
    v_mul_f32 v209, v209, v235
    v_mul_f32 v210, v210, v235
    v_mul_f32 v211, v211, v235
    v_mul_f32 v212, v212, v235
    v_mul_f32 v213, v213, v235
    v_mul_f32 v214, v214, v235
    v_mul_f32 v215, v215, v235
    v_mul_f32 v216, v216, v235
    v_mul_f32 v217, v217, v235
    v_mul_f32 v218, v218, v235
    v_mul_f32 v219, v219, v235
    v_mul_f32 v220, v220, v235
    v_mul_f32 v221, v221, v235
    v_mul_f32 v222, v222, v235
    v_mul_f32 v223, v223, v235
    v_mul_f32 v224, v224, v235
    v_mul_f32 v225, v225, v235
    v_mul_f32 v226, v226, v235
    v_mul_f32 v227, v227, v235
    v_mul_f32 v228, v228, v235
    v_mul_f32 v229, v229, v235
    v_mul_f32 v230, v230, v235
    v_mul_f32 v231, v231, v235
    v_mul_f32 v4, v4, v235
    v_exp_f32 v104, v104
    v_exp_f32 v105, v105
    v_exp_f32 v106, v106
    v_exp_f32 v107, v107
    v_add_f32 v244, v4, v104
    v_cvt_pk_bf16_f32 v152, v104, v105
    v_exp_f32 v108, v108
    v_exp_f32 v109, v109
    v_add_f32 v244, v244, v106
    v_add_f32 v232, v105, v107
    v_cvt_pk_bf16_f32 v153, v106, v107
    v_exp_f32 v110, v110
    v_exp_f32 v111, v111
    v_add_f32 v244, v244, v108
    v_add_f32 v232, v232, v109
    v_cvt_pk_bf16_f32 v154, v108, v109
    v_exp_f32 v112, v112
    v_exp_f32 v113, v113
    v_add_f32 v244, v244, v110
    v_add_f32 v232, v232, v111
    v_cvt_pk_bf16_f32 v155, v110, v111
    v_exp_f32 v114, v114
    v_exp_f32 v115, v115
    v_add_f32 v244, v244, v112
    v_add_f32 v232, v232, v113
    v_cvt_pk_bf16_f32 v156, v112, v113
    v_exp_f32 v116, v116
    v_exp_f32 v117, v117
    v_add_f32 v244, v244, v114
    v_add_f32 v232, v232, v115
    v_cvt_pk_bf16_f32 v157, v114, v115
    v_exp_f32 v118, v118
    v_exp_f32 v119, v119
    v_add_f32 v244, v244, v116
    v_add_f32 v232, v232, v117
    v_cvt_pk_bf16_f32 v158, v116, v117
    v_add_f32 v244, v244, v118
    v_add_f32 v232, v232, v119
    v_cvt_pk_bf16_f32 v159, v118, v119
    v_add_f32 v244, v244, v232
    s_nop 1
    s_branch back_95
resc_105:
    s_nop 15
    s_nop 15
    s_sub_u32 s66, s55, 0
    s_lshl_b32 s66, s66, 1
    s_add_u32 s66, s66, s45
    s_lshl_b32 s66, s66, 14
    s_lshl_b32 s67, s41, 19
    s_add_u32 s66, s66, s67
    s_add_u32 s66, s66, 8192
    s_add_u32 s67, s66, 4096

    buffer_load_dwordx4 v[236:239], v1, s[24:27], s66 offen offset:0
    s_waitcnt vmcnt(0)
    v_mfma_f32_32x32x16_bf16 v[120:135], v[236:239], v[40:43], v[136:151]
    s_nop 7
    buffer_load_dwordx4 v[236:239], v1, s[24:27], s66 offen offset:1024
    s_waitcnt vmcnt(0)
    v_mfma_f32_32x32x16_bf16 v[120:135], v[236:239], v[44:47], v[120:135]
    s_nop 7
    buffer_load_dwordx4 v[236:239], v1, s[24:27], s66 offen offset:2048
    s_waitcnt vmcnt(0)
    v_mfma_f32_32x32x16_bf16 v[120:135], v[236:239], v[48:51], v[120:135]
    s_nop 7
    buffer_load_dwordx4 v[236:239], v1, s[24:27], s66 offen offset:3072
    s_waitcnt vmcnt(0)
    v_mfma_f32_32x32x16_bf16 v[120:135], v[236:239], v[52:55], v[120:135]
    s_nop 7
    buffer_load_dwordx4 v[236:239], v1, s[24:27], s67 offen offset:0
    s_waitcnt vmcnt(0)
    v_mfma_f32_32x32x16_bf16 v[120:135], v[236:239], v[56:59], v[120:135]
    s_nop 7
    buffer_load_dwordx4 v[236:239], v1, s[24:27], s67 offen offset:1024
    s_waitcnt vmcnt(0)
    v_mfma_f32_32x32x16_bf16 v[120:135], v[236:239], v[60:63], v[120:135]
    s_nop 7
    buffer_load_dwordx4 v[236:239], v1, s[24:27], s67 offen offset:2048
    s_waitcnt vmcnt(0)
    v_mfma_f32_32x32x16_bf16 v[120:135], v[236:239], v[64:67], v[120:135]
    s_nop 7
    buffer_load_dwordx4 v[236:239], v1, s[24:27], s67 offen offset:3072
    s_waitcnt vmcnt(0)
    v_mfma_f32_32x32x16_bf16 v[120:135], v[236:239], v[68:71], v[120:135]
    s_nop 7
    s_nop 15
    v_cmp_gt_i32 s[12:13], 32, v7
    v_cmp_gt_i32 s[14:15], 33, v7
    v_cmp_gt_i32 s[16:17], 34, v7
    v_cmp_gt_i32 s[18:19], 35, v7
    v_cndmask_b32 v120, v120, v247, s[12:13]
    v_cndmask_b32 v121, v121, v247, s[14:15]
    v_cndmask_b32 v122, v122, v247, s[16:17]
    v_cndmask_b32 v123, v123, v247, s[18:19]
    v_cmp_gt_i32 s[12:13], 40, v7
    v_cmp_gt_i32 s[14:15], 41, v7
    v_cmp_gt_i32 s[16:17], 42, v7
    v_cmp_gt_i32 s[18:19], 43, v7
    v_cndmask_b32 v124, v124, v247, s[12:13]
    v_cndmask_b32 v125, v125, v247, s[14:15]
    v_cndmask_b32 v126, v126, v247, s[16:17]
    v_cndmask_b32 v127, v127, v247, s[18:19]
    v_cmp_gt_i32 s[12:13], 48, v7
    v_cmp_gt_i32 s[14:15], 49, v7
    v_cmp_gt_i32 s[16:17], 50, v7
    v_cmp_gt_i32 s[18:19], 51, v7
    v_cndmask_b32 v128, v128, v247, s[12:13]
    v_cndmask_b32 v129, v129, v247, s[14:15]
    v_cndmask_b32 v130, v130, v247, s[16:17]
    v_cndmask_b32 v131, v131, v247, s[18:19]
    v_cmp_gt_i32 s[12:13], 56, v7
    v_cmp_gt_i32 s[14:15], 57, v7
    v_cmp_gt_i32 s[16:17], 58, v7
    v_cmp_gt_i32 s[18:19], 59, v7
    v_cndmask_b32 v132, v132, v247, s[12:13]
    v_cndmask_b32 v133, v133, v247, s[14:15]
    v_cndmask_b32 v134, v134, v247, s[16:17]
    v_cndmask_b32 v135, v135, v247, s[18:19]
    v_max3_f32 v234, v120, v121, v122
    v_max3_f32 v234, v234, v123, v124
    v_max3_f32 v234, v234, v125, v126
    v_max3_f32 v234, v234, v127, v128
    v_max3_f32 v234, v234, v129, v130
    v_max3_f32 v234, v234, v131, v132
    v_max3_f32 v234, v234, v133, v134
    v_max_f32 v234, v234, v135
    v_mov_b32 v235, v234
    s_nop 1
    v_permlane32_swap_b32 v234, v235
    s_nop 1
    v_max_f32 v234, v234, v235
    v_max_f32 v234, 0, v234
    v_sub_f32 v235, 0, v234
    v_exp_f32 v235, v235
    v_sub_f32 v136, v136, v234
    v_sub_f32 v137, v137, v234
    v_sub_f32 v138, v138, v234
    v_sub_f32 v139, v139, v234
    v_sub_f32 v140, v140, v234
    v_sub_f32 v141, v141, v234
    v_sub_f32 v142, v142, v234
    v_sub_f32 v143, v143, v234
    v_sub_f32 v144, v144, v234
    v_sub_f32 v145, v145, v234
    v_sub_f32 v146, v146, v234
    v_sub_f32 v147, v147, v234
    v_sub_f32 v148, v148, v234
    v_sub_f32 v149, v149, v234
    v_sub_f32 v150, v150, v234
    v_sub_f32 v151, v151, v234
    v_sub_f32 v104, v104, v234
    v_sub_f32 v105, v105, v234
    v_sub_f32 v106, v106, v234
    v_sub_f32 v107, v107, v234
    v_sub_f32 v108, v108, v234
    v_sub_f32 v109, v109, v234
    v_sub_f32 v110, v110, v234
    v_sub_f32 v111, v111, v234
    v_sub_f32 v112, v112, v234
    v_sub_f32 v113, v113, v234
    v_sub_f32 v114, v114, v234
    v_sub_f32 v115, v115, v234
    v_sub_f32 v116, v116, v234
    v_sub_f32 v117, v117, v234
    v_sub_f32 v118, v118, v234
    v_sub_f32 v119, v119, v234
    v_sub_f32 v120, v120, v234
    v_sub_f32 v121, v121, v234
    v_sub_f32 v122, v122, v234
    v_sub_f32 v123, v123, v234
    v_sub_f32 v124, v124, v234
    v_sub_f32 v125, v125, v234
    v_sub_f32 v126, v126, v234
    v_sub_f32 v127, v127, v234
    v_sub_f32 v128, v128, v234
    v_sub_f32 v129, v129, v234
    v_sub_f32 v130, v130, v234
    v_sub_f32 v131, v131, v234
    v_sub_f32 v132, v132, v234
    v_sub_f32 v133, v133, v234
    v_sub_f32 v134, v134, v234
    v_sub_f32 v135, v135, v234
    v_mul_f32 v168, v168, v235
    v_mul_f32 v169, v169, v235
    v_mul_f32 v170, v170, v235
    v_mul_f32 v171, v171, v235
    v_mul_f32 v172, v172, v235
    v_mul_f32 v173, v173, v235
    v_mul_f32 v174, v174, v235
    v_mul_f32 v175, v175, v235
    v_mul_f32 v176, v176, v235
    v_mul_f32 v177, v177, v235
    v_mul_f32 v178, v178, v235
    v_mul_f32 v179, v179, v235
    v_mul_f32 v180, v180, v235
    v_mul_f32 v181, v181, v235
    v_mul_f32 v182, v182, v235
    v_mul_f32 v183, v183, v235
    v_mul_f32 v184, v184, v235
    v_mul_f32 v185, v185, v235
    v_mul_f32 v186, v186, v235
    v_mul_f32 v187, v187, v235
    v_mul_f32 v188, v188, v235
    v_mul_f32 v189, v189, v235
    v_mul_f32 v190, v190, v235
    v_mul_f32 v191, v191, v235
    v_mul_f32 v192, v192, v235
    v_mul_f32 v193, v193, v235
    v_mul_f32 v194, v194, v235
    v_mul_f32 v195, v195, v235
    v_mul_f32 v196, v196, v235
    v_mul_f32 v197, v197, v235
    v_mul_f32 v198, v198, v235
    v_mul_f32 v199, v199, v235
    v_mul_f32 v200, v200, v235
    v_mul_f32 v201, v201, v235
    v_mul_f32 v202, v202, v235
    v_mul_f32 v203, v203, v235
    v_mul_f32 v204, v204, v235
    v_mul_f32 v205, v205, v235
    v_mul_f32 v206, v206, v235
    v_mul_f32 v207, v207, v235
    v_mul_f32 v208, v208, v235
    v_mul_f32 v209, v209, v235
    v_mul_f32 v210, v210, v235
    v_mul_f32 v211, v211, v235
    v_mul_f32 v212, v212, v235
    v_mul_f32 v213, v213, v235
    v_mul_f32 v214, v214, v235
    v_mul_f32 v215, v215, v235
    v_mul_f32 v216, v216, v235
    v_mul_f32 v217, v217, v235
    v_mul_f32 v218, v218, v235
    v_mul_f32 v219, v219, v235
    v_mul_f32 v220, v220, v235
    v_mul_f32 v221, v221, v235
    v_mul_f32 v222, v222, v235
    v_mul_f32 v223, v223, v235
    v_mul_f32 v224, v224, v235
    v_mul_f32 v225, v225, v235
    v_mul_f32 v226, v226, v235
    v_mul_f32 v227, v227, v235
    v_mul_f32 v228, v228, v235
    v_mul_f32 v229, v229, v235
    v_mul_f32 v230, v230, v235
    v_mul_f32 v231, v231, v235
    v_mul_f32 v244, v244, v235
    v_exp_f32 v120, v120
    v_exp_f32 v121, v121
    v_exp_f32 v122, v122
    v_exp_f32 v123, v123
    v_add_f32 v4, v244, v120
    v_cvt_pk_bf16_f32 v160, v120, v121
    v_exp_f32 v124, v124
    v_exp_f32 v125, v125
    v_add_f32 v4, v4, v122
    v_add_f32 v233, v121, v123
    v_cvt_pk_bf16_f32 v161, v122, v123
    v_exp_f32 v126, v126
    v_exp_f32 v127, v127
    v_add_f32 v4, v4, v124
    v_add_f32 v233, v233, v125
    v_cvt_pk_bf16_f32 v162, v124, v125
    v_exp_f32 v128, v128
    v_exp_f32 v129, v129
    v_add_f32 v4, v4, v126
    v_add_f32 v233, v233, v127
    v_cvt_pk_bf16_f32 v163, v126, v127
    v_exp_f32 v130, v130
    v_exp_f32 v131, v131
    v_add_f32 v4, v4, v128
    v_add_f32 v233, v233, v129
    v_cvt_pk_bf16_f32 v164, v128, v129
    v_exp_f32 v132, v132
    v_exp_f32 v133, v133
    v_add_f32 v4, v4, v130
    v_add_f32 v233, v233, v131
    v_cvt_pk_bf16_f32 v165, v130, v131
    v_exp_f32 v134, v134
    v_exp_f32 v135, v135
    v_add_f32 v4, v4, v132
    v_add_f32 v233, v233, v133
    v_cvt_pk_bf16_f32 v166, v132, v133
    v_add_f32 v4, v4, v134
    v_add_f32 v233, v233, v135
    v_cvt_pk_bf16_f32 v167, v134, v135
    v_add_f32 v4, v4, v233
    s_nop 1
    s_branch back_106
k2_fin_124:
    s_lshl_b32 s58, s54, 2
    s_add_u32 s58, s58, s46
    s_lshl_b32 s58, s58, 18
    s_lshl_b32 s67, s41, 13
    s_add_u32 s58, s58, s67
    s_lshl_b32 s67, s45, 12
    s_add_u32 s58, s58, s67

    s_load_dwordx2 s[54:55], s[0:1], 0
    s_load_dwordx2 s[56:57], s[0:1], 80
    s_and_b32 s44, s41, 7
    s_lshr_b32 s66, s41, 3
    s_cmp_lt_u32 s66, 2
    s_cselect_b32 s43, s42, s65
    s_lshl_b32 s43, s43, 1
    s_and_b32 s66, s66, 1
    s_add_u32 s43, s43, s66
    s_and_b32 s45, s40, 1
    s_lshr_b32 s46, s40, 1
    s_and_b32 s46, s46, 1
    s_lshr_b32 s47, s40, 2
    s_lshl_b32 s66, s43, 1
    s_add_u32 s66, s66, s47
    s_and_b32 s67, s40, 3
    s_lshl_b32 s67, s67, 11
    s_lshl_b32 s50, s66, 18
    s_add_u32 s50, s50, s67
    s_mul_i32 s48, s66, 114688
    s_add_u32 s48, s48, s67
    s_lshl_b32 s51, s40, 14
    s_lshl_b32 s66, s44, 11
    s_add_u32 s51, s51, s66
    s_add_u32 s49, s51, 4194304
    s_lshl_b32 s52, s40, 11
    s_lshl_b32 s66, s45, 13
    s_lshl_b32 s67, s47, 10
    s_add_u32 s66, s66, s67
    v_add_u32 v4, s66, v1
    s_lshl_b32 s66, s47, 11
    s_lshl_b32 s67, s46, 10
    s_add_u32 s66, s66, s67
    s_add_u32 s66, s66, 16384
    v_add_u32 v5, s66, v1

    s_add_u32 s16, s4, 0x7000000
    s_addc_u32 s17, s5, 0
    s_mov_b32 s18, 0x5c0000
    s_mov_b32 s19, 0x00020000
    s_add_u32 s20, s4, 0x7800000
    s_addc_u32 s21, s5, 0
    s_mov_b32 s22, 0x8000
    s_mov_b32 s23, 0x00020000
    v_add_u32 v10, 65536, v4
    v_add_u32 v12, 65536, v5
    v_add_u32 v11, 131072, v4
    v_add_u32 v13, 131072, v5
    v_mov_b64 v[64:65], 0
    v_mov_b64 v[66:67], 0
    v_mov_b64 v[68:69], 0
    v_mov_b64 v[70:71], 0
    v_mov_b64 v[72:73], 0
    v_mov_b64 v[74:75], 0
    v_mov_b64 v[76:77], 0
    v_mov_b64 v[78:79], 0
    v_mov_b64 v[80:81], 0
    v_mov_b64 v[82:83], 0
    v_mov_b64 v[84:85], 0
    v_mov_b64 v[86:87], 0
    v_mov_b64 v[88:89], 0
    v_mov_b64 v[90:91], 0
    v_mov_b64 v[92:93], 0
    v_mov_b64 v[94:95], 0
    s_waitcnt lgkmcnt(0)
    s_mov_b32 s8, s54
    s_mov_b32 s9, s55
    s_mov_b32 s10, 0x200000
    s_mov_b32 s11, 0x00020000
    s_mov_b32 s12, s56
    s_mov_b32 s13, s57
    s_mov_b32 s14, 0x200000
    s_mov_b32 s15, 0x00020000
    s_add_u32 m0, s52, 0
    s_nop 0
    buffer_load_dwordx4 v1, s[32:35], s48 offen lds
    buffer_load_dwordx4 v1, s[32:35], s48 offen offset:1024 lds
    s_add_u32 m0, s52, 16384
    s_add_u32 s48, s48, 8192
    buffer_load_dwordx4 v1, s[16:19], s49 offen lds
    buffer_load_dwordx4 v1, s[16:19], s49 offen offset:1024 lds
    s_add_u32 s49, s49, 131072
    s_add_u32 m0, s52, 32768
    s_nop 0
    buffer_load_dwordx4 v1, s[32:35], s48 offen lds
    buffer_load_dwordx4 v1, s[32:35], s48 offen offset:1024 lds
    s_add_u32 m0, s52, 49152
    s_add_u32 s48, s48, 8192
    buffer_load_dwordx4 v1, s[16:19], s49 offen lds
    buffer_load_dwordx4 v1, s[16:19], s49 offen offset:1024 lds
    s_add_u32 s49, s49, 131072
    s_add_u32 m0, s52, 65536
    s_nop 0
    buffer_load_dwordx4 v1, s[32:35], s48 offen lds
    buffer_load_dwordx4 v1, s[32:35], s48 offen offset:1024 lds
    s_add_u32 m0, s52, 81920
    s_add_u32 s48, s48, 8192
    buffer_load_dwordx4 v1, s[16:19], s49 offen lds
    buffer_load_dwordx4 v1, s[16:19], s49 offen offset:1024 lds
    s_add_u32 s49, s49, 131072
    s_add_u32 m0, s52, 98304
    s_nop 0
    buffer_load_dwordx4 v1, s[32:35], s48 offen lds
    buffer_load_dwordx4 v1, s[32:35], s48 offen offset:1024 lds
    s_add_u32 m0, s52, 114688
    s_add_u32 s48, s48, 8192
    buffer_load_dwordx4 v1, s[16:19], s49 offen lds
    buffer_load_dwordx4 v1, s[16:19], s49 offen offset:1024 lds
    s_add_u32 s49, s49, 131072
    buffer_store_dwordx4 v[104:107], v1, s[36:39], s58 offen offset:0 sc0 sc1
    buffer_store_dwordx4 v[108:111], v1, s[36:39], s58 offen offset:1024 sc0 sc1
    buffer_store_dwordx4 v[112:115], v1, s[36:39], s58 offen offset:2048 sc0 sc1
    buffer_store_dwordx4 v[116:119], v1, s[36:39], s58 offen offset:3072 sc0 sc1
    v_and_b32 v98, 31, v0
    v_lshlrev_b32 v98, 10, v98
    v_lshrrev_b32 v99, 5, v0
    v_lshlrev_b32 v99, 3, v99
    v_add_u32 v98, v98, v99
    s_lshl_b32 s58, s43, 16
    s_lshl_b32 s67, s45, 15
    s_add_u32 s58, s58, s67
    s_lshl_b32 s67, s44, 7
    s_add_u32 s58, s58, s67
    s_lshl_b32 s67, s46, 6
    s_add_u32 s58, s58, s67
    s_lshl_b32 s67, s47, 5
    s_add_u32 s58, s58, s67
    buffer_load_dwordx2 v[100:101], v98, s[8:11], s58 offen
    buffer_load_dwordx2 v[102:103], v98, s[8:11], s58 offen offset:16

    s_waitcnt vmcnt(14)
    s_barrier
    ds_read_b128 v[16:19], v5 offset:0
    ds_read_b128 v[20:23], v4 offset:0
    ds_read_b128 v[24:27], v5 offset:4096
    ds_read_b128 v[28:31], v4 offset:2048
    ds_read_b128 v[32:35], v5 offset:8192
    ds_read_b128 v[36:39], v4 offset:4096
    s_waitcnt lgkmcnt(4)
    v_mfma_f32_32x32x16_bf16 v[80:95], v[16:19], v[20:23], v[80:95]
    s_add_u32 m0, s52, 131072
    s_nop 0
    buffer_load_dwordx4 v1, s[32:35], s48 offen lds
    ds_read_b128 v[40:43], v5 offset:12288
    ds_read_b128 v[44:47], v4 offset:6144
    s_waitcnt lgkmcnt(4)
    v_mfma_f32_32x32x16_bf16 v[80:95], v[24:27], v[28:31], v[80:95]
    buffer_load_dwordx4 v1, s[32:35], s48 offen offset:1024 lds
    ds_read_b128 v[16:19], v5 offset:32768
    ds_read_b128 v[20:23], v4 offset:32768
    s_waitcnt lgkmcnt(4)
    v_mfma_f32_32x32x16_bf16 v[80:95], v[32:35], v[36:39], v[80:95]
    s_add_u32 m0, s52, 147456
    s_add_u32 s48, s48, 8192
    buffer_load_dwordx4 v1, s[16:19], s49 offen lds
    ds_read_b128 v[24:27], v5 offset:36864
    ds_read_b128 v[28:31], v4 offset:34816
    s_waitcnt lgkmcnt(4)
    v_mfma_f32_32x32x16_bf16 v[80:95], v[40:43], v[44:47], v[80:95]
    buffer_load_dwordx4 v1, s[16:19], s49 offen offset:1024 lds
    s_add_u32 s49, s49, 131072
    s_waitcnt vmcnt(14)
    s_barrier
    ds_read_b128 v[32:35], v5 offset:40960
    ds_read_b128 v[36:39], v4 offset:36864
    s_waitcnt lgkmcnt(4)
    v_mfma_f32_32x32x16_bf16 v[80:95], v[16:19], v[20:23], v[80:95]
    s_add_u32 m0, s52, 0
    s_nop 0
    buffer_load_dwordx4 v1, s[32:35], s48 offen lds
    ds_read_b128 v[40:43], v5 offset:45056
    ds_read_b128 v[44:47], v4 offset:38912
    s_waitcnt lgkmcnt(4)
    v_mfma_f32_32x32x16_bf16 v[80:95], v[24:27], v[28:31], v[80:95]
    buffer_load_dwordx4 v1, s[32:35], s48 offen offset:1024 lds
    ds_read_b128 v[16:19], v12 offset:0
    ds_read_b128 v[20:23], v10 offset:0
    s_waitcnt lgkmcnt(4)
    v_mfma_f32_32x32x16_bf16 v[80:95], v[32:35], v[36:39], v[80:95]
    s_add_u32 m0, s52, 16384
    s_add_u32 s48, s48, 8192
    buffer_load_dwordx4 v1, s[16:19], s49 offen lds
    ds_read_b128 v[24:27], v12 offset:4096
    ds_read_b128 v[28:31], v10 offset:2048
    s_waitcnt lgkmcnt(4)
    v_mfma_f32_32x32x16_bf16 v[80:95], v[40:43], v[44:47], v[80:95]
    buffer_load_dwordx4 v1, s[16:19], s49 offen offset:1024 lds
    s_add_u32 s49, s49, 131072
    s_waitcnt vmcnt(14)
    s_barrier
    ds_read_b128 v[32:35], v12 offset:8192
    ds_read_b128 v[36:39], v10 offset:4096
    s_waitcnt lgkmcnt(4)
    v_mfma_f32_32x32x16_bf16 v[80:95], v[16:19], v[20:23], v[80:95]
    s_add_u32 m0, s52, 32768
    s_nop 0
    buffer_load_dwordx4 v1, s[32:35], s48 offen lds
    ds_read_b128 v[40:43], v12 offset:12288
    ds_read_b128 v[44:47], v10 offset:6144
    s_waitcnt lgkmcnt(4)
    v_mfma_f32_32x32x16_bf16 v[80:95], v[24:27], v[28:31], v[80:95]
    buffer_load_dwordx4 v1, s[32:35], s48 offen offset:1024 lds
    ds_read_b128 v[16:19], v12 offset:32768
    ds_read_b128 v[20:23], v10 offset:32768
    s_waitcnt lgkmcnt(4)
    v_mfma_f32_32x32x16_bf16 v[80:95], v[32:35], v[36:39], v[80:95]
    s_add_u32 m0, s52, 49152
    s_add_u32 s48, s48, 8192
    buffer_load_dwordx4 v1, s[16:19], s49 offen lds
    ds_read_b128 v[24:27], v12 offset:36864
    ds_read_b128 v[28:31], v10 offset:34816
    s_waitcnt lgkmcnt(4)
    v_mfma_f32_32x32x16_bf16 v[80:95], v[40:43], v[44:47], v[80:95]
    buffer_load_dwordx4 v1, s[16:19], s49 offen offset:1024 lds
    s_add_u32 s49, s49, 131072
    s_waitcnt vmcnt(8)
    s_barrier
    s_cmp_lg_u32 s40, 0
    s_cbranch_scc1 p4_nd_125
    v_mov_b32 v8, 1
    v_mov_b32 v9, 0
    s_lshl_b32 s66, s2, 7
    s_mov_b64 exec, 1
    buffer_store_dword v8, v9, s[20:23], s66 offen sc0 sc1
    s_mov_b64 exec, -1

p4_nd_125:
    ds_read_b128 v[32:35], v12 offset:40960
    ds_read_b128 v[36:39], v10 offset:36864
    s_waitcnt lgkmcnt(4)
    v_mfma_f32_32x32x16_bf16 v[80:95], v[16:19], v[20:23], v[80:95]
    s_add_u32 m0, s52, 65536
    s_nop 0
    buffer_load_dwordx4 v1, s[32:35], s48 offen lds
    ds_read_b128 v[40:43], v12 offset:45056
    ds_read_b128 v[44:47], v10 offset:38912
    s_waitcnt lgkmcnt(4)
    v_mfma_f32_32x32x16_bf16 v[80:95], v[24:27], v[28:31], v[80:95]
    buffer_load_dwordx4 v1, s[32:35], s48 offen offset:1024 lds
    ds_read_b128 v[16:19], v13 offset:0
    ds_read_b128 v[20:23], v11 offset:0
    s_waitcnt lgkmcnt(4)
    v_mfma_f32_32x32x16_bf16 v[80:95], v[32:35], v[36:39], v[80:95]
    s_add_u32 m0, s52, 81920
    s_add_u32 s48, s48, 8192
    buffer_load_dwordx4 v1, s[16:19], s49 offen lds
    ds_read_b128 v[24:27], v13 offset:4096
    ds_read_b128 v[28:31], v11 offset:2048
    s_waitcnt lgkmcnt(4)
    v_mfma_f32_32x32x16_bf16 v[80:95], v[40:43], v[44:47], v[80:95]
    buffer_load_dwordx4 v1, s[16:19], s49 offen offset:1024 lds
    s_add_u32 s49, s49, 131072
    s_waitcnt vmcnt(8)
    s_barrier
    ds_read_b128 v[32:35], v13 offset:8192
    ds_read_b128 v[36:39], v11 offset:4096
    s_waitcnt lgkmcnt(4)
    v_mfma_f32_32x32x16_bf16 v[80:95], v[16:19], v[20:23], v[80:95]
    s_add_u32 m0, s52, 98304
    s_nop 0
    buffer_load_dwordx4 v1, s[32:35], s48 offen lds
    ds_read_b128 v[40:43], v13 offset:12288
    ds_read_b128 v[44:47], v11 offset:6144
    s_waitcnt lgkmcnt(4)
    v_mfma_f32_32x32x16_bf16 v[80:95], v[24:27], v[28:31], v[80:95]
    buffer_load_dwordx4 v1, s[32:35], s48 offen offset:1024 lds
    ds_read_b128 v[16:19], v5 offset:0
    ds_read_b128 v[20:23], v4 offset:0
    s_waitcnt lgkmcnt(4)
    v_mfma_f32_32x32x16_bf16 v[80:95], v[32:35], v[36:39], v[80:95]
    s_add_u32 m0, s52, 114688
    s_add_u32 s48, s48, 8192
    buffer_load_dwordx4 v1, s[16:19], s49 offen lds
    ds_read_b128 v[24:27], v5 offset:4096
    ds_read_b128 v[28:31], v4 offset:2048
    s_waitcnt lgkmcnt(4)
    v_mfma_f32_32x32x16_bf16 v[80:95], v[40:43], v[44:47], v[80:95]
    buffer_load_dwordx4 v1, s[16:19], s49 offen offset:1024 lds
    s_add_u32 s49, s49, 131072
    s_waitcnt vmcnt(8)
    s_barrier
    ds_read_b128 v[32:35], v5 offset:8192
    ds_read_b128 v[36:39], v4 offset:4096
    s_waitcnt lgkmcnt(4)
    v_mfma_f32_32x32x16_bf16 v[80:95], v[16:19], v[20:23], v[80:95]
    s_add_u32 m0, s52, 131072
    s_nop 0
    buffer_load_dwordx4 v1, s[32:35], s48 offen lds
    ds_read_b128 v[40:43], v5 offset:12288
    ds_read_b128 v[44:47], v4 offset:6144
    s_waitcnt lgkmcnt(4)
    v_mfma_f32_32x32x16_bf16 v[80:95], v[24:27], v[28:31], v[80:95]
    buffer_load_dwordx4 v1, s[32:35], s48 offen offset:1024 lds
    ds_read_b128 v[16:19], v5 offset:32768
    ds_read_b128 v[20:23], v4 offset:32768
    s_waitcnt lgkmcnt(4)
    v_mfma_f32_32x32x16_bf16 v[80:95], v[32:35], v[36:39], v[80:95]
    s_add_u32 m0, s52, 147456
    s_add_u32 s48, s48, 8192
    buffer_load_dwordx4 v1, s[16:19], s49 offen lds
    ds_read_b128 v[24:27], v5 offset:36864
    ds_read_b128 v[28:31], v4 offset:34816
    s_waitcnt lgkmcnt(4)
    v_mfma_f32_32x32x16_bf16 v[80:95], v[40:43], v[44:47], v[80:95]
    buffer_load_dwordx4 v1, s[16:19], s49 offen offset:1024 lds
    s_add_u32 s49, s49, 131072
    s_waitcnt vmcnt(8)
    s_barrier
    ds_read_b128 v[32:35], v5 offset:40960
    ds_read_b128 v[36:39], v4 offset:36864
    s_waitcnt lgkmcnt(4)
    v_mfma_f32_32x32x16_bf16 v[80:95], v[16:19], v[20:23], v[80:95]
    s_add_u32 m0, s52, 0
    s_nop 0
    buffer_load_dwordx4 v1, s[32:35], s48 offen lds
    ds_read_b128 v[40:43], v5 offset:45056
    ds_read_b128 v[44:47], v4 offset:38912
    s_waitcnt lgkmcnt(4)
    v_mfma_f32_32x32x16_bf16 v[80:95], v[24:27], v[28:31], v[80:95]
    buffer_load_dwordx4 v1, s[32:35], s48 offen offset:1024 lds
    ds_read_b128 v[16:19], v12 offset:0
    ds_read_b128 v[20:23], v10 offset:0
    s_waitcnt lgkmcnt(4)
    v_mfma_f32_32x32x16_bf16 v[80:95], v[32:35], v[36:39], v[80:95]
    s_add_u32 m0, s52, 16384
    s_add_u32 s48, s48, 8192
    buffer_load_dwordx4 v1, s[16:19], s49 offen lds
    ds_read_b128 v[24:27], v12 offset:4096
    ds_read_b128 v[28:31], v10 offset:2048
    s_waitcnt lgkmcnt(4)
    v_mfma_f32_32x32x16_bf16 v[80:95], v[40:43], v[44:47], v[80:95]
    buffer_load_dwordx4 v1, s[16:19], s49 offen offset:1024 lds
    s_add_u32 s49, s49, 131072
    s_waitcnt vmcnt(8)
    s_barrier
    ds_read_b128 v[32:35], v12 offset:8192
    ds_read_b128 v[36:39], v10 offset:4096
    s_waitcnt lgkmcnt(4)
    v_mfma_f32_32x32x16_bf16 v[80:95], v[16:19], v[20:23], v[80:95]
    s_add_u32 m0, s52, 32768
    s_nop 0
    buffer_load_dwordx4 v1, s[32:35], s48 offen lds
    ds_read_b128 v[40:43], v12 offset:12288
    ds_read_b128 v[44:47], v10 offset:6144
    s_waitcnt lgkmcnt(4)
    v_mfma_f32_32x32x16_bf16 v[80:95], v[24:27], v[28:31], v[80:95]
    buffer_load_dwordx4 v1, s[32:35], s48 offen offset:1024 lds
    ds_read_b128 v[16:19], v12 offset:32768
    ds_read_b128 v[20:23], v10 offset:32768
    s_waitcnt lgkmcnt(4)
    v_mfma_f32_32x32x16_bf16 v[80:95], v[32:35], v[36:39], v[80:95]
    s_add_u32 m0, s52, 49152
    s_add_u32 s48, s48, 8192
    buffer_load_dwordx4 v1, s[16:19], s49 offen lds
    ds_read_b128 v[24:27], v12 offset:36864
    ds_read_b128 v[28:31], v10 offset:34816
    s_waitcnt lgkmcnt(4)
    v_mfma_f32_32x32x16_bf16 v[80:95], v[40:43], v[44:47], v[80:95]
    buffer_load_dwordx4 v1, s[16:19], s49 offen offset:1024 lds
    s_add_u32 s49, s49, 131072
    s_waitcnt vmcnt(8)
    s_barrier
    ds_read_b128 v[32:35], v12 offset:40960
    ds_read_b128 v[36:39], v10 offset:36864
    s_waitcnt lgkmcnt(4)
    v_mfma_f32_32x32x16_bf16 v[80:95], v[16:19], v[20:23], v[80:95]
    s_add_u32 m0, s52, 65536
    s_nop 0
    buffer_load_dwordx4 v1, s[32:35], s48 offen lds
    ds_read_b128 v[40:43], v12 offset:45056
    ds_read_b128 v[44:47], v10 offset:38912
    s_waitcnt lgkmcnt(4)
    v_mfma_f32_32x32x16_bf16 v[80:95], v[24:27], v[28:31], v[80:95]
    buffer_load_dwordx4 v1, s[32:35], s48 offen offset:1024 lds
    ds_read_b128 v[16:19], v13 offset:0
    ds_read_b128 v[20:23], v11 offset:0
    s_waitcnt lgkmcnt(4)
    v_mfma_f32_32x32x16_bf16 v[80:95], v[32:35], v[36:39], v[80:95]
    s_add_u32 m0, s52, 81920
    s_add_u32 s48, s48, 8192
    buffer_load_dwordx4 v1, s[16:19], s49 offen lds
    ds_read_b128 v[24:27], v13 offset:4096
    ds_read_b128 v[28:31], v11 offset:2048
    s_waitcnt lgkmcnt(4)
    v_mfma_f32_32x32x16_bf16 v[80:95], v[40:43], v[44:47], v[80:95]
    buffer_load_dwordx4 v1, s[16:19], s49 offen offset:1024 lds
    s_add_u32 s49, s49, 131072
    s_waitcnt vmcnt(8)
    s_barrier
    ds_read_b128 v[32:35], v13 offset:8192
    ds_read_b128 v[36:39], v11 offset:4096
    s_waitcnt lgkmcnt(4)
    v_mfma_f32_32x32x16_bf16 v[80:95], v[16:19], v[20:23], v[80:95]
    s_add_u32 m0, s52, 98304
    s_nop 0
    buffer_load_dwordx4 v1, s[32:35], s48 offen lds
    ds_read_b128 v[40:43], v13 offset:12288
    ds_read_b128 v[44:47], v11 offset:6144
    s_waitcnt lgkmcnt(4)
    v_mfma_f32_32x32x16_bf16 v[80:95], v[24:27], v[28:31], v[80:95]
    buffer_load_dwordx4 v1, s[32:35], s48 offen offset:1024 lds
    ds_read_b128 v[16:19], v5 offset:0
    ds_read_b128 v[20:23], v4 offset:0
    s_waitcnt lgkmcnt(4)
    v_mfma_f32_32x32x16_bf16 v[80:95], v[32:35], v[36:39], v[80:95]
    s_add_u32 m0, s52, 114688
    s_add_u32 s48, s48, 8192
    buffer_load_dwordx4 v1, s[16:19], s49 offen lds
    ds_read_b128 v[24:27], v5 offset:4096
    ds_read_b128 v[28:31], v4 offset:2048
    s_waitcnt lgkmcnt(4)
    v_mfma_f32_32x32x16_bf16 v[80:95], v[40:43], v[44:47], v[80:95]
    buffer_load_dwordx4 v1, s[16:19], s49 offen offset:1024 lds
    s_add_u32 s49, s49, 131072
    s_mov_b32 s48, s50
    s_mov_b32 s49, s51
    s_cmp_lg_u32 s40, 0
    s_cbranch_scc1 p4_ok_126
    s_cmp_ge_u32 s41, 16
    s_cbranch_scc1 p4_ok_126
    v_lshlrev_b32 v9, 7, v0
    s_lshl_b32 s66, s42, 12
    s_mov_b32 s73, 0

p4_spin_127:
    s_mov_b64 exec, 0xffffffff
    buffer_load_dword v8, v9, s[20:23], s66 offen sc1
    s_waitcnt vmcnt(0)
    v_cmp_eq_u32 vcc, 1, v8
    s_mov_b64 exec, -1
    s_cmp_eq_u32 vcc_lo, -1
    s_cbranch_scc1 p4_ok_126
    s_add_u32 s73, s73, 1
    s_cmp_ge_u32 s73, 262144
    s_cbranch_scc1 p4_ok_126
    s_sleep 4
    s_branch p4_spin_127

p4_ok_126:
    s_waitcnt vmcnt(8)
    s_barrier
    ds_read_b128 v[32:35], v5 offset:8192
    ds_read_b128 v[36:39], v4 offset:4096
    s_waitcnt lgkmcnt(4)
    v_mfma_f32_32x32x16_bf16 v[80:95], v[16:19], v[20:23], v[80:95]
    s_add_u32 m0, s52, 131072
    s_nop 0
    buffer_load_dwordx4 v1, s[36:39], s48 offen lds
    ds_read_b128 v[40:43], v5 offset:12288
    ds_read_b128 v[44:47], v4 offset:6144
    s_waitcnt lgkmcnt(4)
    v_mfma_f32_32x32x16_bf16 v[80:95], v[24:27], v[28:31], v[80:95]
    buffer_load_dwordx4 v1, s[36:39], s48 offen offset:1024 lds
    ds_read_b128 v[16:19], v5 offset:32768
    ds_read_b128 v[20:23], v4 offset:32768
    s_waitcnt lgkmcnt(4)
    v_mfma_f32_32x32x16_bf16 v[80:95], v[32:35], v[36:39], v[80:95]
    s_add_u32 m0, s52, 147456
    s_add_u32 s48, s48, 8192
    buffer_load_dwordx4 v1, s[16:19], s49 offen lds
    ds_read_b128 v[24:27], v5 offset:36864
    ds_read_b128 v[28:31], v4 offset:34816
    s_waitcnt lgkmcnt(4)
    v_mfma_f32_32x32x16_bf16 v[80:95], v[40:43], v[44:47], v[80:95]
    buffer_load_dwordx4 v1, s[16:19], s49 offen offset:1024 lds
    s_add_u32 s49, s49, 131072
    s_waitcnt vmcnt(8)
    s_barrier
    ds_read_b128 v[32:35], v5 offset:40960
    ds_read_b128 v[36:39], v4 offset:36864
    s_waitcnt lgkmcnt(4)
    v_mfma_f32_32x32x16_bf16 v[80:95], v[16:19], v[20:23], v[80:95]
    s_add_u32 m0, s52, 0
    s_nop 0
    buffer_load_dwordx4 v1, s[36:39], s48 offen lds
    ds_read_b128 v[40:43], v5 offset:45056
    ds_read_b128 v[44:47], v4 offset:38912
    s_waitcnt lgkmcnt(4)
    v_mfma_f32_32x32x16_bf16 v[80:95], v[24:27], v[28:31], v[80:95]
    buffer_load_dwordx4 v1, s[36:39], s48 offen offset:1024 lds
    ds_read_b128 v[16:19], v12 offset:0
    ds_read_b128 v[20:23], v10 offset:0
    s_waitcnt lgkmcnt(4)
    v_mfma_f32_32x32x16_bf16 v[80:95], v[32:35], v[36:39], v[80:95]
    s_add_u32 m0, s52, 16384
    s_add_u32 s48, s48, 8192
    buffer_load_dwordx4 v1, s[16:19], s49 offen lds
    ds_read_b128 v[24:27], v12 offset:4096
    ds_read_b128 v[28:31], v10 offset:2048
    s_waitcnt lgkmcnt(4)
    v_mfma_f32_32x32x16_bf16 v[80:95], v[40:43], v[44:47], v[80:95]
    buffer_load_dwordx4 v1, s[16:19], s49 offen offset:1024 lds
    s_add_u32 s49, s49, 131072
    s_waitcnt vmcnt(8)
    s_barrier
    ds_read_b128 v[32:35], v12 offset:8192
    ds_read_b128 v[36:39], v10 offset:4096
    s_waitcnt lgkmcnt(4)
    v_mfma_f32_32x32x16_bf16 v[80:95], v[16:19], v[20:23], v[80:95]
    s_add_u32 m0, s52, 32768
    s_nop 0
    buffer_load_dwordx4 v1, s[36:39], s48 offen lds
    ds_read_b128 v[40:43], v12 offset:12288
    ds_read_b128 v[44:47], v10 offset:6144
    s_waitcnt lgkmcnt(4)
    v_mfma_f32_32x32x16_bf16 v[80:95], v[24:27], v[28:31], v[80:95]
    buffer_load_dwordx4 v1, s[36:39], s48 offen offset:1024 lds
    ds_read_b128 v[16:19], v12 offset:32768
    ds_read_b128 v[20:23], v10 offset:32768
    s_waitcnt lgkmcnt(4)
    v_mfma_f32_32x32x16_bf16 v[80:95], v[32:35], v[36:39], v[80:95]
    s_add_u32 m0, s52, 49152
    s_add_u32 s48, s48, 8192
    buffer_load_dwordx4 v1, s[16:19], s49 offen lds
    ds_read_b128 v[24:27], v12 offset:36864
    ds_read_b128 v[28:31], v10 offset:34816
    s_waitcnt lgkmcnt(4)
    v_mfma_f32_32x32x16_bf16 v[80:95], v[40:43], v[44:47], v[80:95]
    buffer_load_dwordx4 v1, s[16:19], s49 offen offset:1024 lds
    s_add_u32 s49, s49, 131072
    s_waitcnt vmcnt(8)
    s_barrier
    ds_read_b128 v[32:35], v12 offset:40960
    ds_read_b128 v[36:39], v10 offset:36864
    s_waitcnt lgkmcnt(4)
    v_mfma_f32_32x32x16_bf16 v[80:95], v[16:19], v[20:23], v[80:95]
    s_add_u32 m0, s52, 65536
    s_nop 0
    buffer_load_dwordx4 v1, s[36:39], s48 offen lds
    ds_read_b128 v[40:43], v12 offset:45056
    ds_read_b128 v[44:47], v10 offset:38912
    s_waitcnt lgkmcnt(4)
    v_mfma_f32_32x32x16_bf16 v[80:95], v[24:27], v[28:31], v[80:95]
    buffer_load_dwordx4 v1, s[36:39], s48 offen offset:1024 lds
    ds_read_b128 v[16:19], v13 offset:0
    ds_read_b128 v[20:23], v11 offset:0
    s_waitcnt lgkmcnt(4)
    v_mfma_f32_32x32x16_bf16 v[80:95], v[32:35], v[36:39], v[80:95]
    s_add_u32 m0, s52, 81920
    s_add_u32 s48, s48, 8192
    buffer_load_dwordx4 v1, s[16:19], s49 offen lds
    ds_read_b128 v[24:27], v13 offset:4096
    ds_read_b128 v[28:31], v11 offset:2048
    s_waitcnt lgkmcnt(4)
    v_mfma_f32_32x32x16_bf16 v[80:95], v[40:43], v[44:47], v[80:95]
    buffer_load_dwordx4 v1, s[16:19], s49 offen offset:1024 lds
    s_add_u32 s49, s49, 131072
    s_mov_b32 s53, 0
.p2align 6
p4_loop_128:
    s_waitcnt vmcnt(8)
    s_barrier
    ds_read_b128 v[32:35], v13 offset:8192
    ds_read_b128 v[36:39], v11 offset:4096
    s_waitcnt lgkmcnt(4)
    v_mfma_f32_32x32x16_bf16 v[64:79], v[16:19], v[20:23], v[64:79]
    s_add_u32 m0, s52, 98304
    s_nop 0
    buffer_load_dwordx4 v1, s[36:39], s48 offen lds
    ds_read_b128 v[40:43], v13 offset:12288
    ds_read_b128 v[44:47], v11 offset:6144
    s_waitcnt lgkmcnt(4)
    v_mfma_f32_32x32x16_bf16 v[64:79], v[24:27], v[28:31], v[64:79]
    buffer_load_dwordx4 v1, s[36:39], s48 offen offset:1024 lds
    ds_read_b128 v[16:19], v5 offset:0
    ds_read_b128 v[20:23], v4 offset:0
    s_waitcnt lgkmcnt(4)
    v_mfma_f32_32x32x16_bf16 v[64:79], v[32:35], v[36:39], v[64:79]
    s_add_u32 m0, s52, 114688
    s_add_u32 s48, s48, 8192
    buffer_load_dwordx4 v1, s[16:19], s49 offen lds
    ds_read_b128 v[24:27], v5 offset:4096
    ds_read_b128 v[28:31], v4 offset:2048
    s_waitcnt lgkmcnt(4)
    v_mfma_f32_32x32x16_bf16 v[64:79], v[40:43], v[44:47], v[64:79]
    buffer_load_dwordx4 v1, s[16:19], s49 offen offset:1024 lds
    s_add_u32 s49, s49, 131072
    s_waitcnt vmcnt(8)
    s_barrier
    ds_read_b128 v[32:35], v5 offset:8192
    ds_read_b128 v[36:39], v4 offset:4096
    s_waitcnt lgkmcnt(4)
    v_mfma_f32_32x32x16_bf16 v[64:79], v[16:19], v[20:23], v[64:79]
    s_add_u32 m0, s52, 131072
    s_nop 0
    buffer_load_dwordx4 v1, s[36:39], s48 offen lds
    ds_read_b128 v[40:43], v5 offset:12288
    ds_read_b128 v[44:47], v4 offset:6144
    s_waitcnt lgkmcnt(4)
    v_mfma_f32_32x32x16_bf16 v[64:79], v[24:27], v[28:31], v[64:79]
    buffer_load_dwordx4 v1, s[36:39], s48 offen offset:1024 lds
    ds_read_b128 v[16:19], v5 offset:32768
    ds_read_b128 v[20:23], v4 offset:32768
    s_waitcnt lgkmcnt(4)
    v_mfma_f32_32x32x16_bf16 v[64:79], v[32:35], v[36:39], v[64:79]
    s_add_u32 m0, s52, 147456
    s_add_u32 s48, s48, 8192
    buffer_load_dwordx4 v1, s[16:19], s49 offen lds
    ds_read_b128 v[24:27], v5 offset:36864
    ds_read_b128 v[28:31], v4 offset:34816
    s_waitcnt lgkmcnt(4)
    v_mfma_f32_32x32x16_bf16 v[64:79], v[40:43], v[44:47], v[64:79]
    buffer_load_dwordx4 v1, s[16:19], s49 offen offset:1024 lds
    s_add_u32 s49, s49, 131072
    s_waitcnt vmcnt(8)
    s_barrier
    ds_read_b128 v[32:35], v5 offset:40960
    ds_read_b128 v[36:39], v4 offset:36864
    s_waitcnt lgkmcnt(4)
    v_mfma_f32_32x32x16_bf16 v[64:79], v[16:19], v[20:23], v[64:79]
    s_add_u32 m0, s52, 0
    s_nop 0
    buffer_load_dwordx4 v1, s[36:39], s48 offen lds
    ds_read_b128 v[40:43], v5 offset:45056
    ds_read_b128 v[44:47], v4 offset:38912
    s_waitcnt lgkmcnt(4)
    v_mfma_f32_32x32x16_bf16 v[64:79], v[24:27], v[28:31], v[64:79]
    buffer_load_dwordx4 v1, s[36:39], s48 offen offset:1024 lds
    ds_read_b128 v[16:19], v12 offset:0
    ds_read_b128 v[20:23], v10 offset:0
    s_waitcnt lgkmcnt(4)
    v_mfma_f32_32x32x16_bf16 v[64:79], v[32:35], v[36:39], v[64:79]
    s_add_u32 m0, s52, 16384
    s_add_u32 s48, s48, 8192
    buffer_load_dwordx4 v1, s[16:19], s49 offen lds
    ds_read_b128 v[24:27], v12 offset:4096
    ds_read_b128 v[28:31], v10 offset:2048
    s_waitcnt lgkmcnt(4)
    v_mfma_f32_32x32x16_bf16 v[64:79], v[40:43], v[44:47], v[64:79]
    buffer_load_dwordx4 v1, s[16:19], s49 offen offset:1024 lds
    s_add_u32 s49, s49, 131072
    s_waitcnt vmcnt(8)
    s_barrier
    ds_read_b128 v[32:35], v12 offset:8192
    ds_read_b128 v[36:39], v10 offset:4096
    s_waitcnt lgkmcnt(4)
    v_mfma_f32_32x32x16_bf16 v[64:79], v[16:19], v[20:23], v[64:79]
    s_add_u32 m0, s52, 32768
    s_nop 0
    buffer_load_dwordx4 v1, s[36:39], s48 offen lds
    ds_read_b128 v[40:43], v12 offset:12288
    ds_read_b128 v[44:47], v10 offset:6144
    s_waitcnt lgkmcnt(4)
    v_mfma_f32_32x32x16_bf16 v[64:79], v[24:27], v[28:31], v[64:79]
    buffer_load_dwordx4 v1, s[36:39], s48 offen offset:1024 lds
    ds_read_b128 v[16:19], v12 offset:32768
    ds_read_b128 v[20:23], v10 offset:32768
    s_waitcnt lgkmcnt(4)
    v_mfma_f32_32x32x16_bf16 v[64:79], v[32:35], v[36:39], v[64:79]
    s_add_u32 m0, s52, 49152
    s_add_u32 s48, s48, 8192
    buffer_load_dwordx4 v1, s[16:19], s49 offen lds
    ds_read_b128 v[24:27], v12 offset:36864
    ds_read_b128 v[28:31], v10 offset:34816
    s_waitcnt lgkmcnt(4)
    v_mfma_f32_32x32x16_bf16 v[64:79], v[40:43], v[44:47], v[64:79]
    buffer_load_dwordx4 v1, s[16:19], s49 offen offset:1024 lds
    s_add_u32 s49, s49, 131072
    s_waitcnt vmcnt(8)
    s_barrier
    ds_read_b128 v[32:35], v12 offset:40960
    ds_read_b128 v[36:39], v10 offset:36864
    s_waitcnt lgkmcnt(4)
    v_mfma_f32_32x32x16_bf16 v[64:79], v[16:19], v[20:23], v[64:79]
    s_add_u32 m0, s52, 65536
    s_nop 0
    buffer_load_dwordx4 v1, s[36:39], s48 offen lds
    ds_read_b128 v[40:43], v12 offset:45056
    ds_read_b128 v[44:47], v10 offset:38912
    s_waitcnt lgkmcnt(4)
    v_mfma_f32_32x32x16_bf16 v[64:79], v[24:27], v[28:31], v[64:79]
    buffer_load_dwordx4 v1, s[36:39], s48 offen offset:1024 lds
    ds_read_b128 v[16:19], v13 offset:0
    ds_read_b128 v[20:23], v11 offset:0
    s_waitcnt lgkmcnt(4)
    v_mfma_f32_32x32x16_bf16 v[64:79], v[32:35], v[36:39], v[64:79]
    s_add_u32 m0, s52, 81920
    s_add_u32 s48, s48, 8192
    buffer_load_dwordx4 v1, s[16:19], s49 offen lds
    ds_read_b128 v[24:27], v13 offset:4096
    ds_read_b128 v[28:31], v11 offset:2048
    s_waitcnt lgkmcnt(4)
    v_mfma_f32_32x32x16_bf16 v[64:79], v[40:43], v[44:47], v[64:79]
    buffer_load_dwordx4 v1, s[16:19], s49 offen offset:1024 lds
    s_add_u32 s49, s49, 131072
    s_add_u32 s53, s53, 1
    s_cmp_lt_u32 s53, 5
    s_cbranch_scc1 p4_loop_128
    s_waitcnt vmcnt(8)
    s_barrier
    ds_read_b128 v[32:35], v13 offset:8192
    ds_read_b128 v[36:39], v11 offset:4096
    s_waitcnt lgkmcnt(4)
    v_mfma_f32_32x32x16_bf16 v[64:79], v[16:19], v[20:23], v[64:79]
    s_add_u32 m0, s52, 98304
    s_nop 0
    buffer_load_dwordx4 v1, s[36:39], s48 offen lds
    ds_read_b128 v[40:43], v13 offset:12288
    ds_read_b128 v[44:47], v11 offset:6144
    s_waitcnt lgkmcnt(4)
    v_mfma_f32_32x32x16_bf16 v[64:79], v[24:27], v[28:31], v[64:79]
    buffer_load_dwordx4 v1, s[36:39], s48 offen offset:1024 lds
    ds_read_b128 v[16:19], v5 offset:0
    ds_read_b128 v[20:23], v4 offset:0
    s_waitcnt lgkmcnt(4)
    v_mfma_f32_32x32x16_bf16 v[64:79], v[32:35], v[36:39], v[64:79]
    s_add_u32 m0, s52, 114688
    s_add_u32 s48, s48, 8192
    buffer_load_dwordx4 v1, s[16:19], s49 offen lds
    ds_read_b128 v[24:27], v5 offset:4096
    ds_read_b128 v[28:31], v4 offset:2048
    s_waitcnt lgkmcnt(4)
    v_mfma_f32_32x32x16_bf16 v[64:79], v[40:43], v[44:47], v[64:79]
    buffer_load_dwordx4 v1, s[16:19], s49 offen offset:1024 lds
    s_add_u32 s49, s49, 131072
    s_waitcnt vmcnt(8)
    s_barrier
    ds_read_b128 v[32:35], v5 offset:8192
    ds_read_b128 v[36:39], v4 offset:4096
    s_waitcnt lgkmcnt(4)
    v_mfma_f32_32x32x16_bf16 v[64:79], v[16:19], v[20:23], v[64:79]
    s_add_u32 m0, s52, 131072
    s_nop 0
    buffer_load_dwordx4 v1, s[36:39], s48 offen lds
    ds_read_b128 v[40:43], v5 offset:12288
    ds_read_b128 v[44:47], v4 offset:6144
    s_waitcnt lgkmcnt(4)
    v_mfma_f32_32x32x16_bf16 v[64:79], v[24:27], v[28:31], v[64:79]
    buffer_load_dwordx4 v1, s[36:39], s48 offen offset:1024 lds
    ds_read_b128 v[16:19], v5 offset:32768
    ds_read_b128 v[20:23], v4 offset:32768
    s_waitcnt lgkmcnt(4)
    v_mfma_f32_32x32x16_bf16 v[64:79], v[32:35], v[36:39], v[64:79]
    s_add_u32 m0, s52, 147456
    s_add_u32 s48, s48, 8192
    buffer_load_dwordx4 v1, s[16:19], s49 offen lds
    ds_read_b128 v[24:27], v5 offset:36864
    ds_read_b128 v[28:31], v4 offset:34816
    s_waitcnt lgkmcnt(4)
    v_mfma_f32_32x32x16_bf16 v[64:79], v[40:43], v[44:47], v[64:79]
    buffer_load_dwordx4 v1, s[16:19], s49 offen offset:1024 lds
    s_add_u32 s49, s49, 131072
    s_waitcnt vmcnt(8)
    s_barrier
    ds_read_b128 v[32:35], v5 offset:40960
    ds_read_b128 v[36:39], v4 offset:36864
    s_waitcnt lgkmcnt(4)
    v_mfma_f32_32x32x16_bf16 v[64:79], v[16:19], v[20:23], v[64:79]
    s_add_u32 m0, s52, 0
    s_nop 0
    buffer_load_dwordx4 v1, s[36:39], s48 offen lds
    ds_read_b128 v[40:43], v5 offset:45056
    ds_read_b128 v[44:47], v4 offset:38912
    s_waitcnt lgkmcnt(4)
    v_mfma_f32_32x32x16_bf16 v[64:79], v[24:27], v[28:31], v[64:79]
    buffer_load_dwordx4 v1, s[36:39], s48 offen offset:1024 lds
    ds_read_b128 v[16:19], v12 offset:0
    ds_read_b128 v[20:23], v10 offset:0
    s_waitcnt lgkmcnt(4)
    v_mfma_f32_32x32x16_bf16 v[64:79], v[32:35], v[36:39], v[64:79]
    s_add_u32 m0, s52, 16384
    s_add_u32 s48, s48, 8192
    buffer_load_dwordx4 v1, s[16:19], s49 offen lds
    ds_read_b128 v[24:27], v12 offset:4096
    ds_read_b128 v[28:31], v10 offset:2048
    s_waitcnt lgkmcnt(4)
    v_mfma_f32_32x32x16_bf16 v[64:79], v[40:43], v[44:47], v[64:79]
    buffer_load_dwordx4 v1, s[16:19], s49 offen offset:1024 lds
    s_add_u32 s49, s49, 131072
    s_waitcnt vmcnt(8)
    s_barrier
    ds_read_b128 v[32:35], v12 offset:8192
    ds_read_b128 v[36:39], v10 offset:4096
    s_waitcnt lgkmcnt(4)
    v_mfma_f32_32x32x16_bf16 v[64:79], v[16:19], v[20:23], v[64:79]
    ds_read_b128 v[40:43], v12 offset:12288
    ds_read_b128 v[44:47], v10 offset:6144
    s_waitcnt lgkmcnt(4)
    v_mfma_f32_32x32x16_bf16 v[64:79], v[24:27], v[28:31], v[64:79]
    ds_read_b128 v[16:19], v12 offset:32768
    ds_read_b128 v[20:23], v10 offset:32768
    s_waitcnt lgkmcnt(4)
    v_mfma_f32_32x32x16_bf16 v[64:79], v[32:35], v[36:39], v[64:79]
    ds_read_b128 v[24:27], v12 offset:36864
    ds_read_b128 v[28:31], v10 offset:34816
    s_waitcnt lgkmcnt(4)
    v_mfma_f32_32x32x16_bf16 v[64:79], v[40:43], v[44:47], v[64:79]
    s_waitcnt vmcnt(4)
    s_barrier
    ds_read_b128 v[32:35], v12 offset:40960
    ds_read_b128 v[36:39], v10 offset:36864
    s_waitcnt lgkmcnt(4)
    v_mfma_f32_32x32x16_bf16 v[64:79], v[16:19], v[20:23], v[64:79]
    ds_read_b128 v[40:43], v12 offset:45056
    ds_read_b128 v[44:47], v10 offset:38912
    s_waitcnt lgkmcnt(4)
    v_mfma_f32_32x32x16_bf16 v[64:79], v[24:27], v[28:31], v[64:79]
    ds_read_b128 v[16:19], v13 offset:0
    ds_read_b128 v[20:23], v11 offset:0
    s_waitcnt lgkmcnt(4)
    v_mfma_f32_32x32x16_bf16 v[64:79], v[32:35], v[36:39], v[64:79]
    ds_read_b128 v[24:27], v13 offset:4096
    ds_read_b128 v[28:31], v11 offset:2048
    s_waitcnt lgkmcnt(4)
    v_mfma_f32_32x32x16_bf16 v[64:79], v[40:43], v[44:47], v[64:79]
    s_waitcnt vmcnt(0)
    s_barrier
    ds_read_b128 v[32:35], v13 offset:8192
    ds_read_b128 v[36:39], v11 offset:4096
    s_waitcnt lgkmcnt(4)
    v_mfma_f32_32x32x16_bf16 v[64:79], v[16:19], v[20:23], v[64:79]
    ds_read_b128 v[40:43], v13 offset:12288
    ds_read_b128 v[44:47], v11 offset:6144
    s_waitcnt lgkmcnt(4)
    v_mfma_f32_32x32x16_bf16 v[64:79], v[24:27], v[28:31], v[64:79]
    ds_read_b128 v[16:19], v5 offset:0
    ds_read_b128 v[20:23], v4 offset:0
    s_waitcnt lgkmcnt(4)
    v_mfma_f32_32x32x16_bf16 v[64:79], v[32:35], v[36:39], v[64:79]
    ds_read_b128 v[24:27], v5 offset:4096
    ds_read_b128 v[28:31], v4 offset:2048
    s_waitcnt lgkmcnt(4)
    v_mfma_f32_32x32x16_bf16 v[64:79], v[40:43], v[44:47], v[64:79]
    ds_read_b128 v[32:35], v5 offset:8192
    ds_read_b128 v[36:39], v4 offset:4096
    s_waitcnt lgkmcnt(4)
    v_mfma_f32_32x32x16_bf16 v[64:79], v[16:19], v[20:23], v[64:79]
    ds_read_b128 v[40:43], v5 offset:12288
    ds_read_b128 v[44:47], v4 offset:6144
    s_waitcnt lgkmcnt(4)
    v_mfma_f32_32x32x16_bf16 v[64:79], v[24:27], v[28:31], v[64:79]
    s_waitcnt lgkmcnt(2)
    v_mfma_f32_32x32x16_bf16 v[64:79], v[32:35], v[36:39], v[64:79]
    s_waitcnt lgkmcnt(0)
    v_mfma_f32_32x32x16_bf16 v[64:79], v[40:43], v[44:47], v[64:79]
    s_nop 7
    s_nop 7
    s_barrier
    s_lshl_b32 s66, s40, 12
    v_add_u32 v6, s66, v1
    s_xor_b32 s66, s66, 16384
    v_add_u32 v7, s66, v1

    s_cmp_eq_u32 s47, 0
    s_cbranch_scc0 p4g1_129
    ds_write_b128 v6, v[72:75]
    ds_write_b128 v6, v[76:79] offset:1024
    ds_write_b128 v6, v[88:91] offset:2048
    ds_write_b128 v6, v[92:95] offset:3072
    s_waitcnt lgkmcnt(0)
    s_barrier
    ds_read_b128 v[16:19], v7 offset:0
    ds_read_b128 v[20:23], v7 offset:1024
    ds_read_b128 v[24:27], v7 offset:2048
    ds_read_b128 v[28:31], v7 offset:3072
    s_waitcnt lgkmcnt(0)
    v_add_f32 v32, v64, v16
    v_add_f32 v40, v80, v24
    v_add_f32 v33, v65, v17
    v_add_f32 v41, v81, v25
    v_add_f32 v34, v66, v18
    v_add_f32 v42, v82, v26
    v_add_f32 v35, v67, v19
    v_add_f32 v43, v83, v27
    v_add_f32 v36, v68, v20
    v_add_f32 v44, v84, v28
    v_add_f32 v37, v69, v21
    v_add_f32 v45, v85, v29
    v_add_f32 v38, v70, v22
    v_add_f32 v46, v86, v30
    v_add_f32 v39, v71, v23
    v_add_f32 v47, v87, v31
    s_branch p4gd_130
p4g1_129:
    ds_write_b128 v6, v[64:67]
    ds_write_b128 v6, v[68:71] offset:1024
    ds_write_b128 v6, v[80:83] offset:2048
    ds_write_b128 v6, v[84:87] offset:3072
    s_waitcnt lgkmcnt(0)
    s_barrier
    ds_read_b128 v[16:19], v7 offset:0
    ds_read_b128 v[20:23], v7 offset:1024
    ds_read_b128 v[24:27], v7 offset:2048
    ds_read_b128 v[28:31], v7 offset:3072
    s_waitcnt lgkmcnt(0)
    v_add_f32 v32, v72, v16
    v_add_f32 v40, v88, v24
    v_add_f32 v33, v73, v17
    v_add_f32 v41, v89, v25
    v_add_f32 v34, v74, v18
    v_add_f32 v42, v90, v26
    v_add_f32 v35, v75, v19
    v_add_f32 v43, v91, v27
    v_add_f32 v36, v76, v20
    v_add_f32 v44, v92, v28
    v_add_f32 v37, v77, v21
    v_add_f32 v45, v93, v29
    v_add_f32 v38, v78, v22
    v_add_f32 v46, v94, v30
    v_add_f32 v39, v79, v23
    v_add_f32 v47, v95, v31
p4gd_130:
    s_mov_b32 s68, 0xbfb8aa3b
    v_cvt_pk_bf16_f32 v32, v32, v32
    v_lshlrev_b32 v32, 16, v32
    v_cvt_pk_bf16_f32 v40, v40, v40
    v_lshlrev_b32 v40, 16, v40
    v_mul_f32 v48, s68, v40
    v_exp_f32 v48, v48
    v_cvt_pk_bf16_f32 v33, v33, v33
    v_lshlrev_b32 v33, 16, v33
    v_cvt_pk_bf16_f32 v41, v41, v41
    v_lshlrev_b32 v41, 16, v41
    v_mul_f32 v49, s68, v41
    v_exp_f32 v49, v49
    v_cvt_pk_bf16_f32 v34, v34, v34
    v_lshlrev_b32 v34, 16, v34
    v_cvt_pk_bf16_f32 v42, v42, v42
    v_lshlrev_b32 v42, 16, v42
    v_mul_f32 v50, s68, v42
    v_exp_f32 v50, v50
    v_cvt_pk_bf16_f32 v35, v35, v35
    v_lshlrev_b32 v35, 16, v35
    v_cvt_pk_bf16_f32 v43, v43, v43
    v_lshlrev_b32 v43, 16, v43
    v_mul_f32 v51, s68, v43
    v_exp_f32 v51, v51
    v_cvt_pk_bf16_f32 v36, v36, v36
    v_lshlrev_b32 v36, 16, v36
    v_cvt_pk_bf16_f32 v44, v44, v44
    v_lshlrev_b32 v44, 16, v44
    v_mul_f32 v52, s68, v44
    v_exp_f32 v52, v52
    v_cvt_pk_bf16_f32 v37, v37, v37
    v_lshlrev_b32 v37, 16, v37
    v_cvt_pk_bf16_f32 v45, v45, v45
    v_lshlrev_b32 v45, 16, v45
    v_mul_f32 v53, s68, v45
    v_exp_f32 v53, v53
    v_cvt_pk_bf16_f32 v38, v38, v38
    v_lshlrev_b32 v38, 16, v38
    v_cvt_pk_bf16_f32 v46, v46, v46
    v_lshlrev_b32 v46, 16, v46
    v_mul_f32 v54, s68, v46
    v_exp_f32 v54, v54
    v_cvt_pk_bf16_f32 v39, v39, v39
    v_lshlrev_b32 v39, 16, v39
    v_cvt_pk_bf16_f32 v47, v47, v47
    v_lshlrev_b32 v47, 16, v47
    v_mul_f32 v55, s68, v47
    v_exp_f32 v55, v55
    v_add_f32 v48, 1.0, v48
    v_rcp_f32 v48, v48
    v_add_f32 v49, 1.0, v49
    v_rcp_f32 v49, v49
    v_add_f32 v50, 1.0, v50
    v_rcp_f32 v50, v50
    v_add_f32 v51, 1.0, v51
    v_rcp_f32 v51, v51
    v_add_f32 v52, 1.0, v52
    v_rcp_f32 v52, v52
    v_add_f32 v53, 1.0, v53
    v_rcp_f32 v53, v53
    v_add_f32 v54, 1.0, v54
    v_rcp_f32 v54, v54
    v_add_f32 v55, 1.0, v55
    v_rcp_f32 v55, v55
    v_mul_f32 v40, v40, v48
    v_cvt_pk_bf16_f32 v40, v40, v40
    v_lshlrev_b32 v40, 16, v40
    v_mul_f32 v32, v32, v40
    v_cvt_pk_bf16_f32 v32, v32, v32
    v_lshlrev_b32 v32, 16, v32
    v_mul_f32 v41, v41, v49
    v_cvt_pk_bf16_f32 v41, v41, v41
    v_lshlrev_b32 v41, 16, v41
    v_mul_f32 v33, v33, v41
    v_cvt_pk_bf16_f32 v33, v33, v33
    v_lshlrev_b32 v33, 16, v33
    v_mul_f32 v42, v42, v50
    v_cvt_pk_bf16_f32 v42, v42, v42
    v_lshlrev_b32 v42, 16, v42
    v_mul_f32 v34, v34, v42
    v_cvt_pk_bf16_f32 v34, v34, v34
    v_lshlrev_b32 v34, 16, v34
    v_mul_f32 v43, v43, v51
    v_cvt_pk_bf16_f32 v43, v43, v43
    v_lshlrev_b32 v43, 16, v43
    v_mul_f32 v35, v35, v43
    v_cvt_pk_bf16_f32 v35, v35, v35
    v_lshlrev_b32 v35, 16, v35
    v_mul_f32 v44, v44, v52
    v_cvt_pk_bf16_f32 v44, v44, v44
    v_lshlrev_b32 v44, 16, v44
    v_mul_f32 v36, v36, v44
    v_cvt_pk_bf16_f32 v36, v36, v36
    v_lshlrev_b32 v36, 16, v36
    v_mul_f32 v45, v45, v53
    v_cvt_pk_bf16_f32 v45, v45, v45
    v_lshlrev_b32 v45, 16, v45
    v_mul_f32 v37, v37, v45
    v_cvt_pk_bf16_f32 v37, v37, v37
    v_lshlrev_b32 v37, 16, v37
    v_mul_f32 v46, v46, v54
    v_cvt_pk_bf16_f32 v46, v46, v46
    v_lshlrev_b32 v46, 16, v46
    v_mul_f32 v38, v38, v46
    v_cvt_pk_bf16_f32 v38, v38, v38
    v_lshlrev_b32 v38, 16, v38
    v_mul_f32 v47, v47, v55
    v_cvt_pk_bf16_f32 v47, v47, v47
    v_lshlrev_b32 v47, 16, v47
    v_mul_f32 v39, v39, v47
    v_cvt_pk_bf16_f32 v39, v39, v39
    v_lshlrev_b32 v39, 16, v39
    s_waitcnt vmcnt(0)
    v_lshlrev_b32 v48, 16, v100
    v_and_b32 v49, 0xffff0000, v100
    v_add_f32 v32, v32, v48
    v_add_f32 v33, v33, v49
    v_cvt_pk_bf16_f32 v52, v32, v33
    v_lshlrev_b32 v48, 16, v101
    v_and_b32 v49, 0xffff0000, v101
    v_add_f32 v34, v34, v48
    v_add_f32 v35, v35, v49
    v_cvt_pk_bf16_f32 v53, v34, v35
    v_lshlrev_b32 v48, 16, v102
    v_and_b32 v49, 0xffff0000, v102
    v_add_f32 v36, v36, v48
    v_add_f32 v37, v37, v49
    v_cvt_pk_bf16_f32 v54, v36, v37
    v_lshlrev_b32 v48, 16, v103
    v_and_b32 v49, 0xffff0000, v103
    v_add_f32 v38, v38, v48
    v_add_f32 v39, v39, v49
    v_cvt_pk_bf16_f32 v55, v38, v39
    buffer_store_dwordx2 v[52:53], v98, s[12:15], s58 offen
    buffer_store_dwordx2 v[54:55], v98, s[12:15], s58 offen offset:16
f_done_1:
    s_endpgm
code_end:
    s_endpgm
.section .rodata,"a"
.p2align 6
.amdhsa_kernel recurrent_scan__compressed_kv_cla__geglu_ffn__prompt_kernel
  .amdhsa_next_free_vgpr 248
  .amdhsa_next_free_sgpr 102
  .amdhsa_accum_offset 248
  .amdhsa_group_segment_fixed_size 0
  .amdhsa_kernarg_size 104
  .amdhsa_user_sgpr_count 2
  .amdhsa_user_sgpr_kernarg_segment_ptr 1
  .amdhsa_system_sgpr_workgroup_id_x 1
.end_amdhsa_kernel
```
